```python
import torch

def _softmax(x, axis=-1):
    return torch.softmax(x, dim=axis)
def _gelu(x):
    return torch.nn.functional.gelu(x, approximate="tanh")
def _silu(x):
    return torch.nn.functional.silu(x)
def _sigmoid(x):
    return torch.sigmoid(x)
def _layernorm(x, axis=-1, eps=1e-5):
    m = x.mean(dim=axis, keepdim=True)
    v = x.var(dim=axis, keepdim=True, unbiased=False)
    return (x - m) / torch.sqrt(v + eps)
def _scatter_add(tgt, idx, src, axis=0):
    return tgt.clone().index_add_(axis, idx, src)
def _segment_sum(src, seg, n):
    out = torch.zeros((n,) + src.shape[1:], dtype=src.dtype)
    return out.index_add_(0, seg, src)
def _pad(x, pw):
    flat = tuple(v for pair in reversed(pw) for v in pair)
    return torch.nn.functional.pad(x, flat)

kernel_name = 'sequential_preLN__spectral_gfnet__dense_activation_mish__prompt'

def setup_inputs():

    _w = (lambda a: (lambda t: t.to(torch.bfloat16) if t.is_floating_point() else t)(torch.as_tensor(a)))
    def _A_setup():
        B, S, D = 1, 2048, 1024
        Df = D // 2 + 1
        return {
            "x": _w((lambda *s: torch.randn(*s, dtype=torch.bfloat16) * 0.05)(B, S, D)),
            "w_r": _w((lambda *s: torch.randn(*s, dtype=torch.bfloat16) * 0.4)(S, Df) * 0.02),
            "w_i": _w((lambda *s: torch.randn(*s, dtype=torch.bfloat16) * 0.4)(S, Df) * 0.02),
        }
    _A_in = _A_setup()

    def _B_setup():
        B, S, D, F = 1, 2048, 1024, 3584
        return {
            "x": _w((lambda *s: torch.randn(*s, dtype=torch.bfloat16) * 0.05)(B, S, D)),
            "w1": _w((lambda *s: torch.randn(*s, dtype=torch.bfloat16) * 0.8)(D, F) * (D ** -0.5)),
            "b1": _w((lambda *s: torch.randn(*s, dtype=torch.bfloat16) * 0.2)(F)),
            "w2": _w((lambda *s: torch.randn(*s, dtype=torch.bfloat16) * 0.1)(F, D) * (F ** -0.5)),
        }
    _B_in = _B_setup()

    return {
        "A_x": _A_in["x"],
        "A_w_r": _A_in["w_r"],
        "A_w_i": _A_in["w_i"],
        "B_x": _B_in["x"],
        "B_w1": _B_in["w1"],
        "B_b1": _B_in["b1"],
        "B_w2": _B_in["w2"],
    }

def reference(A_x, A_w_r, A_w_i, B_x, B_w1, B_b1, B_w2):
    def _A_ref(x, w_r, w_i):
        B, S, D = x.shape
        X = (lambda x, axes=(-2,-1): torch.fft.rfft2(x.float(), dim=axes))(x, axes=(-2, -1))
        W = w_r + 1j * w_i
        X = X * W
        y = (lambda x, s, axes=(-2,-1): torch.fft.irfft2(x, s=s, dim=axes).to(torch.bfloat16))(X, (S, D), axes=(-2, -1))
        return y

    def _B_ref(x, w1, b1, w2):
        h = torch.einsum("bsd,df->bsf", x, w1) + b1
        sp = torch.log1p(torch.exp(-torch.abs(h))) + torch.where(h > 0, h, torch.zeros_like(h))
        act = h * torch.tanh(sp)
        return torch.einsum("bsf,fd->bsd", act, w2)

    x = A_x
    h = x + _A_ref(_layernorm(x, axis=-1), A_w_r, A_w_i)
    h2 = h + _B_ref(_layernorm(h, axis=-1), B_w1, B_b1, B_w2)
    return h2
```

```asm
; @launch kernel=k1_kernel grid=(512,1,1) block=(256,1,1) lds=34816
; @launch kernel=k2_kernel grid=(961,1,1) block=(128,1,1) lds=34816
; @launch kernel=k3_kernel grid=(480,1,1) block=(256,1,1) lds=67648
; @launch kernel=k4_kernel grid=(256,1,1) block=(512,1,1) lds=135168
; @launch kernel=k5_kernel grid=(256,1,1) block=(512,1,1) lds=98304
.amdgcn_target "amdgcn-amd-amdhsa--gfx950"
.text
.p2align 8
.globl k1_kernel
.type k1_kernel,@function
k1_kernel:
    s_cmp_ge_u32 s2, 512
    s_cbranch_scc1 k1_end
    s_load_dwordx4 s[4:7], s[0:1], 0
    s_load_dwordx2 s[8:9], s[0:1], 16
    s_load_dwordx2 s[10:11], s[0:1], 32
    s_load_dwordx2 s[12:13], s[0:1], 72
    s_waitcnt lgkmcnt(0)
    s_cmp_ge_u32 s2, 256
    s_cbranch_scc1 k1_wt
    s_mov_b32 s16, s4
    s_mov_b32 s17, s5
    s_mov_b32 s18, 0x400000
    s_mov_b32 s19, 0x00020000
    s_mov_b32 s28, s12
    s_mov_b32 s29, s13
    s_mov_b32 s30, 0x824100
    s_mov_b32 s31, 0x00020000
    v_and_b32 v1, 63, v0
    v_lshrrev_b32 v2, 6, v0
    s_lshl_b32 s3, s2, 3
    v_lshlrev_b32 v3, 1, v2
    v_add_u32 v3, s3, v3
    v_lshlrev_b32 v3, 11, v3
    v_lshl_add_u32 v3, v1, 4, v3
    buffer_load_dwordx4 v[8:11], v3, s[16:19], 0 offen
    buffer_load_dwordx4 v[12:15], v3, s[16:19], 0 offen offset:1024
    buffer_load_dwordx4 v[16:19], v3, s[16:19], 0 offen offset:2048
    buffer_load_dwordx4 v[20:23], v3, s[16:19], 0 offen offset:3072
    s_mov_b32 s36, 0x3f3504f3
    s_mov_b32 s37, 0x3f3504f3
    s_mov_b32 s38, 0x3f6c835e
    s_mov_b32 s39, 0x3ec3ef15
    v_mul_u32_u24 v24, 8704, v2
    v_lshrrev_b32 v25, 4, v1
    v_add_u32 v25, v25, v1
    v_lshl_add_u32 v25, v25, 3, v24
    v_lshrrev_b32 v26, 1, v1
    v_lshl_add_u32 v26, v1, 3, v26
    v_lshl_add_u32 v26, v26, 3, v24
    s_waitcnt vmcnt(0)
    v_lshlrev_b32 v28, 16, v8
    v_and_b32 v30, 0xffff0000, v8
    v_lshlrev_b32 v29, 16, v16
    v_and_b32 v31, 0xffff0000, v16
    v_lshlrev_b32 v32, 16, v9
    v_and_b32 v34, 0xffff0000, v9
    v_lshlrev_b32 v33, 16, v17
    v_and_b32 v35, 0xffff0000, v17
    v_lshlrev_b32 v36, 16, v10
    v_and_b32 v38, 0xffff0000, v10
    v_lshlrev_b32 v37, 16, v18
    v_and_b32 v39, 0xffff0000, v18
    v_lshlrev_b32 v40, 16, v11
    v_and_b32 v42, 0xffff0000, v11
    v_lshlrev_b32 v41, 16, v19
    v_and_b32 v43, 0xffff0000, v19
    v_lshlrev_b32 v44, 16, v12
    v_and_b32 v46, 0xffff0000, v12
    v_lshlrev_b32 v45, 16, v20
    v_and_b32 v47, 0xffff0000, v20
    v_lshlrev_b32 v48, 16, v13
    v_and_b32 v50, 0xffff0000, v13
    v_lshlrev_b32 v49, 16, v21
    v_and_b32 v51, 0xffff0000, v21
    v_lshlrev_b32 v52, 16, v14
    v_and_b32 v54, 0xffff0000, v14
    v_lshlrev_b32 v53, 16, v22
    v_and_b32 v55, 0xffff0000, v22
    v_lshlrev_b32 v56, 16, v15
    v_and_b32 v58, 0xffff0000, v15
    v_lshlrev_b32 v57, 16, v23
    v_and_b32 v59, 0xffff0000, v23
    v_pk_add_f32 v[60:61], v[28:29], v[30:31]
    v_pk_add_f32 v[60:61], v[60:61], v[32:33]
    v_pk_add_f32 v[60:61], v[60:61], v[34:35]
    v_pk_add_f32 v[60:61], v[60:61], v[36:37]
    v_pk_add_f32 v[60:61], v[60:61], v[38:39]
    v_pk_add_f32 v[60:61], v[60:61], v[40:41]
    v_pk_add_f32 v[60:61], v[60:61], v[42:43]
    v_pk_add_f32 v[60:61], v[60:61], v[44:45]
    v_pk_add_f32 v[60:61], v[60:61], v[46:47]
    v_pk_add_f32 v[60:61], v[60:61], v[48:49]
    v_pk_add_f32 v[60:61], v[60:61], v[50:51]
    v_pk_add_f32 v[60:61], v[60:61], v[52:53]
    v_pk_add_f32 v[60:61], v[60:61], v[54:55]
    v_pk_add_f32 v[60:61], v[60:61], v[56:57]
    v_pk_add_f32 v[60:61], v[60:61], v[58:59]
    s_nop 1
    v_add_f32_dpp v60, v60, v60 row_shr:1 row_mask:0xf bank_mask:0xf bound_ctrl:0
    v_add_f32_dpp v61, v61, v61 row_shr:1 row_mask:0xf bank_mask:0xf bound_ctrl:0
    s_nop 0
    v_add_f32_dpp v60, v60, v60 row_shr:2 row_mask:0xf bank_mask:0xf bound_ctrl:0
    v_add_f32_dpp v61, v61, v61 row_shr:2 row_mask:0xf bank_mask:0xf bound_ctrl:0
    s_nop 0
    v_add_f32_dpp v60, v60, v60 row_shr:4 row_mask:0xf bank_mask:0xf bound_ctrl:0
    v_add_f32_dpp v61, v61, v61 row_shr:4 row_mask:0xf bank_mask:0xf bound_ctrl:0
    s_nop 0
    v_add_f32_dpp v60, v60, v60 row_shr:8 row_mask:0xf bank_mask:0xf bound_ctrl:0
    v_add_f32_dpp v61, v61, v61 row_shr:8 row_mask:0xf bank_mask:0xf bound_ctrl:0
    s_nop 0
    v_add_f32_dpp v60, v60, v60 row_bcast:15 row_mask:0xa bank_mask:0xf
    v_add_f32_dpp v61, v61, v61 row_bcast:15 row_mask:0xa bank_mask:0xf
    s_nop 0
    v_add_f32_dpp v60, v60, v60 row_bcast:31 row_mask:0xc bank_mask:0xf
    v_add_f32_dpp v61, v61, v61 row_bcast:31 row_mask:0xc bank_mask:0xf
    s_nop 0
    v_readlane_b32 s42, v60, 63
    v_readlane_b32 s43, v61, 63
    s_nop 1
    v_mov_b32 v60, s42
    v_mov_b32 v61, s43
    v_mul_f32 v64, 0x3a800000, v60
    v_mul_f32 v65, 0x3a800000, v61
    v_pk_add_f32 v[62:63], v[28:29], v[64:65] neg_lo:[0,1] neg_hi:[0,1]
    v_pk_mul_f32 v[60:61], v[62:63], v[62:63]
    v_pk_add_f32 v[62:63], v[30:31], v[64:65] neg_lo:[0,1] neg_hi:[0,1]
    v_pk_fma_f32 v[60:61], v[62:63], v[62:63], v[60:61]
    v_pk_add_f32 v[62:63], v[32:33], v[64:65] neg_lo:[0,1] neg_hi:[0,1]
    v_pk_fma_f32 v[60:61], v[62:63], v[62:63], v[60:61]
    v_pk_add_f32 v[62:63], v[34:35], v[64:65] neg_lo:[0,1] neg_hi:[0,1]
    v_pk_fma_f32 v[60:61], v[62:63], v[62:63], v[60:61]
    v_pk_add_f32 v[62:63], v[36:37], v[64:65] neg_lo:[0,1] neg_hi:[0,1]
    v_pk_fma_f32 v[60:61], v[62:63], v[62:63], v[60:61]
    v_pk_add_f32 v[62:63], v[38:39], v[64:65] neg_lo:[0,1] neg_hi:[0,1]
    v_pk_fma_f32 v[60:61], v[62:63], v[62:63], v[60:61]
    v_pk_add_f32 v[62:63], v[40:41], v[64:65] neg_lo:[0,1] neg_hi:[0,1]
    v_pk_fma_f32 v[60:61], v[62:63], v[62:63], v[60:61]
    v_pk_add_f32 v[62:63], v[42:43], v[64:65] neg_lo:[0,1] neg_hi:[0,1]
    v_pk_fma_f32 v[60:61], v[62:63], v[62:63], v[60:61]
    v_pk_add_f32 v[62:63], v[44:45], v[64:65] neg_lo:[0,1] neg_hi:[0,1]
    v_pk_fma_f32 v[60:61], v[62:63], v[62:63], v[60:61]
    v_pk_add_f32 v[62:63], v[46:47], v[64:65] neg_lo:[0,1] neg_hi:[0,1]
    v_pk_fma_f32 v[60:61], v[62:63], v[62:63], v[60:61]
    v_pk_add_f32 v[62:63], v[48:49], v[64:65] neg_lo:[0,1] neg_hi:[0,1]
    v_pk_fma_f32 v[60:61], v[62:63], v[62:63], v[60:61]
    v_pk_add_f32 v[62:63], v[50:51], v[64:65] neg_lo:[0,1] neg_hi:[0,1]
    v_pk_fma_f32 v[60:61], v[62:63], v[62:63], v[60:61]
    v_pk_add_f32 v[62:63], v[52:53], v[64:65] neg_lo:[0,1] neg_hi:[0,1]
    v_pk_fma_f32 v[60:61], v[62:63], v[62:63], v[60:61]
    v_pk_add_f32 v[62:63], v[54:55], v[64:65] neg_lo:[0,1] neg_hi:[0,1]
    v_pk_fma_f32 v[60:61], v[62:63], v[62:63], v[60:61]
    v_pk_add_f32 v[62:63], v[56:57], v[64:65] neg_lo:[0,1] neg_hi:[0,1]
    v_pk_fma_f32 v[60:61], v[62:63], v[62:63], v[60:61]
    v_pk_add_f32 v[62:63], v[58:59], v[64:65] neg_lo:[0,1] neg_hi:[0,1]
    v_pk_fma_f32 v[60:61], v[62:63], v[62:63], v[60:61]
    s_nop 1
    v_add_f32_dpp v60, v60, v60 row_shr:1 row_mask:0xf bank_mask:0xf bound_ctrl:0
    v_add_f32_dpp v61, v61, v61 row_shr:1 row_mask:0xf bank_mask:0xf bound_ctrl:0
    s_nop 0
    v_add_f32_dpp v60, v60, v60 row_shr:2 row_mask:0xf bank_mask:0xf bound_ctrl:0
    v_add_f32_dpp v61, v61, v61 row_shr:2 row_mask:0xf bank_mask:0xf bound_ctrl:0
    s_nop 0
    v_add_f32_dpp v60, v60, v60 row_shr:4 row_mask:0xf bank_mask:0xf bound_ctrl:0
    v_add_f32_dpp v61, v61, v61 row_shr:4 row_mask:0xf bank_mask:0xf bound_ctrl:0
    s_nop 0
    v_add_f32_dpp v60, v60, v60 row_shr:8 row_mask:0xf bank_mask:0xf bound_ctrl:0
    v_add_f32_dpp v61, v61, v61 row_shr:8 row_mask:0xf bank_mask:0xf bound_ctrl:0
    s_nop 0
    v_add_f32_dpp v60, v60, v60 row_bcast:15 row_mask:0xa bank_mask:0xf
    v_add_f32_dpp v61, v61, v61 row_bcast:15 row_mask:0xa bank_mask:0xf
    s_nop 0
    v_add_f32_dpp v60, v60, v60 row_bcast:31 row_mask:0xc bank_mask:0xf
    v_add_f32_dpp v61, v61, v61 row_bcast:31 row_mask:0xc bank_mask:0xf
    s_nop 0
    v_readlane_b32 s42, v60, 63
    v_readlane_b32 s43, v61, 63
    s_nop 1
    v_mov_b32 v60, s42
    v_mov_b32 v61, s43
    v_mul_f32 v60, 0x3a800000, v60
    v_cvt_pk_bf16_f32 v60, v60, v60
    v_and_b32 v60, 0xffff0000, v60
    v_add_f32 v60, 0x3727c5ac, v60
    v_cvt_pk_bf16_f32 v60, v60, v60
    v_and_b32 v60, 0xffff0000, v60
    v_sqrt_f32 v60, v60
    s_nop 0
    v_cvt_pk_bf16_f32 v60, v60, v60
    v_and_b32 v60, 0xffff0000, v60
    v_rcp_f32 v60, v60
    v_cvt_pk_bf16_f32 v64, v64, v64
    v_and_b32 v64, 0xffff0000, v64
    v_mul_f32 v61, 0x3a800000, v61
    v_cvt_pk_bf16_f32 v61, v61, v61
    v_and_b32 v61, 0xffff0000, v61
    v_add_f32 v61, 0x3727c5ac, v61
    v_cvt_pk_bf16_f32 v61, v61, v61
    v_and_b32 v61, 0xffff0000, v61
    v_sqrt_f32 v61, v61
    s_nop 0
    v_cvt_pk_bf16_f32 v61, v61, v61
    v_and_b32 v61, 0xffff0000, v61
    v_rcp_f32 v61, v61
    v_cvt_pk_bf16_f32 v65, v65, v65
    v_and_b32 v65, 0xffff0000, v65
    v_pk_add_f32 v[28:29], v[28:29], v[64:65] neg_lo:[0,1] neg_hi:[0,1]
    v_cvt_pk_bf16_f32 v62, v28, v29
    v_lshlrev_b32 v28, 16, v62
    v_and_b32 v29, 0xffff0000, v62
    v_pk_mul_f32 v[28:29], v[28:29], v[60:61]
    v_cvt_pk_bf16_f32 v62, v28, v29
    v_lshlrev_b32 v28, 16, v62
    v_and_b32 v29, 0xffff0000, v62
    v_pk_add_f32 v[30:31], v[30:31], v[64:65] neg_lo:[0,1] neg_hi:[0,1]
    v_cvt_pk_bf16_f32 v62, v30, v31
    v_lshlrev_b32 v30, 16, v62
    v_and_b32 v31, 0xffff0000, v62
    v_pk_mul_f32 v[30:31], v[30:31], v[60:61]
    v_cvt_pk_bf16_f32 v62, v30, v31
    v_lshlrev_b32 v30, 16, v62
    v_and_b32 v31, 0xffff0000, v62
    v_pk_add_f32 v[32:33], v[32:33], v[64:65] neg_lo:[0,1] neg_hi:[0,1]
    v_cvt_pk_bf16_f32 v62, v32, v33
    v_lshlrev_b32 v32, 16, v62
    v_and_b32 v33, 0xffff0000, v62
    v_pk_mul_f32 v[32:33], v[32:33], v[60:61]
    v_cvt_pk_bf16_f32 v62, v32, v33
    v_lshlrev_b32 v32, 16, v62
    v_and_b32 v33, 0xffff0000, v62
    v_pk_add_f32 v[34:35], v[34:35], v[64:65] neg_lo:[0,1] neg_hi:[0,1]
    v_cvt_pk_bf16_f32 v62, v34, v35
    v_lshlrev_b32 v34, 16, v62
    v_and_b32 v35, 0xffff0000, v62
    v_pk_mul_f32 v[34:35], v[34:35], v[60:61]
    v_cvt_pk_bf16_f32 v62, v34, v35
    v_lshlrev_b32 v34, 16, v62
    v_and_b32 v35, 0xffff0000, v62
    v_pk_add_f32 v[36:37], v[36:37], v[64:65] neg_lo:[0,1] neg_hi:[0,1]
    v_cvt_pk_bf16_f32 v62, v36, v37
    v_lshlrev_b32 v36, 16, v62
    v_and_b32 v37, 0xffff0000, v62
    v_pk_mul_f32 v[36:37], v[36:37], v[60:61]
    v_cvt_pk_bf16_f32 v62, v36, v37
    v_lshlrev_b32 v36, 16, v62
    v_and_b32 v37, 0xffff0000, v62
    v_pk_add_f32 v[38:39], v[38:39], v[64:65] neg_lo:[0,1] neg_hi:[0,1]
    v_cvt_pk_bf16_f32 v62, v38, v39
    v_lshlrev_b32 v38, 16, v62
    v_and_b32 v39, 0xffff0000, v62
    v_pk_mul_f32 v[38:39], v[38:39], v[60:61]
    v_cvt_pk_bf16_f32 v62, v38, v39
    v_lshlrev_b32 v38, 16, v62
    v_and_b32 v39, 0xffff0000, v62
    v_pk_add_f32 v[40:41], v[40:41], v[64:65] neg_lo:[0,1] neg_hi:[0,1]
    v_cvt_pk_bf16_f32 v62, v40, v41
    v_lshlrev_b32 v40, 16, v62
    v_and_b32 v41, 0xffff0000, v62
    v_pk_mul_f32 v[40:41], v[40:41], v[60:61]
    v_cvt_pk_bf16_f32 v62, v40, v41
    v_lshlrev_b32 v40, 16, v62
    v_and_b32 v41, 0xffff0000, v62
    v_pk_add_f32 v[42:43], v[42:43], v[64:65] neg_lo:[0,1] neg_hi:[0,1]
    v_cvt_pk_bf16_f32 v62, v42, v43
    v_lshlrev_b32 v42, 16, v62
    v_and_b32 v43, 0xffff0000, v62
    v_pk_mul_f32 v[42:43], v[42:43], v[60:61]
    v_cvt_pk_bf16_f32 v62, v42, v43
    v_lshlrev_b32 v42, 16, v62
    v_and_b32 v43, 0xffff0000, v62
    v_pk_add_f32 v[44:45], v[44:45], v[64:65] neg_lo:[0,1] neg_hi:[0,1]
    v_cvt_pk_bf16_f32 v62, v44, v45
    v_lshlrev_b32 v44, 16, v62
    v_and_b32 v45, 0xffff0000, v62
    v_pk_mul_f32 v[44:45], v[44:45], v[60:61]
    v_cvt_pk_bf16_f32 v62, v44, v45
    v_lshlrev_b32 v44, 16, v62
    v_and_b32 v45, 0xffff0000, v62
    v_pk_add_f32 v[46:47], v[46:47], v[64:65] neg_lo:[0,1] neg_hi:[0,1]
    v_cvt_pk_bf16_f32 v62, v46, v47
    v_lshlrev_b32 v46, 16, v62
    v_and_b32 v47, 0xffff0000, v62
    v_pk_mul_f32 v[46:47], v[46:47], v[60:61]
    v_cvt_pk_bf16_f32 v62, v46, v47
    v_lshlrev_b32 v46, 16, v62
    v_and_b32 v47, 0xffff0000, v62
    v_pk_add_f32 v[48:49], v[48:49], v[64:65] neg_lo:[0,1] neg_hi:[0,1]
    v_cvt_pk_bf16_f32 v62, v48, v49
    v_lshlrev_b32 v48, 16, v62
    v_and_b32 v49, 0xffff0000, v62
    v_pk_mul_f32 v[48:49], v[48:49], v[60:61]
    v_cvt_pk_bf16_f32 v62, v48, v49
    v_lshlrev_b32 v48, 16, v62
    v_and_b32 v49, 0xffff0000, v62
    v_pk_add_f32 v[50:51], v[50:51], v[64:65] neg_lo:[0,1] neg_hi:[0,1]
    v_cvt_pk_bf16_f32 v62, v50, v51
    v_lshlrev_b32 v50, 16, v62
    v_and_b32 v51, 0xffff0000, v62
    v_pk_mul_f32 v[50:51], v[50:51], v[60:61]
    v_cvt_pk_bf16_f32 v62, v50, v51
    v_lshlrev_b32 v50, 16, v62
    v_and_b32 v51, 0xffff0000, v62
    v_pk_add_f32 v[52:53], v[52:53], v[64:65] neg_lo:[0,1] neg_hi:[0,1]
    v_cvt_pk_bf16_f32 v62, v52, v53
    v_lshlrev_b32 v52, 16, v62
    v_and_b32 v53, 0xffff0000, v62
    v_pk_mul_f32 v[52:53], v[52:53], v[60:61]
    v_cvt_pk_bf16_f32 v62, v52, v53
    v_lshlrev_b32 v52, 16, v62
    v_and_b32 v53, 0xffff0000, v62
    v_pk_add_f32 v[54:55], v[54:55], v[64:65] neg_lo:[0,1] neg_hi:[0,1]
    v_cvt_pk_bf16_f32 v62, v54, v55
    v_lshlrev_b32 v54, 16, v62
    v_and_b32 v55, 0xffff0000, v62
    v_pk_mul_f32 v[54:55], v[54:55], v[60:61]
    v_cvt_pk_bf16_f32 v62, v54, v55
    v_lshlrev_b32 v54, 16, v62
    v_and_b32 v55, 0xffff0000, v62
    v_pk_add_f32 v[56:57], v[56:57], v[64:65] neg_lo:[0,1] neg_hi:[0,1]
    v_cvt_pk_bf16_f32 v62, v56, v57
    v_lshlrev_b32 v56, 16, v62
    v_and_b32 v57, 0xffff0000, v62
    v_pk_mul_f32 v[56:57], v[56:57], v[60:61]
    v_cvt_pk_bf16_f32 v62, v56, v57
    v_lshlrev_b32 v56, 16, v62
    v_and_b32 v57, 0xffff0000, v62
    v_pk_add_f32 v[58:59], v[58:59], v[64:65] neg_lo:[0,1] neg_hi:[0,1]
    v_cvt_pk_bf16_f32 v62, v58, v59
    v_lshlrev_b32 v58, 16, v62
    v_and_b32 v59, 0xffff0000, v62
    v_pk_mul_f32 v[58:59], v[58:59], v[60:61]
    v_cvt_pk_bf16_f32 v62, v58, v59
    v_lshlrev_b32 v58, 16, v62
    v_and_b32 v59, 0xffff0000, v62
    ds_write_b64 v26, v[28:29] offset:0
    ds_write_b64 v26, v[44:45] offset:4352
    ds_write_b64 v26, v[30:31] offset:8
    ds_write_b64 v26, v[46:47] offset:4360
    ds_write_b64 v26, v[32:33] offset:16
    ds_write_b64 v26, v[48:49] offset:4368
    ds_write_b64 v26, v[34:35] offset:24
    ds_write_b64 v26, v[50:51] offset:4376
    ds_write_b64 v26, v[36:37] offset:32
    ds_write_b64 v26, v[52:53] offset:4384
    ds_write_b64 v26, v[38:39] offset:40
    ds_write_b64 v26, v[54:55] offset:4392
    ds_write_b64 v26, v[40:41] offset:48
    ds_write_b64 v26, v[56:57] offset:4400
    ds_write_b64 v26, v[42:43] offset:56
    ds_write_b64 v26, v[58:59] offset:4408
    ds_read_b64 v[66:67], v25 offset:0
    ds_read_b64 v[68:69], v25 offset:544
    ds_read_b64 v[70:71], v25 offset:1088
    ds_read_b64 v[72:73], v25 offset:1632
    ds_read_b64 v[74:75], v25 offset:2176
    ds_read_b64 v[76:77], v25 offset:2720
    ds_read_b64 v[78:79], v25 offset:3264
    ds_read_b64 v[80:81], v25 offset:3808
    ds_read_b64 v[82:83], v25 offset:4352
    ds_read_b64 v[84:85], v25 offset:4896
    ds_read_b64 v[86:87], v25 offset:5440
    ds_read_b64 v[88:89], v25 offset:5984
    ds_read_b64 v[90:91], v25 offset:6528
    ds_read_b64 v[92:93], v25 offset:7072
    ds_read_b64 v[94:95], v25 offset:7616
    ds_read_b64 v[96:97], v25 offset:8160
    v_add_u32 v27, 0, v1
    v_lshlrev_b32 v27, 4, v27
    v_lshrrev_b32 v98, 4, v27
    v_add_u32 v27, v27, v98
    v_lshl_add_u32 v27, v27, 3, v24
    s_waitcnt lgkmcnt(0)
    v_pk_add_f32 v[100:101], v[66:67], v[82:83] neg_lo:[0,1] neg_hi:[0,1]
    v_pk_add_f32 v[66:67], v[66:67], v[82:83]
    v_pk_add_f32 v[102:103], v[74:75], v[90:91] neg_lo:[0,1] neg_hi:[0,1]
    v_pk_add_f32 v[74:75], v[74:75], v[90:91]
    v_pk_add_f32 v[108:109], v[70:71], v[86:87] neg_lo:[0,1] neg_hi:[0,1]
    v_pk_add_f32 v[70:71], v[70:71], v[86:87]
    v_pk_add_f32 v[106:107], v[100:101], v[102:103] op_sel:[0,1] op_sel_hi:[1,0] neg_lo:[0,1]
    v_pk_add_f32 v[104:105], v[66:67], v[74:75] neg_lo:[0,1] neg_hi:[0,1]
    v_pk_add_f32 v[66:67], v[66:67], v[74:75]
    v_pk_add_f32 v[100:101], v[100:101], v[102:103] op_sel:[0,1] op_sel_hi:[1,0] neg_hi:[0,1]
    v_pk_add_f32 v[110:111], v[78:79], v[94:95] neg_lo:[0,1] neg_hi:[0,1]
    v_pk_add_f32 v[78:79], v[78:79], v[94:95]
    v_pk_add_f32 v[60:61], v[68:69], v[84:85] neg_lo:[0,1] neg_hi:[0,1]
    v_pk_add_f32 v[68:69], v[68:69], v[84:85]
    v_pk_add_f32 v[114:115], v[108:109], v[110:111] op_sel:[0,1] op_sel_hi:[1,0] neg_lo:[0,1]
    v_pk_add_f32 v[112:113], v[70:71], v[78:79] neg_lo:[0,1] neg_hi:[0,1]
    v_pk_add_f32 v[70:71], v[70:71], v[78:79]
    v_pk_add_f32 v[108:109], v[108:109], v[110:111] op_sel:[0,1] op_sel_hi:[1,0] neg_hi:[0,1]
    v_pk_add_f32 v[122:123], v[114:115], v[114:115] op_sel:[0,1] op_sel_hi:[1,0] neg_lo:[1,0] neg_hi:[1,1]
    v_pk_add_f32 v[120:121], v[104:105], v[112:113] op_sel:[0,1] op_sel_hi:[1,0] neg_lo:[0,1]
    v_pk_add_f32 v[116:117], v[66:67], v[70:71] neg_lo:[0,1] neg_hi:[0,1]
    v_pk_add_f32 v[66:67], v[66:67], v[70:71]
    v_pk_add_f32 v[118:119], v[108:109], v[108:109] op_sel:[0,1] op_sel_hi:[1,0] neg_lo:[0,0] neg_hi:[0,1]
    v_pk_add_f32 v[104:105], v[104:105], v[112:113] op_sel:[0,1] op_sel_hi:[1,0] neg_hi:[0,1]
    v_pk_fma_f32 v[114:115], v[122:123], s[36:37], v[106:107] neg_lo:[1,0,0] neg_hi:[1,0,0]
    v_pk_fma_f32 v[106:107], v[122:123], s[36:37], v[106:107]
    v_pk_fma_f32 v[108:109], v[118:119], s[36:37], v[100:101] neg_lo:[1,0,0] neg_hi:[1,0,0]
    v_pk_fma_f32 v[100:101], v[118:119], s[36:37], v[100:101]
    v_pk_add_f32 v[62:63], v[76:77], v[92:93] neg_lo:[0,1] neg_hi:[0,1]
    v_pk_add_f32 v[76:77], v[76:77], v[92:93]
    v_pk_add_f32 v[30:31], v[72:73], v[88:89] neg_lo:[0,1] neg_hi:[0,1]
    v_pk_add_f32 v[72:73], v[72:73], v[88:89]
    v_pk_add_f32 v[28:29], v[60:61], v[62:63] op_sel:[0,1] op_sel_hi:[1,0] neg_lo:[0,1]
    v_pk_add_f32 v[64:65], v[68:69], v[76:77] neg_lo:[0,1] neg_hi:[0,1]
    v_pk_add_f32 v[68:69], v[68:69], v[76:77]
    v_pk_add_f32 v[60:61], v[60:61], v[62:63] op_sel:[0,1] op_sel_hi:[1,0] neg_hi:[0,1]
    v_pk_add_f32 v[32:33], v[80:81], v[96:97] neg_lo:[0,1] neg_hi:[0,1]
    v_pk_add_f32 v[80:81], v[80:81], v[96:97]
    v_pk_add_f32 v[36:37], v[30:31], v[32:33] op_sel:[0,1] op_sel_hi:[1,0] neg_lo:[0,1]
    v_pk_add_f32 v[30:31], v[30:31], v[32:33] op_sel:[0,1] op_sel_hi:[1,0] neg_hi:[0,1]
    v_pk_add_f32 v[34:35], v[72:73], v[80:81] neg_lo:[0,1] neg_hi:[0,1]
    v_pk_add_f32 v[72:73], v[72:73], v[80:81]
    v_pk_add_f32 v[44:45], v[36:37], v[36:37] op_sel:[0,1] op_sel_hi:[1,0] neg_lo:[1,0] neg_hi:[1,1]
    v_pk_add_f32 v[40:41], v[30:31], v[30:31] op_sel:[0,1] op_sel_hi:[1,0] neg_lo:[0,0] neg_hi:[0,1]
    v_pk_add_f32 v[42:43], v[64:65], v[34:35] op_sel:[0,1] op_sel_hi:[1,0] neg_lo:[0,1]
    v_pk_add_f32 v[38:39], v[68:69], v[72:73] neg_lo:[0,1] neg_hi:[0,1]
    v_pk_add_f32 v[68:69], v[68:69], v[72:73]
    v_pk_fma_f32 v[30:31], v[40:41], s[36:37], v[60:61] neg_lo:[1,0,0] neg_hi:[1,0,0]
    v_pk_fma_f32 v[60:61], v[40:41], s[36:37], v[60:61]
    v_pk_add_f32 v[64:65], v[64:65], v[34:35] op_sel:[0,1] op_sel_hi:[1,0] neg_hi:[0,1]
    v_pk_fma_f32 v[36:37], v[44:45], s[36:37], v[28:29] neg_lo:[1,0,0] neg_hi:[1,0,0]
    v_pk_fma_f32 v[28:29], v[44:45], s[36:37], v[28:29]
    v_pk_add_f32 v[46:47], v[66:67], v[68:69] neg_lo:[0,1] neg_hi:[0,1]
    v_pk_add_f32 v[66:67], v[66:67], v[68:69]
    v_pk_mul_f32 v[48:49], v[60:61], s[38:39] op_sel:[0,0] op_sel_hi:[1,0] neg_lo:[0,0] neg_hi:[0,0]
    v_pk_add_f32 v[50:51], v[64:65], v[64:65] op_sel:[0,1] op_sel_hi:[1,0] neg_lo:[0,0] neg_hi:[0,1]
    v_pk_mul_f32 v[52:53], v[28:29], s[38:39] op_sel:[0,1] op_sel_hi:[1,1] neg_lo:[0,0] neg_hi:[0,0]
    v_pk_add_f32 v[54:55], v[116:117], v[38:39] op_sel:[0,1] op_sel_hi:[1,0] neg_lo:[0,1]
    v_pk_fma_f32 v[48:49], v[60:61], s[38:39], v[48:49] op_sel:[1,1,0] op_sel_hi:[0,1,1] neg_lo:[1,1,0] neg_hi:[0,1,0]
    v_pk_fma_f32 v[64:65], v[50:51], s[36:37], v[104:105] neg_lo:[1,0,0] neg_hi:[1,0,0]
    v_pk_fma_f32 v[104:105], v[50:51], s[36:37], v[104:105]
    v_pk_fma_f32 v[52:53], v[28:29], s[38:39], v[52:53] op_sel:[1,0,0] op_sel_hi:[0,0,1] neg_lo:[1,1,0] neg_hi:[0,1,0]
    v_pk_add_f32 v[60:61], v[100:101], v[48:49] neg_lo:[0,1] neg_hi:[0,1]
    v_pk_add_f32 v[100:101], v[100:101], v[48:49]
    v_pk_add_f32 v[116:117], v[116:117], v[38:39] op_sel:[0,1] op_sel_hi:[1,0] neg_hi:[0,1]
    v_pk_add_f32 v[28:29], v[106:107], v[52:53] neg_lo:[0,1] neg_hi:[0,1]
    v_pk_add_f32 v[106:107], v[106:107], v[52:53]
    v_pk_mul_f32 v[56:57], v[30:31], s[38:39] op_sel:[0,1] op_sel_hi:[1,1] neg_lo:[0,1] neg_hi:[0,1]
    v_pk_add_f32 v[58:59], v[42:43], v[42:43] op_sel:[0,1] op_sel_hi:[1,0] neg_lo:[1,0] neg_hi:[1,1]
    v_pk_mul_f32 v[98:99], v[36:37], s[38:39] op_sel:[0,0] op_sel_hi:[1,0] neg_lo:[0,1] neg_hi:[0,1]
    ds_write_b64 v27, v[66:67] offset:0
    v_pk_fma_f32 v[56:57], v[30:31], s[38:39], v[56:57] op_sel:[1,0,0] op_sel_hi:[0,0,1] neg_lo:[1,1,0] neg_hi:[0,1,0]
    v_pk_fma_f32 v[42:43], v[58:59], s[36:37], v[120:121] neg_lo:[1,0,0] neg_hi:[1,0,0]
    v_pk_fma_f32 v[120:121], v[58:59], s[36:37], v[120:121]
    v_pk_fma_f32 v[98:99], v[36:37], s[38:39], v[98:99] op_sel:[1,1,0] op_sel_hi:[0,1,1] neg_lo:[1,1,0] neg_hi:[0,1,0]
    v_pk_add_f32 v[30:31], v[108:109], v[56:57] neg_lo:[0,1] neg_hi:[0,1]
    v_pk_add_f32 v[108:109], v[108:109], v[56:57]
    ds_write_b64 v27, v[100:101] offset:8
    v_pk_add_f32 v[36:37], v[114:115], v[98:99] neg_lo:[0,1] neg_hi:[0,1]
    v_pk_add_f32 v[114:115], v[114:115], v[98:99]
    ds_write_b64 v27, v[104:105] offset:16
    ds_write_b64 v27, v[106:107] offset:24
    ds_write_b64 v27, v[116:117] offset:32
    ds_write_b64 v27, v[108:109] offset:40
    ds_write_b64 v27, v[120:121] offset:48
    ds_write_b64 v27, v[114:115] offset:56
    ds_write_b64 v27, v[46:47] offset:64
    ds_write_b64 v27, v[60:61] offset:72
    ds_write_b64 v27, v[64:65] offset:80
    ds_write_b64 v27, v[28:29] offset:88
    ds_write_b64 v27, v[54:55] offset:96
    ds_write_b64 v27, v[30:31] offset:104
    ds_write_b64 v27, v[42:43] offset:112
    ds_write_b64 v27, v[36:37] offset:120
    ds_read_b64 v[82:83], v25 offset:0
    ds_read_b64 v[90:91], v25 offset:544
    ds_read_b64 v[74:75], v25 offset:1088
    ds_read_b64 v[102:103], v25 offset:1632
    ds_read_b64 v[86:87], v25 offset:2176
    ds_read_b64 v[94:95], v25 offset:2720
    ds_read_b64 v[78:79], v25 offset:3264
    ds_read_b64 v[110:111], v25 offset:3808
    ds_read_b64 v[70:71], v25 offset:4352
    ds_read_b64 v[118:119], v25 offset:4896
    ds_read_b64 v[112:113], v25 offset:5440
    ds_read_b64 v[122:123], v25 offset:5984
    ds_read_b64 v[84:85], v25 offset:6528
    ds_read_b64 v[92:93], v25 offset:7072
    ds_read_b64 v[76:77], v25 offset:7616
    ds_read_b64 v[62:63], v25 offset:8160
    v_and_b32 v88, 0xf, v1
    v_add_u32 v89, 0, v1
    v_cvt_f32_u32 v88, v88
    v_and_b32 v66, 0xf, v89
    v_mul_f32 v97, 0xbb800000, v88
    v_sub_u32 v89, v89, v66
    v_cos_f32 v96, v97
    v_sin_f32 v97, v97
    v_lshl_add_u32 v89, v89, 4, v66
    v_pk_mul_f32 v[80:81], v[96:97], v[96:97] op_sel:[0,0] op_sel_hi:[1,0]
    v_lshrrev_b32 v66, 4, v89
    v_pk_fma_f32 v[80:81], v[96:97], v[96:97], v[80:81] op_sel:[1,1,0] op_sel_hi:[0,1,1] neg_lo:[1,0,0]
    v_add_u32 v89, v89, v66
    v_pk_mul_f32 v[32:33], v[96:97], v[80:81] op_sel:[0,0] op_sel_hi:[1,0]
    v_pk_mul_f32 v[72:73], v[80:81], v[80:81] op_sel:[0,0] op_sel_hi:[1,0]
    v_lshl_add_u32 v89, v89, 3, v24
    v_pk_fma_f32 v[32:33], v[96:97], v[80:81], v[32:33] op_sel:[1,1,0] op_sel_hi:[0,1,1] neg_lo:[1,0,0]
    v_pk_fma_f32 v[72:73], v[80:81], v[80:81], v[72:73] op_sel:[1,1,0] op_sel_hi:[0,1,1] neg_lo:[1,0,0]
    v_pk_mul_f32 v[40:41], v[80:81], v[32:33] op_sel:[0,0] op_sel_hi:[1,0]
    v_pk_mul_f32 v[34:35], v[32:33], v[32:33] op_sel:[0,0] op_sel_hi:[1,0]
    v_pk_mul_f32 v[44:45], v[32:33], v[72:73] op_sel:[0,0] op_sel_hi:[1,0]
    v_pk_mul_f32 v[68:69], v[72:73], v[72:73] op_sel:[0,0] op_sel_hi:[1,0]
    v_pk_fma_f32 v[40:41], v[80:81], v[32:33], v[40:41] op_sel:[1,1,0] op_sel_hi:[0,1,1] neg_lo:[1,0,0]
    v_pk_fma_f32 v[34:35], v[32:33], v[32:33], v[34:35] op_sel:[1,1,0] op_sel_hi:[0,1,1] neg_lo:[1,0,0]
    v_pk_fma_f32 v[44:45], v[32:33], v[72:73], v[44:45] op_sel:[1,1,0] op_sel_hi:[0,1,1] neg_lo:[1,0,0]
    v_pk_fma_f32 v[68:69], v[72:73], v[72:73], v[68:69] op_sel:[1,1,0] op_sel_hi:[0,1,1] neg_lo:[1,0,0]
    v_pk_mul_f32 v[48:49], v[72:73], v[40:41] op_sel:[0,0] op_sel_hi:[1,0]
    v_pk_mul_f32 v[50:51], v[40:41], v[40:41] op_sel:[0,0] op_sel_hi:[1,0]
    v_pk_mul_f32 v[52:53], v[40:41], v[34:35] op_sel:[0,0] op_sel_hi:[1,0]
    v_pk_mul_f32 v[38:39], v[34:35], v[34:35] op_sel:[0,0] op_sel_hi:[1,0]
    v_pk_fma_f32 v[48:49], v[72:73], v[40:41], v[48:49] op_sel:[1,1,0] op_sel_hi:[0,1,1] neg_lo:[1,0,0]
    v_pk_fma_f32 v[50:51], v[40:41], v[40:41], v[50:51] op_sel:[1,1,0] op_sel_hi:[0,1,1] neg_lo:[1,0,0]
    v_pk_fma_f32 v[52:53], v[40:41], v[34:35], v[52:53] op_sel:[1,1,0] op_sel_hi:[0,1,1] neg_lo:[1,0,0]
    v_pk_fma_f32 v[38:39], v[34:35], v[34:35], v[38:39] op_sel:[1,1,0] op_sel_hi:[0,1,1] neg_lo:[1,0,0]
    v_pk_mul_f32 v[56:57], v[34:35], v[44:45] op_sel:[0,0] op_sel_hi:[1,0]
    v_pk_mul_f32 v[58:59], v[44:45], v[44:45] op_sel:[0,0] op_sel_hi:[1,0]
    v_pk_mul_f32 v[98:99], v[44:45], v[68:69] op_sel:[0,0] op_sel_hi:[1,0]
    v_pk_fma_f32 v[56:57], v[34:35], v[44:45], v[56:57] op_sel:[1,1,0] op_sel_hi:[0,1,1] neg_lo:[1,0,0]
    v_pk_fma_f32 v[58:59], v[44:45], v[44:45], v[58:59] op_sel:[1,1,0] op_sel_hi:[0,1,1] neg_lo:[1,0,0]
    v_pk_fma_f32 v[98:99], v[44:45], v[68:69], v[98:99] op_sel:[1,1,0] op_sel_hi:[0,1,1] neg_lo:[1,0,0]
    s_waitcnt lgkmcnt(0)
    v_pk_mul_f32 v[100:101], v[90:91], v[96:97] op_sel:[0,0] op_sel_hi:[1,0]
    v_pk_mul_f32 v[104:105], v[74:75], v[80:81] op_sel:[0,0] op_sel_hi:[1,0]
    v_pk_mul_f32 v[106:107], v[102:103], v[32:33] op_sel:[0,0] op_sel_hi:[1,0]
    v_pk_mul_f32 v[116:117], v[86:87], v[72:73] op_sel:[0,0] op_sel_hi:[1,0]
    v_pk_fma_f32 v[100:101], v[90:91], v[96:97], v[100:101] op_sel:[1,1,0] op_sel_hi:[0,1,1] neg_lo:[1,0,0]
    v_pk_fma_f32 v[104:105], v[74:75], v[80:81], v[104:105] op_sel:[1,1,0] op_sel_hi:[0,1,1] neg_lo:[1,0,0]
    v_pk_fma_f32 v[106:107], v[102:103], v[32:33], v[106:107] op_sel:[1,1,0] op_sel_hi:[0,1,1] neg_lo:[1,0,0]
    v_pk_fma_f32 v[116:117], v[86:87], v[72:73], v[116:117] op_sel:[1,1,0] op_sel_hi:[0,1,1] neg_lo:[1,0,0]
    v_pk_mul_f32 v[108:109], v[94:95], v[40:41] op_sel:[0,0] op_sel_hi:[1,0]
    v_pk_mul_f32 v[120:121], v[78:79], v[34:35] op_sel:[0,0] op_sel_hi:[1,0]
    v_pk_mul_f32 v[114:115], v[110:111], v[44:45] op_sel:[0,0] op_sel_hi:[1,0]
    v_pk_mul_f32 v[46:47], v[70:71], v[68:69] op_sel:[0,0] op_sel_hi:[1,0]
    v_pk_fma_f32 v[108:109], v[94:95], v[40:41], v[108:109] op_sel:[1,1,0] op_sel_hi:[0,1,1] neg_lo:[1,0,0]
    v_pk_fma_f32 v[120:121], v[78:79], v[34:35], v[120:121] op_sel:[1,1,0] op_sel_hi:[0,1,1] neg_lo:[1,0,0]
    v_pk_fma_f32 v[114:115], v[110:111], v[44:45], v[114:115] op_sel:[1,1,0] op_sel_hi:[0,1,1] neg_lo:[1,0,0]
    v_pk_fma_f32 v[46:47], v[70:71], v[68:69], v[46:47] op_sel:[1,1,0] op_sel_hi:[0,1,1] neg_lo:[1,0,0]
    v_pk_mul_f32 v[60:61], v[118:119], v[48:49] op_sel:[0,0] op_sel_hi:[1,0]
    v_pk_mul_f32 v[64:65], v[112:113], v[50:51] op_sel:[0,0] op_sel_hi:[1,0]
    v_pk_mul_f32 v[28:29], v[122:123], v[52:53] op_sel:[0,0] op_sel_hi:[1,0]
    v_pk_mul_f32 v[54:55], v[84:85], v[38:39] op_sel:[0,0] op_sel_hi:[1,0]
    v_pk_fma_f32 v[60:61], v[118:119], v[48:49], v[60:61] op_sel:[1,1,0] op_sel_hi:[0,1,1] neg_lo:[1,0,0]
    v_pk_fma_f32 v[64:65], v[112:113], v[50:51], v[64:65] op_sel:[1,1,0] op_sel_hi:[0,1,1] neg_lo:[1,0,0]
    v_pk_fma_f32 v[28:29], v[122:123], v[52:53], v[28:29] op_sel:[1,1,0] op_sel_hi:[0,1,1] neg_lo:[1,0,0]
    v_pk_fma_f32 v[54:55], v[84:85], v[38:39], v[54:55] op_sel:[1,1,0] op_sel_hi:[0,1,1] neg_lo:[1,0,0]
    v_pk_mul_f32 v[30:31], v[92:93], v[56:57] op_sel:[0,0] op_sel_hi:[1,0]
    v_pk_mul_f32 v[42:43], v[76:77], v[58:59] op_sel:[0,0] op_sel_hi:[1,0]
    v_pk_mul_f32 v[36:37], v[62:63], v[98:99] op_sel:[0,0] op_sel_hi:[1,0]
    v_pk_add_f32 v[66:67], v[82:83], v[46:47] neg_lo:[0,1] neg_hi:[0,1]
    v_pk_fma_f32 v[30:31], v[92:93], v[56:57], v[30:31] op_sel:[1,1,0] op_sel_hi:[0,1,1] neg_lo:[1,0,0]
    v_pk_fma_f32 v[42:43], v[76:77], v[58:59], v[42:43] op_sel:[1,1,0] op_sel_hi:[0,1,1] neg_lo:[1,0,0]
    v_pk_fma_f32 v[36:37], v[62:63], v[98:99], v[36:37] op_sel:[1,1,0] op_sel_hi:[0,1,1] neg_lo:[1,0,0]
    v_pk_add_f32 v[82:83], v[82:83], v[46:47]
    v_pk_add_f32 v[90:91], v[116:117], v[54:55] neg_lo:[0,1] neg_hi:[0,1]
    v_pk_add_f32 v[116:117], v[116:117], v[54:55]
    v_pk_add_f32 v[80:81], v[104:105], v[64:65] neg_lo:[0,1] neg_hi:[0,1]
    v_pk_add_f32 v[104:105], v[104:105], v[64:65]
    v_pk_add_f32 v[74:75], v[66:67], v[90:91] op_sel:[0,1] op_sel_hi:[1,0] neg_lo:[0,1]
    v_pk_add_f32 v[96:97], v[82:83], v[116:117] neg_lo:[0,1] neg_hi:[0,1]
    v_pk_add_f32 v[82:83], v[82:83], v[116:117]
    v_pk_add_f32 v[66:67], v[66:67], v[90:91] op_sel:[0,1] op_sel_hi:[1,0] neg_hi:[0,1]
    v_pk_add_f32 v[102:103], v[120:121], v[42:43] neg_lo:[0,1] neg_hi:[0,1]
    v_pk_add_f32 v[120:121], v[120:121], v[42:43]
    v_pk_add_f32 v[34:35], v[100:101], v[60:61] neg_lo:[0,1] neg_hi:[0,1]
    v_pk_add_f32 v[100:101], v[100:101], v[60:61]
    v_pk_add_f32 v[86:87], v[80:81], v[102:103] op_sel:[0,1] op_sel_hi:[1,0] neg_lo:[0,1]
    v_pk_add_f32 v[32:33], v[104:105], v[120:121] neg_lo:[0,1] neg_hi:[0,1]
    v_pk_add_f32 v[104:105], v[104:105], v[120:121]
    v_pk_add_f32 v[80:81], v[80:81], v[102:103] op_sel:[0,1] op_sel_hi:[1,0] neg_hi:[0,1]
    v_pk_add_f32 v[78:79], v[86:87], v[86:87] op_sel:[0,1] op_sel_hi:[1,0] neg_lo:[1,0] neg_hi:[1,1]
    v_pk_add_f32 v[40:41], v[96:97], v[32:33] op_sel:[0,1] op_sel_hi:[1,0] neg_lo:[0,1]
    v_pk_add_f32 v[72:73], v[82:83], v[104:105] neg_lo:[0,1] neg_hi:[0,1]
    v_pk_add_f32 v[82:83], v[82:83], v[104:105]
    v_pk_add_f32 v[94:95], v[80:81], v[80:81] op_sel:[0,1] op_sel_hi:[1,0] neg_lo:[0,0] neg_hi:[0,1]
    v_pk_add_f32 v[96:97], v[96:97], v[32:33] op_sel:[0,1] op_sel_hi:[1,0] neg_hi:[0,1]
    v_pk_fma_f32 v[86:87], v[78:79], s[36:37], v[74:75] neg_lo:[1,0,0] neg_hi:[1,0,0]
    v_pk_fma_f32 v[74:75], v[78:79], s[36:37], v[74:75]
    v_pk_fma_f32 v[80:81], v[94:95], s[36:37], v[66:67] neg_lo:[1,0,0] neg_hi:[1,0,0]
    v_pk_fma_f32 v[66:67], v[94:95], s[36:37], v[66:67]
    v_pk_add_f32 v[110:111], v[108:109], v[30:31] neg_lo:[0,1] neg_hi:[0,1]
    v_pk_add_f32 v[108:109], v[108:109], v[30:31]
    v_pk_add_f32 v[68:69], v[106:107], v[28:29] neg_lo:[0,1] neg_hi:[0,1]
    v_pk_add_f32 v[106:107], v[106:107], v[28:29]
    v_pk_add_f32 v[70:71], v[34:35], v[110:111] op_sel:[0,1] op_sel_hi:[1,0] neg_lo:[0,1]
    v_pk_add_f32 v[44:45], v[100:101], v[108:109] neg_lo:[0,1] neg_hi:[0,1]
    v_pk_add_f32 v[100:101], v[100:101], v[108:109]
    v_pk_add_f32 v[34:35], v[34:35], v[110:111] op_sel:[0,1] op_sel_hi:[1,0] neg_hi:[0,1]
    v_pk_add_f32 v[118:119], v[114:115], v[36:37] neg_lo:[0,1] neg_hi:[0,1]
    v_pk_add_f32 v[114:115], v[114:115], v[36:37]
    v_pk_add_f32 v[112:113], v[68:69], v[118:119] op_sel:[0,1] op_sel_hi:[1,0] neg_lo:[0,1]
    v_pk_add_f32 v[68:69], v[68:69], v[118:119] op_sel:[0,1] op_sel_hi:[1,0] neg_hi:[0,1]
    v_pk_add_f32 v[48:49], v[106:107], v[114:115] neg_lo:[0,1] neg_hi:[0,1]
    v_pk_add_f32 v[106:107], v[106:107], v[114:115]
    v_pk_add_f32 v[84:85], v[112:113], v[112:113] op_sel:[0,1] op_sel_hi:[1,0] neg_lo:[1,0] neg_hi:[1,1]
    v_pk_add_f32 v[122:123], v[68:69], v[68:69] op_sel:[0,1] op_sel_hi:[1,0] neg_lo:[0,0] neg_hi:[0,1]
    v_pk_add_f32 v[52:53], v[44:45], v[48:49] op_sel:[0,1] op_sel_hi:[1,0] neg_lo:[0,1]
    v_pk_add_f32 v[50:51], v[100:101], v[106:107] neg_lo:[0,1] neg_hi:[0,1]
    v_pk_add_f32 v[100:101], v[100:101], v[106:107]
    v_pk_fma_f32 v[68:69], v[122:123], s[36:37], v[34:35] neg_lo:[1,0,0] neg_hi:[1,0,0]
    v_pk_fma_f32 v[34:35], v[122:123], s[36:37], v[34:35]
    v_pk_add_f32 v[44:45], v[44:45], v[48:49] op_sel:[0,1] op_sel_hi:[1,0] neg_hi:[0,1]
    v_pk_fma_f32 v[112:113], v[84:85], s[36:37], v[70:71] neg_lo:[1,0,0] neg_hi:[1,0,0]
    v_pk_fma_f32 v[70:71], v[84:85], s[36:37], v[70:71]
    v_pk_add_f32 v[38:39], v[82:83], v[100:101] neg_lo:[0,1] neg_hi:[0,1]
    v_pk_add_f32 v[82:83], v[82:83], v[100:101]
    v_pk_mul_f32 v[92:93], v[34:35], s[38:39] op_sel:[0,0] op_sel_hi:[1,0] neg_lo:[0,0] neg_hi:[0,0]
    v_pk_add_f32 v[56:57], v[44:45], v[44:45] op_sel:[0,1] op_sel_hi:[1,0] neg_lo:[0,0] neg_hi:[0,1]
    v_pk_mul_f32 v[76:77], v[70:71], s[38:39] op_sel:[0,1] op_sel_hi:[1,1] neg_lo:[0,0] neg_hi:[0,0]
    v_pk_add_f32 v[58:59], v[72:73], v[50:51] op_sel:[0,1] op_sel_hi:[1,0] neg_lo:[0,1]
    v_pk_fma_f32 v[92:93], v[34:35], s[38:39], v[92:93] op_sel:[1,1,0] op_sel_hi:[0,1,1] neg_lo:[1,1,0] neg_hi:[0,1,0]
    v_pk_fma_f32 v[44:45], v[56:57], s[36:37], v[96:97] neg_lo:[1,0,0] neg_hi:[1,0,0]
    v_pk_fma_f32 v[96:97], v[56:57], s[36:37], v[96:97]
    v_pk_fma_f32 v[76:77], v[70:71], s[38:39], v[76:77] op_sel:[1,0,0] op_sel_hi:[0,0,1] neg_lo:[1,1,0] neg_hi:[0,1,0]
    v_pk_add_f32 v[34:35], v[66:67], v[92:93] neg_lo:[0,1] neg_hi:[0,1]
    v_pk_add_f32 v[66:67], v[66:67], v[92:93]
    v_pk_add_f32 v[72:73], v[72:73], v[50:51] op_sel:[0,1] op_sel_hi:[1,0] neg_hi:[0,1]
    v_pk_add_f32 v[70:71], v[74:75], v[76:77] neg_lo:[0,1] neg_hi:[0,1]
    v_pk_add_f32 v[74:75], v[74:75], v[76:77]
    v_pk_mul_f32 v[62:63], v[68:69], s[38:39] op_sel:[0,1] op_sel_hi:[1,1] neg_lo:[0,1] neg_hi:[0,1]
    v_pk_add_f32 v[98:99], v[52:53], v[52:53] op_sel:[0,1] op_sel_hi:[1,0] neg_lo:[1,0] neg_hi:[1,1]
    v_pk_mul_f32 v[46:47], v[112:113], s[38:39] op_sel:[0,0] op_sel_hi:[1,0] neg_lo:[0,1] neg_hi:[0,1]
    ds_write_b64 v89, v[82:83] offset:0
    v_pk_fma_f32 v[62:63], v[68:69], s[38:39], v[62:63] op_sel:[1,0,0] op_sel_hi:[0,0,1] neg_lo:[1,1,0] neg_hi:[0,1,0]
    v_pk_fma_f32 v[52:53], v[98:99], s[36:37], v[40:41] neg_lo:[1,0,0] neg_hi:[1,0,0]
    v_pk_fma_f32 v[40:41], v[98:99], s[36:37], v[40:41]
    v_pk_fma_f32 v[46:47], v[112:113], s[38:39], v[46:47] op_sel:[1,1,0] op_sel_hi:[0,1,1] neg_lo:[1,1,0] neg_hi:[0,1,0]
    v_pk_add_f32 v[68:69], v[80:81], v[62:63] neg_lo:[0,1] neg_hi:[0,1]
    v_pk_add_f32 v[80:81], v[80:81], v[62:63]
    ds_write_b64 v89, v[66:67] offset:136
    v_pk_add_f32 v[112:113], v[86:87], v[46:47] neg_lo:[0,1] neg_hi:[0,1]
    v_pk_add_f32 v[86:87], v[86:87], v[46:47]
    ds_write_b64 v89, v[96:97] offset:272
    ds_write_b64 v89, v[74:75] offset:408
    ds_write_b64 v89, v[72:73] offset:544
    ds_write_b64 v89, v[80:81] offset:680
    ds_write_b64 v89, v[40:41] offset:816
    ds_write_b64 v89, v[86:87] offset:952
    ds_write_b64 v89, v[38:39] offset:1088
    ds_write_b64 v89, v[34:35] offset:1224
    ds_write_b64 v89, v[44:45] offset:1360
    ds_write_b64 v89, v[70:71] offset:1496
    ds_write_b64 v89, v[58:59] offset:1632
    ds_write_b64 v89, v[68:69] offset:1768
    ds_write_b64 v89, v[52:53] offset:1904
    ds_write_b64 v89, v[112:113] offset:2040
    ds_read_b64 v[88:89], v25 offset:0
    ds_read_b64 v[54:55], v25 offset:2176
    ds_read_b64 v[116:117], v25 offset:4352
    ds_read_b64 v[90:91], v25 offset:6528
    ds_read_b64 v[64:65], v25 offset:544
    ds_read_b64 v[42:43], v25 offset:2720
    ds_read_b64 v[120:121], v25 offset:4896
    ds_read_b64 v[102:103], v25 offset:7072
    ds_read_b64 v[104:105], v25 offset:1088
    ds_read_b64 v[94:95], v25 offset:3264
    ds_read_b64 v[32:33], v25 offset:5440
    ds_read_b64 v[78:79], v25 offset:7616
    ds_read_b64 v[60:61], v25 offset:1632
    ds_read_b64 v[30:31], v25 offset:3808
    ds_read_b64 v[108:109], v25 offset:5984
    ds_read_b64 v[110:111], v25 offset:8160
    v_and_b32 v27, 0xff, v1
    v_add_u32 v118, 64, v1
    v_add_u32 v119, 128, v1
    v_add_u32 v56, 192, v1
    v_cvt_f32_u32 v27, v27
    v_and_b32 v118, 0xff, v118
    v_and_b32 v119, 0xff, v119
    v_and_b32 v56, 0xff, v56
    v_mul_f32 v29, 0xba800000, v27
    v_cvt_f32_u32 v118, v118
    v_cvt_f32_u32 v119, v119
    v_cvt_f32_u32 v56, v56
    v_cos_f32 v28, v29
    v_sin_f32 v29, v29
    v_mul_f32 v107, 0xba800000, v118
    v_mul_f32 v85, 0xba800000, v119
    v_mul_f32 v77, 0xba800000, v56
    v_add_u32 v57, 0, v1
    v_pk_mul_f32 v[36:37], v[28:29], v[28:29] op_sel:[0,0] op_sel_hi:[1,0]
    v_cos_f32 v106, v107
    v_sin_f32 v107, v107
    v_cos_f32 v84, v85
    v_pk_fma_f32 v[36:37], v[28:29], v[28:29], v[36:37] op_sel:[1,1,0] op_sel_hi:[0,1,1] neg_lo:[1,0,0]
    v_sin_f32 v85, v85
    v_cos_f32 v76, v77
    v_pk_mul_f32 v[122:123], v[106:107], v[106:107] op_sel:[0,0] op_sel_hi:[1,0]
    v_pk_mul_f32 v[114:115], v[28:29], v[36:37] op_sel:[0,0] op_sel_hi:[1,0]
    v_sin_f32 v77, v77
    v_pk_mul_f32 v[100:101], v[84:85], v[84:85] op_sel:[0,0] op_sel_hi:[1,0]
    v_pk_fma_f32 v[122:123], v[106:107], v[106:107], v[122:123] op_sel:[1,1,0] op_sel_hi:[0,1,1] neg_lo:[1,0,0]
    v_pk_fma_f32 v[114:115], v[28:29], v[36:37], v[114:115] op_sel:[1,1,0] op_sel_hi:[0,1,1] neg_lo:[1,0,0]
    v_and_b32 v98, 0xff, v57
    v_pk_fma_f32 v[100:101], v[84:85], v[84:85], v[100:101] op_sel:[1,1,0] op_sel_hi:[0,1,1] neg_lo:[1,0,0]
    v_pk_mul_f32 v[48:49], v[106:107], v[122:123] op_sel:[0,0] op_sel_hi:[1,0]
    v_pk_mul_f32 v[50:51], v[76:77], v[76:77] op_sel:[0,0] op_sel_hi:[1,0]
    v_sub_u32 v57, v57, v98
    v_pk_mul_f32 v[92:93], v[84:85], v[100:101] op_sel:[0,0] op_sel_hi:[1,0]
    v_pk_fma_f32 v[48:49], v[106:107], v[122:123], v[48:49] op_sel:[1,1,0] op_sel_hi:[0,1,1] neg_lo:[1,0,0]
    v_pk_fma_f32 v[50:51], v[76:77], v[76:77], v[50:51] op_sel:[1,1,0] op_sel_hi:[0,1,1] neg_lo:[1,0,0]
    v_lshl_add_u32 v57, v57, 2, v98
    v_pk_fma_f32 v[92:93], v[84:85], v[100:101], v[92:93] op_sel:[1,1,0] op_sel_hi:[0,1,1] neg_lo:[1,0,0]
    v_add_u32 v99, 64, v1
    v_pk_mul_f32 v[62:63], v[76:77], v[50:51] op_sel:[0,0] op_sel_hi:[1,0]
    v_lshrrev_b32 v98, 4, v57
    v_add_u32 v47, 128, v1
    v_and_b32 v46, 0xff, v99
    v_pk_fma_f32 v[62:63], v[76:77], v[50:51], v[62:63] op_sel:[1,1,0] op_sel_hi:[0,1,1] neg_lo:[1,0,0]
    v_add_u32 v57, v57, v98
    v_and_b32 v82, 0xff, v47
    v_sub_u32 v99, v99, v46
    v_add_u32 v83, 192, v1
    v_lshl_add_u32 v57, v57, 3, v24
    v_sub_u32 v47, v47, v82
    v_lshl_add_u32 v99, v99, 2, v46
    v_and_b32 v66, 0xff, v83
    v_lshl_add_u32 v47, v47, 2, v82
    v_lshrrev_b32 v46, 4, v99
    v_sub_u32 v83, v83, v66
    v_lshrrev_b32 v82, 4, v47
    v_add_u32 v99, v99, v46
    v_lshl_add_u32 v83, v83, 2, v66
    v_add_u32 v47, v47, v82
    v_lshl_add_u32 v99, v99, 3, v24
    v_lshrrev_b32 v66, 4, v83
    v_lshl_add_u32 v47, v47, 3, v24
    v_add_u32 v83, v83, v66
    v_lshl_add_u32 v83, v83, 3, v24
    s_waitcnt lgkmcnt(0)
    v_pk_mul_f32 v[96:97], v[54:55], v[28:29] op_sel:[0,0] op_sel_hi:[1,0]
    v_pk_mul_f32 v[74:75], v[116:117], v[36:37] op_sel:[0,0] op_sel_hi:[1,0]
    v_pk_mul_f32 v[72:73], v[90:91], v[114:115] op_sel:[0,0] op_sel_hi:[1,0]
    v_pk_mul_f32 v[34:35], v[42:43], v[106:107] op_sel:[0,0] op_sel_hi:[1,0]
    v_pk_fma_f32 v[96:97], v[54:55], v[28:29], v[96:97] op_sel:[1,1,0] op_sel_hi:[0,1,1] neg_lo:[1,0,0]
    v_pk_fma_f32 v[74:75], v[116:117], v[36:37], v[74:75] op_sel:[1,1,0] op_sel_hi:[0,1,1] neg_lo:[1,0,0]
    v_pk_fma_f32 v[72:73], v[90:91], v[114:115], v[72:73] op_sel:[1,1,0] op_sel_hi:[0,1,1] neg_lo:[1,0,0]
    v_pk_fma_f32 v[34:35], v[42:43], v[106:107], v[34:35] op_sel:[1,1,0] op_sel_hi:[0,1,1] neg_lo:[1,0,0]
    v_pk_mul_f32 v[44:45], v[120:121], v[122:123] op_sel:[0,0] op_sel_hi:[1,0]
    v_pk_add_f32 v[80:81], v[88:89], v[74:75] neg_lo:[0,1] neg_hi:[0,1]
    v_pk_add_f32 v[88:89], v[88:89], v[74:75]
    v_pk_add_f32 v[40:41], v[96:97], v[72:73] neg_lo:[0,1] neg_hi:[0,1]
    v_pk_add_f32 v[96:97], v[96:97], v[72:73]
    v_pk_fma_f32 v[44:45], v[120:121], v[122:123], v[44:45] op_sel:[1,1,0] op_sel_hi:[0,1,1] neg_lo:[1,0,0]
    v_pk_mul_f32 v[70:71], v[102:103], v[48:49] op_sel:[0,0] op_sel_hi:[1,0]
    v_pk_add_f32 v[38:39], v[80:81], v[40:41] op_sel:[0,1] op_sel_hi:[1,0] neg_lo:[0,1]
    v_pk_add_f32 v[86:87], v[88:89], v[96:97] neg_lo:[0,1] neg_hi:[0,1]
    v_pk_add_f32 v[88:89], v[88:89], v[96:97]
    v_pk_add_f32 v[80:81], v[80:81], v[40:41] op_sel:[0,1] op_sel_hi:[1,0] neg_hi:[0,1]
    v_pk_fma_f32 v[70:71], v[102:103], v[48:49], v[70:71] op_sel:[1,1,0] op_sel_hi:[0,1,1] neg_lo:[1,0,0]
    v_pk_add_f32 v[58:59], v[64:65], v[44:45] neg_lo:[0,1] neg_hi:[0,1]
    v_pk_add_f32 v[64:65], v[64:65], v[44:45]
    v_pk_mul_f32 v[118:119], v[94:95], v[84:85] op_sel:[0,0] op_sel_hi:[1,0]
    v_pk_add_f32 v[68:69], v[34:35], v[70:71] neg_lo:[0,1] neg_hi:[0,1]
    v_pk_add_f32 v[34:35], v[34:35], v[70:71]
    v_pk_mul_f32 v[66:67], v[32:33], v[100:101] op_sel:[0,0] op_sel_hi:[1,0]
    v_pk_fma_f32 v[118:119], v[94:95], v[84:85], v[118:119] op_sel:[1,1,0] op_sel_hi:[0,1,1] neg_lo:[1,0,0]
    v_pk_add_f32 v[112:113], v[58:59], v[68:69] op_sel:[0,1] op_sel_hi:[1,0] neg_lo:[0,1]
    v_pk_add_f32 v[52:53], v[64:65], v[34:35] neg_lo:[0,1] neg_hi:[0,1]
    v_pk_add_f32 v[64:65], v[64:65], v[34:35]
    v_pk_add_f32 v[58:59], v[58:59], v[68:69] op_sel:[0,1] op_sel_hi:[1,0] neg_hi:[0,1]
    v_pk_fma_f32 v[66:67], v[32:33], v[100:101], v[66:67] op_sel:[1,1,0] op_sel_hi:[0,1,1] neg_lo:[1,0,0]
    v_pk_mul_f32 v[54:55], v[78:79], v[92:93] op_sel:[0,0] op_sel_hi:[1,0]
    v_pk_mul_f32 v[114:115], v[30:31], v[76:77] op_sel:[0,0] op_sel_hi:[1,0]
    v_pk_mul_f32 v[74:75], v[108:109], v[50:51] op_sel:[0,0] op_sel_hi:[1,0]
    v_pk_add_f32 v[28:29], v[104:105], v[66:67] neg_lo:[0,1] neg_hi:[0,1]
    v_pk_fma_f32 v[54:55], v[78:79], v[92:93], v[54:55] op_sel:[1,1,0] op_sel_hi:[0,1,1] neg_lo:[1,0,0]
    v_pk_add_f32 v[104:105], v[104:105], v[66:67]
    v_pk_fma_f32 v[114:115], v[30:31], v[76:77], v[114:115] op_sel:[1,1,0] op_sel_hi:[0,1,1] neg_lo:[1,0,0]
    v_pk_fma_f32 v[74:75], v[108:109], v[50:51], v[74:75] op_sel:[1,1,0] op_sel_hi:[0,1,1] neg_lo:[1,0,0]
    v_pk_add_f32 v[116:117], v[118:119], v[54:55] neg_lo:[0,1] neg_hi:[0,1]
    v_pk_add_f32 v[118:119], v[118:119], v[54:55]
    v_pk_mul_f32 v[72:73], v[110:111], v[62:63] op_sel:[0,0] op_sel_hi:[1,0]
    v_pk_add_f32 v[96:97], v[60:61], v[74:75] neg_lo:[0,1] neg_hi:[0,1]
    v_pk_add_f32 v[90:91], v[28:29], v[116:117] op_sel:[0,1] op_sel_hi:[1,0] neg_lo:[0,1]
    v_pk_add_f32 v[36:37], v[104:105], v[118:119] neg_lo:[0,1] neg_hi:[0,1]
    v_pk_add_f32 v[104:105], v[104:105], v[118:119]
    v_pk_add_f32 v[28:29], v[28:29], v[116:117] op_sel:[0,1] op_sel_hi:[1,0] neg_hi:[0,1]
    v_pk_fma_f32 v[72:73], v[110:111], v[62:63], v[72:73] op_sel:[1,1,0] op_sel_hi:[0,1,1] neg_lo:[1,0,0]
    v_pk_add_f32 v[60:61], v[60:61], v[74:75]
    ds_write_b64 v57, v[88:89] offset:0
    ds_write_b64 v57, v[80:81] offset:2176
    v_pk_add_f32 v[40:41], v[114:115], v[72:73] neg_lo:[0,1] neg_hi:[0,1]
    v_pk_add_f32 v[114:115], v[114:115], v[72:73]
    ds_write_b64 v57, v[86:87] offset:4352
    ds_write_b64 v57, v[38:39] offset:6528
    v_pk_add_f32 v[106:107], v[96:97], v[40:41] op_sel:[0,1] op_sel_hi:[1,0] neg_lo:[0,1]
    v_pk_add_f32 v[42:43], v[60:61], v[114:115] neg_lo:[0,1] neg_hi:[0,1]
    v_pk_add_f32 v[60:61], v[60:61], v[114:115]
    v_pk_add_f32 v[96:97], v[96:97], v[40:41] op_sel:[0,1] op_sel_hi:[1,0] neg_hi:[0,1]
    ds_write_b64 v99, v[64:65] offset:0
    ds_write_b64 v99, v[58:59] offset:2176
    ds_write_b64 v99, v[52:53] offset:4352
    ds_write_b64 v99, v[112:113] offset:6528
    ds_write_b64 v47, v[104:105] offset:0
    ds_write_b64 v47, v[28:29] offset:2176
    ds_write_b64 v47, v[36:37] offset:4352
    ds_write_b64 v47, v[90:91] offset:6528
    ds_write_b64 v83, v[60:61] offset:0
    ds_write_b64 v83, v[96:97] offset:2176
    ds_write_b64 v83, v[42:43] offset:4352
    ds_write_b64 v83, v[106:107] offset:6528
    s_waitcnt lgkmcnt(0)
    s_barrier
    v_and_b32 v27, 3, v0
    v_lshrrev_b32 v56, 2, v0
    v_mul_u32_u24 v27, 8704, v27
    v_lshrrev_b32 v82, 4, v56
    v_add_u32 v82, v82, v56
    v_lshl_add_u32 v98, v82, 3, v27
    v_mul_u32_u24 v46, 16640, v56
    v_and_b32 v82, 3, v0
    v_lshl_add_u32 v46, v82, 4, v46
    s_lshl_b32 s41, s3, 3
    v_add_u32 v82, 0, v56
    v_sub_u32 v82, 1024, v82
    v_and_b32 v82, 1023, v82
    v_lshrrev_b32 v120, 4, v82
    v_add_u32 v82, v82, v120
    v_lshl_add_u32 v120, v82, 3, v27
    ds_read_b64 v[122:123], v98 offset:0
    ds_read_b64 v[102:103], v120
    v_add_u32 v82, 64, v56
    v_sub_u32 v82, 1024, v82
    v_and_b32 v82, 1023, v82
    v_lshrrev_b32 v121, 4, v82
    v_add_u32 v82, v82, v121
    v_lshl_add_u32 v121, v82, 3, v27
    ds_read_b64 v[48:49], v98 offset:544
    ds_read_b64 v[44:45], v121
    v_add_u32 v82, 128, v56
    v_sub_u32 v82, 1024, v82
    v_and_b32 v82, 1023, v82
    v_lshrrev_b32 v70, 4, v82
    v_add_u32 v82, v82, v70
    v_lshl_add_u32 v70, v82, 3, v27
    ds_read_b64 v[34:35], v98 offset:1088
    ds_read_b64 v[68:69], v70
    v_add_u32 v82, 192, v56
    v_sub_u32 v82, 1024, v82
    v_and_b32 v82, 1023, v82
    v_lshrrev_b32 v71, 4, v82
    v_add_u32 v82, v82, v71
    v_lshl_add_u32 v71, v82, 3, v27
    ds_read_b64 v[94:95], v98 offset:1632
    ds_read_b64 v[84:85], v71
    v_add_u32 v82, 256, v56
    v_sub_u32 v82, 1024, v82
    v_and_b32 v82, 1023, v82
    v_lshrrev_b32 v32, 4, v82
    v_add_u32 v82, v82, v32
    v_lshl_add_u32 v32, v82, 3, v27
    ds_read_b64 v[100:101], v98 offset:2176
    ds_read_b64 v[78:79], v32
    v_add_u32 v82, 320, v56
    v_sub_u32 v82, 1024, v82
    v_and_b32 v82, 1023, v82
    v_lshrrev_b32 v33, 4, v82
    v_add_u32 v82, v82, v33
    v_lshl_add_u32 v33, v82, 3, v27
    ds_read_b64 v[92:93], v98 offset:2720
    ds_read_b64 v[66:67], v33
    v_add_u32 v82, 384, v56
    v_sub_u32 v82, 1024, v82
    v_and_b32 v82, 1023, v82
    v_lshrrev_b32 v54, 4, v82
    v_add_u32 v82, v82, v54
    v_lshl_add_u32 v54, v82, 3, v27
    ds_read_b64 v[118:119], v98 offset:3264
    ds_read_b64 v[116:117], v54
    v_add_u32 v82, 448, v56
    v_sub_u32 v82, 1024, v82
    v_and_b32 v82, 1023, v82
    v_lshrrev_b32 v55, 4, v82
    v_add_u32 v82, v82, v55
    v_lshl_add_u32 v55, v82, 3, v27
    ds_read_b64 v[30:31], v98 offset:3808
    ds_read_b64 v[76:77], v55
    s_waitcnt lgkmcnt(0)
    v_add_f32 v108, v122, v102
    v_sub_f32 v109, v123, v103
    v_add_f32 v110, v123, v103
    v_sub_f32 v111, v102, v122
    s_add_u32 s42, s41, 0
    buffer_store_dwordx4 v[108:111], v46, s[28:31], s42 offen sc1
    v_add_f32 v72, v48, v44
    v_sub_f32 v73, v49, v45
    v_add_f32 v74, v49, v45
    v_sub_f32 v75, v44, v48
    s_add_u32 s42, s41, 1064960
    buffer_store_dwordx4 v[72:75], v46, s[28:31], s42 offen sc1
    v_add_f32 v40, v34, v68
    v_sub_f32 v41, v35, v69
    v_add_f32 v42, v35, v69
    v_sub_f32 v43, v68, v34
    s_add_u32 s42, s41, 2129920
    buffer_store_dwordx4 v[40:43], v46, s[28:31], s42 offen sc1
    v_add_f32 v88, v94, v84
    v_sub_f32 v89, v95, v85
    v_add_f32 v90, v95, v85
    v_sub_f32 v91, v84, v94
    s_add_u32 s42, s41, 3194880
    buffer_store_dwordx4 v[88:91], v46, s[28:31], s42 offen sc1
    v_add_f32 v52, v100, v78
    v_sub_f32 v53, v101, v79
    v_add_f32 v54, v101, v79
    v_sub_f32 v55, v78, v100
    s_add_u32 s42, s41, 4259840
    buffer_store_dwordx4 v[52:55], v46, s[28:31], s42 offen sc1
    v_add_f32 v112, v92, v66
    v_sub_f32 v113, v93, v67
    v_add_f32 v114, v93, v67
    v_sub_f32 v115, v66, v92
    s_add_u32 s42, s41, 5324800
    buffer_store_dwordx4 v[112:115], v46, s[28:31], s42 offen sc1
    v_add_f32 v64, v118, v116
    v_sub_f32 v65, v119, v117
    v_add_f32 v66, v119, v117
    v_sub_f32 v67, v116, v118
    s_add_u32 s42, s41, 6389760
    buffer_store_dwordx4 v[64:67], v46, s[28:31], s42 offen sc1
    v_add_f32 v104, v30, v76
    v_sub_f32 v105, v31, v77
    v_add_f32 v106, v31, v77
    v_sub_f32 v107, v76, v30
    s_add_u32 s42, s41, 7454720
    buffer_store_dwordx4 v[104:107], v46, s[28:31], s42 offen sc1
    v_cmp_gt_u32 vcc, 4, v0
    s_and_saveexec_b64 s[44:45], vcc
    s_cbranch_execz k1_end
    v_add_u32 v82, 512, v56
    v_sub_u32 v82, 1024, v82
    v_and_b32 v82, 1023, v82
    v_lshrrev_b32 v50, 4, v82
    v_add_u32 v82, v82, v50
    v_lshl_add_u32 v50, v82, 3, v27
    ds_read_b64 v[62:63], v98 offset:4352
    ds_read_b64 v[80:81], v50
    s_waitcnt lgkmcnt(0)
    v_add_f32 v28, v62, v80
    v_sub_f32 v29, v63, v81
    v_add_f32 v30, v63, v81
    v_sub_f32 v31, v80, v62
    s_add_u32 s42, s41, 8519680
    buffer_store_dwordx4 v[28:31], v46, s[28:31], s42 offen sc1
    s_branch k1_end
k1_wt:
    s_mov_b32 s20, s6
    s_mov_b32 s21, s7
    s_mov_b32 s22, 0x201000
    s_mov_b32 s23, 0x00020000
    s_mov_b32 s24, s8
    s_mov_b32 s25, s9
    s_mov_b32 s26, 0x201000
    s_mov_b32 s27, 0x00020000
    s_add_u32 s32, s12, 0x1000000
    s_addc_u32 s33, s13, 0
    s_mov_b32 s34, 0x422100
    s_mov_b32 s35, 0x00020000
    s_sub_u32 s3, s2, 256
    s_lshl_b32 s3, s3, 3
    s_mul_i32 s40, s3, 1026
    v_lshlrev_b32 v4, 1, v0
    s_add_u32 s41, s40, 0
    buffer_load_ushort v8, v4, s[20:23], s41 offen
    buffer_load_ushort v16, v4, s[24:27], s41 offen
    s_add_u32 s41, s40, 1026
    buffer_load_ushort v9, v4, s[20:23], s41 offen
    buffer_load_ushort v17, v4, s[24:27], s41 offen
    s_add_u32 s41, s40, 2052
    buffer_load_ushort v10, v4, s[20:23], s41 offen
    buffer_load_ushort v18, v4, s[24:27], s41 offen
    s_add_u32 s41, s40, 3078
    buffer_load_ushort v11, v4, s[20:23], s41 offen
    buffer_load_ushort v19, v4, s[24:27], s41 offen
    s_add_u32 s41, s40, 4104
    buffer_load_ushort v12, v4, s[20:23], s41 offen
    buffer_load_ushort v20, v4, s[24:27], s41 offen
    s_add_u32 s41, s40, 5130
    buffer_load_ushort v13, v4, s[20:23], s41 offen
    buffer_load_ushort v21, v4, s[24:27], s41 offen
    s_add_u32 s41, s40, 6156
    buffer_load_ushort v14, v4, s[20:23], s41 offen
    buffer_load_ushort v22, v4, s[24:27], s41 offen
    s_add_u32 s41, s40, 7182
    buffer_load_ushort v15, v4, s[20:23], s41 offen
    buffer_load_ushort v23, v4, s[24:27], s41 offen
    s_add_u32 s41, s40, 512
    buffer_load_ushort v24, v4, s[20:23], s41 offen
    buffer_load_ushort v32, v4, s[24:27], s41 offen
    s_add_u32 s41, s40, 1538
    buffer_load_ushort v25, v4, s[20:23], s41 offen
    buffer_load_ushort v33, v4, s[24:27], s41 offen
    s_add_u32 s41, s40, 2564
    buffer_load_ushort v26, v4, s[20:23], s41 offen
    buffer_load_ushort v34, v4, s[24:27], s41 offen
    s_add_u32 s41, s40, 3590
    buffer_load_ushort v27, v4, s[20:23], s41 offen
    buffer_load_ushort v35, v4, s[24:27], s41 offen
    s_add_u32 s41, s40, 4616
    buffer_load_ushort v28, v4, s[20:23], s41 offen
    buffer_load_ushort v36, v4, s[24:27], s41 offen
    s_add_u32 s41, s40, 5642
    buffer_load_ushort v29, v4, s[20:23], s41 offen
    buffer_load_ushort v37, v4, s[24:27], s41 offen
    s_add_u32 s41, s40, 6668
    buffer_load_ushort v30, v4, s[20:23], s41 offen
    buffer_load_ushort v38, v4, s[24:27], s41 offen
    s_add_u32 s41, s40, 7694
    buffer_load_ushort v31, v4, s[20:23], s41 offen
    buffer_load_ushort v39, v4, s[24:27], s41 offen
    v_mul_u32_u24 v5, 8448, v0
    s_lshl_b32 s41, s3, 2
    s_add_u32 s42, s41, 2162688
    s_waitcnt vmcnt(0)
    v_lshl_or_b32 v40, v16, 16, v8
    v_lshl_or_b32 v41, v17, 16, v9
    v_lshl_or_b32 v42, v18, 16, v10
    v_lshl_or_b32 v43, v19, 16, v11
    v_lshl_or_b32 v44, v20, 16, v12
    v_lshl_or_b32 v45, v21, 16, v13
    v_lshl_or_b32 v46, v22, 16, v14
    v_lshl_or_b32 v47, v23, 16, v15
    v_lshl_or_b32 v48, v32, 16, v24
    v_lshl_or_b32 v49, v33, 16, v25
    v_lshl_or_b32 v50, v34, 16, v26
    v_lshl_or_b32 v51, v35, 16, v27
    v_lshl_or_b32 v52, v36, 16, v28
    v_lshl_or_b32 v53, v37, 16, v29
    v_lshl_or_b32 v54, v38, 16, v30
    v_lshl_or_b32 v55, v39, 16, v31
    buffer_store_dwordx4 v[40:43], v5, s[32:35], s41 offen sc1
    buffer_store_dwordx4 v[44:47], v5, s[32:35], s41 offen offset:16 sc1
    buffer_store_dwordx4 v[48:51], v5, s[32:35], s42 offen sc1
    buffer_store_dwordx4 v[52:55], v5, s[32:35], s42 offen offset:16 sc1
    v_cmp_gt_u32 vcc, 8, v0
    s_and_saveexec_b64 s[44:45], vcc
    s_cbranch_execz k1_end
    v_mul_u32_u24 v4, 1026, v0
    v_add_u32 v4, 1024, v4
    buffer_load_ushort v8, v4, s[20:23], s40 offen
    buffer_load_ushort v9, v4, s[24:27], s40 offen
    v_lshlrev_b32 v4, 2, v0
    v_add_u32 v4, 0x420000, v4
    s_waitcnt vmcnt(0)
    v_lshl_or_b32 v8, v9, 16, v8
    buffer_store_dword v8, v4, s[32:35], s41 offen sc1
    s_branch k1_end
k1_end:
    s_endpgm
.p2align 8
.globl k2_kernel
.type k2_kernel,@function
k2_kernel:
    s_cmp_ge_u32 s2, 961
    s_cbranch_scc1 k2_end
    s_load_dwordx2 s[10:11], s[0:1], 48
    s_load_dwordx2 s[12:13], s[0:1], 72
    s_waitcnt lgkmcnt(0)
    s_cmp_ge_u32 s2, 513
    s_cbranch_scc1 k2_tr
    s_mov_b32 s28, s12
    s_mov_b32 s29, s13
    s_mov_b32 s30, 0x824100
    s_mov_b32 s31, 0x00020000
    s_add_u32 s32, s12, 0x1000000
    s_addc_u32 s33, s13, 0
    s_mov_b32 s34, 0x422100
    s_mov_b32 s35, 0x00020000
    s_mul_i32 s3, s2, 16640
    s_mul_i32 s4, s2, 8448
    v_lshlrev_b32 v10, 3, v0
    s_add_u32 s5, s3, 0
    buffer_load_dwordx2 v[12:13], v10, s[28:31], s5 offen
    s_add_u32 s5, s3, 1024
    buffer_load_dwordx2 v[14:15], v10, s[28:31], s5 offen
    s_add_u32 s5, s3, 2048
    buffer_load_dwordx2 v[16:17], v10, s[28:31], s5 offen
    s_add_u32 s5, s3, 3072
    buffer_load_dwordx2 v[18:19], v10, s[28:31], s5 offen
    s_add_u32 s5, s3, 4096
    buffer_load_dwordx2 v[20:21], v10, s[28:31], s5 offen
    s_add_u32 s5, s3, 5120
    buffer_load_dwordx2 v[22:23], v10, s[28:31], s5 offen
    s_add_u32 s5, s3, 6144
    buffer_load_dwordx2 v[24:25], v10, s[28:31], s5 offen
    s_add_u32 s5, s3, 7168
    buffer_load_dwordx2 v[26:27], v10, s[28:31], s5 offen
    s_add_u32 s5, s3, 8192
    buffer_load_dwordx2 v[28:29], v10, s[28:31], s5 offen
    s_add_u32 s5, s3, 9216
    buffer_load_dwordx2 v[30:31], v10, s[28:31], s5 offen
    s_add_u32 s5, s3, 10240
    buffer_load_dwordx2 v[32:33], v10, s[28:31], s5 offen
    s_add_u32 s5, s3, 11264
    buffer_load_dwordx2 v[34:35], v10, s[28:31], s5 offen
    s_add_u32 s5, s3, 12288
    buffer_load_dwordx2 v[36:37], v10, s[28:31], s5 offen
    s_add_u32 s5, s3, 13312
    buffer_load_dwordx2 v[38:39], v10, s[28:31], s5 offen
    s_add_u32 s5, s3, 14336
    buffer_load_dwordx2 v[40:41], v10, s[28:31], s5 offen
    s_add_u32 s5, s3, 15360
    buffer_load_dwordx2 v[42:43], v10, s[28:31], s5 offen
    v_lshlrev_b32 v11, 2, v0
    s_add_u32 s5, s4, 0
    buffer_load_dword v44, v11, s[32:35], s5 offen
    s_add_u32 s5, s4, 1024
    buffer_load_dword v45, v11, s[32:35], s5 offen
    s_add_u32 s5, s4, 2048
    buffer_load_dword v46, v11, s[32:35], s5 offen
    s_add_u32 s5, s4, 3072
    buffer_load_dword v47, v11, s[32:35], s5 offen
    s_add_u32 s5, s4, 4096
    buffer_load_dword v48, v11, s[32:35], s5 offen
    s_add_u32 s5, s4, 5120
    buffer_load_dword v49, v11, s[32:35], s5 offen
    s_add_u32 s5, s4, 6144
    buffer_load_dword v50, v11, s[32:35], s5 offen
    s_add_u32 s5, s4, 7168
    buffer_load_dword v51, v11, s[32:35], s5 offen
    s_add_u32 s5, s4, 512
    buffer_load_dword v52, v11, s[32:35], s5 offen
    s_add_u32 s5, s4, 1536
    buffer_load_dword v53, v11, s[32:35], s5 offen
    s_add_u32 s5, s4, 2560
    buffer_load_dword v54, v11, s[32:35], s5 offen
    s_add_u32 s5, s4, 3584
    buffer_load_dword v55, v11, s[32:35], s5 offen
    s_add_u32 s5, s4, 4608
    buffer_load_dword v56, v11, s[32:35], s5 offen
    s_add_u32 s5, s4, 5632
    buffer_load_dword v57, v11, s[32:35], s5 offen
    s_add_u32 s5, s4, 6656
    buffer_load_dword v58, v11, s[32:35], s5 offen
    s_add_u32 s5, s4, 7680
    buffer_load_dword v59, v11, s[32:35], s5 offen
    s_mov_b32 s36, 0x3f3504f3
    s_mov_b32 s37, 0x3f3504f3
    s_mov_b32 s38, 0x3f6c835e
    s_mov_b32 s39, 0x3ec3ef15
    v_mov_b32 v8, 0
    v_lshrrev_b32 v9, 4, v0
    v_add_u32 v9, v9, v0
    v_lshlrev_b32 v9, 3, v9
    s_waitcnt vmcnt(16)
    v_add_u32 v60, 0, v0
    v_lshlrev_b32 v60, 4, v60
    v_lshrrev_b32 v61, 4, v60
    v_add_u32 v60, v60, v61
    v_lshl_add_u32 v60, v60, 3, v8
    s_nop 0
    v_pk_add_f32 v[62:63], v[12:13], v[28:29] neg_lo:[0,1] neg_hi:[0,1]
    v_pk_add_f32 v[12:13], v[12:13], v[28:29]
    v_pk_add_f32 v[64:65], v[20:21], v[36:37] neg_lo:[0,1] neg_hi:[0,1]
    v_pk_add_f32 v[20:21], v[20:21], v[36:37]
    v_pk_add_f32 v[70:71], v[16:17], v[32:33] neg_lo:[0,1] neg_hi:[0,1]
    v_pk_add_f32 v[16:17], v[16:17], v[32:33]
    v_pk_add_f32 v[68:69], v[62:63], v[64:65] op_sel:[0,1] op_sel_hi:[1,0] neg_lo:[0,1]
    v_pk_add_f32 v[66:67], v[12:13], v[20:21] neg_lo:[0,1] neg_hi:[0,1]
    v_pk_add_f32 v[12:13], v[12:13], v[20:21]
    v_pk_add_f32 v[62:63], v[62:63], v[64:65] op_sel:[0,1] op_sel_hi:[1,0] neg_hi:[0,1]
    v_pk_add_f32 v[72:73], v[24:25], v[40:41] neg_lo:[0,1] neg_hi:[0,1]
    v_pk_add_f32 v[24:25], v[24:25], v[40:41]
    v_pk_add_f32 v[86:87], v[14:15], v[30:31] neg_lo:[0,1] neg_hi:[0,1]
    v_pk_add_f32 v[14:15], v[14:15], v[30:31]
    v_pk_add_f32 v[76:77], v[70:71], v[72:73] op_sel:[0,1] op_sel_hi:[1,0] neg_lo:[0,1]
    v_pk_add_f32 v[74:75], v[16:17], v[24:25] neg_lo:[0,1] neg_hi:[0,1]
    v_pk_add_f32 v[16:17], v[16:17], v[24:25]
    v_pk_add_f32 v[70:71], v[70:71], v[72:73] op_sel:[0,1] op_sel_hi:[1,0] neg_hi:[0,1]
    v_pk_add_f32 v[84:85], v[76:77], v[76:77] op_sel:[0,1] op_sel_hi:[1,0] neg_lo:[1,0] neg_hi:[1,1]
    v_pk_add_f32 v[82:83], v[66:67], v[74:75] op_sel:[0,1] op_sel_hi:[1,0] neg_lo:[0,1]
    v_pk_add_f32 v[78:79], v[12:13], v[16:17] neg_lo:[0,1] neg_hi:[0,1]
    v_pk_add_f32 v[12:13], v[12:13], v[16:17]
    v_pk_add_f32 v[80:81], v[70:71], v[70:71] op_sel:[0,1] op_sel_hi:[1,0] neg_lo:[0,0] neg_hi:[0,1]
    v_pk_add_f32 v[66:67], v[66:67], v[74:75] op_sel:[0,1] op_sel_hi:[1,0] neg_hi:[0,1]
    v_pk_fma_f32 v[76:77], v[84:85], s[36:37], v[68:69] neg_lo:[1,0,0] neg_hi:[1,0,0]
    v_pk_fma_f32 v[68:69], v[84:85], s[36:37], v[68:69]
    v_pk_fma_f32 v[70:71], v[80:81], s[36:37], v[62:63] neg_lo:[1,0,0] neg_hi:[1,0,0]
    v_pk_fma_f32 v[62:63], v[80:81], s[36:37], v[62:63]
    v_pk_add_f32 v[88:89], v[22:23], v[38:39] neg_lo:[0,1] neg_hi:[0,1]
    v_pk_add_f32 v[22:23], v[22:23], v[38:39]
    v_pk_add_f32 v[94:95], v[18:19], v[34:35] neg_lo:[0,1] neg_hi:[0,1]
    v_pk_add_f32 v[18:19], v[18:19], v[34:35]
    v_pk_add_f32 v[92:93], v[86:87], v[88:89] op_sel:[0,1] op_sel_hi:[1,0] neg_lo:[0,1]
    v_pk_add_f32 v[90:91], v[14:15], v[22:23] neg_lo:[0,1] neg_hi:[0,1]
    v_pk_add_f32 v[14:15], v[14:15], v[22:23]
    v_pk_add_f32 v[86:87], v[86:87], v[88:89] op_sel:[0,1] op_sel_hi:[1,0] neg_hi:[0,1]
    v_pk_add_f32 v[96:97], v[26:27], v[42:43] neg_lo:[0,1] neg_hi:[0,1]
    v_pk_add_f32 v[26:27], v[26:27], v[42:43]
    v_pk_add_f32 v[100:101], v[94:95], v[96:97] op_sel:[0,1] op_sel_hi:[1,0] neg_lo:[0,1]
    v_pk_add_f32 v[94:95], v[94:95], v[96:97] op_sel:[0,1] op_sel_hi:[1,0] neg_hi:[0,1]
    v_pk_add_f32 v[98:99], v[18:19], v[26:27] neg_lo:[0,1] neg_hi:[0,1]
    v_pk_add_f32 v[18:19], v[18:19], v[26:27]
    v_pk_add_f32 v[108:109], v[100:101], v[100:101] op_sel:[0,1] op_sel_hi:[1,0] neg_lo:[1,0] neg_hi:[1,1]
    v_pk_add_f32 v[104:105], v[94:95], v[94:95] op_sel:[0,1] op_sel_hi:[1,0] neg_lo:[0,0] neg_hi:[0,1]
    v_pk_add_f32 v[106:107], v[90:91], v[98:99] op_sel:[0,1] op_sel_hi:[1,0] neg_lo:[0,1]
    v_pk_add_f32 v[102:103], v[14:15], v[18:19] neg_lo:[0,1] neg_hi:[0,1]
    v_pk_add_f32 v[14:15], v[14:15], v[18:19]
    v_pk_fma_f32 v[94:95], v[104:105], s[36:37], v[86:87] neg_lo:[1,0,0] neg_hi:[1,0,0]
    v_pk_fma_f32 v[86:87], v[104:105], s[36:37], v[86:87]
    v_pk_add_f32 v[90:91], v[90:91], v[98:99] op_sel:[0,1] op_sel_hi:[1,0] neg_hi:[0,1]
    v_pk_fma_f32 v[100:101], v[108:109], s[36:37], v[92:93] neg_lo:[1,0,0] neg_hi:[1,0,0]
    v_pk_fma_f32 v[92:93], v[108:109], s[36:37], v[92:93]
    v_pk_add_f32 v[110:111], v[12:13], v[14:15] neg_lo:[0,1] neg_hi:[0,1]
    v_pk_add_f32 v[12:13], v[12:13], v[14:15]
    v_pk_mul_f32 v[112:113], v[86:87], s[38:39] op_sel:[0,0] op_sel_hi:[1,0] neg_lo:[0,0] neg_hi:[0,0]
    v_pk_add_f32 v[114:115], v[90:91], v[90:91] op_sel:[0,1] op_sel_hi:[1,0] neg_lo:[0,0] neg_hi:[0,1]
    v_pk_mul_f32 v[116:117], v[92:93], s[38:39] op_sel:[0,1] op_sel_hi:[1,1] neg_lo:[0,0] neg_hi:[0,0]
    v_pk_add_f32 v[118:119], v[78:79], v[102:103] op_sel:[0,1] op_sel_hi:[1,0] neg_lo:[0,1]
    v_pk_fma_f32 v[112:113], v[86:87], s[38:39], v[112:113] op_sel:[1,1,0] op_sel_hi:[0,1,1] neg_lo:[1,1,0] neg_hi:[0,1,0]
    v_pk_fma_f32 v[90:91], v[114:115], s[36:37], v[66:67] neg_lo:[1,0,0] neg_hi:[1,0,0]
    v_pk_fma_f32 v[66:67], v[114:115], s[36:37], v[66:67]
    v_pk_fma_f32 v[116:117], v[92:93], s[38:39], v[116:117] op_sel:[1,0,0] op_sel_hi:[0,0,1] neg_lo:[1,1,0] neg_hi:[0,1,0]
    v_pk_add_f32 v[86:87], v[62:63], v[112:113] neg_lo:[0,1] neg_hi:[0,1]
    v_pk_add_f32 v[62:63], v[62:63], v[112:113]
    v_pk_add_f32 v[78:79], v[78:79], v[102:103] op_sel:[0,1] op_sel_hi:[1,0] neg_hi:[0,1]
    v_pk_add_f32 v[92:93], v[68:69], v[116:117] neg_lo:[0,1] neg_hi:[0,1]
    v_pk_add_f32 v[68:69], v[68:69], v[116:117]
    v_pk_mul_f32 v[120:121], v[94:95], s[38:39] op_sel:[0,1] op_sel_hi:[1,1] neg_lo:[0,1] neg_hi:[0,1]
    v_pk_add_f32 v[122:123], v[106:107], v[106:107] op_sel:[0,1] op_sel_hi:[1,0] neg_lo:[1,0] neg_hi:[1,1]
    v_pk_mul_f32 v[28:29], v[100:101], s[38:39] op_sel:[0,0] op_sel_hi:[1,0] neg_lo:[0,1] neg_hi:[0,1]
    ds_write_b64 v60, v[12:13] offset:0
    v_pk_fma_f32 v[120:121], v[94:95], s[38:39], v[120:121] op_sel:[1,0,0] op_sel_hi:[0,0,1] neg_lo:[1,1,0] neg_hi:[0,1,0]
    v_pk_fma_f32 v[106:107], v[122:123], s[36:37], v[82:83] neg_lo:[1,0,0] neg_hi:[1,0,0]
    v_pk_fma_f32 v[82:83], v[122:123], s[36:37], v[82:83]
    v_pk_fma_f32 v[28:29], v[100:101], s[38:39], v[28:29] op_sel:[1,1,0] op_sel_hi:[0,1,1] neg_lo:[1,1,0] neg_hi:[0,1,0]
    v_pk_add_f32 v[94:95], v[70:71], v[120:121] neg_lo:[0,1] neg_hi:[0,1]
    v_pk_add_f32 v[70:71], v[70:71], v[120:121]
    ds_write_b64 v60, v[62:63] offset:8
    v_pk_add_f32 v[100:101], v[76:77], v[28:29] neg_lo:[0,1] neg_hi:[0,1]
    v_pk_add_f32 v[76:77], v[76:77], v[28:29]
    ds_write_b64 v60, v[66:67] offset:16
    ds_write_b64 v60, v[68:69] offset:24
    ds_write_b64 v60, v[78:79] offset:32
    ds_write_b64 v60, v[70:71] offset:40
    ds_write_b64 v60, v[82:83] offset:48
    ds_write_b64 v60, v[76:77] offset:56
    ds_write_b64 v60, v[110:111] offset:64
    ds_write_b64 v60, v[86:87] offset:72
    ds_write_b64 v60, v[90:91] offset:80
    ds_write_b64 v60, v[92:93] offset:88
    ds_write_b64 v60, v[118:119] offset:96
    ds_write_b64 v60, v[94:95] offset:104
    ds_write_b64 v60, v[106:107] offset:112
    ds_write_b64 v60, v[100:101] offset:120
    s_waitcnt lgkmcnt(0)
    s_barrier
    ds_read_b64 v[36:37], v9 offset:0
    ds_read_b64 v[20:21], v9 offset:1088
    ds_read_b64 v[64:65], v9 offset:2176
    ds_read_b64 v[32:33], v9 offset:3264
    ds_read_b64 v[40:41], v9 offset:4352
    ds_read_b64 v[24:25], v9 offset:5440
    ds_read_b64 v[72:73], v9 offset:6528
    ds_read_b64 v[16:17], v9 offset:7616
    ds_read_b64 v[80:81], v9 offset:8704
    ds_read_b64 v[74:75], v9 offset:9792
    ds_read_b64 v[84:85], v9 offset:10880
    ds_read_b64 v[30:31], v9 offset:11968
    ds_read_b64 v[38:39], v9 offset:13056
    ds_read_b64 v[22:23], v9 offset:14144
    ds_read_b64 v[88:89], v9 offset:15232
    ds_read_b64 v[34:35], v9 offset:16320
    v_and_b32 v11, 0xf, v0
    v_add_u32 v61, 0, v0
    v_cvt_f32_u32 v11, v11
    v_and_b32 v12, 0xf, v61
    v_mul_f32 v43, 0xbb800000, v11
    v_sub_u32 v61, v61, v12
    v_cos_f32 v42, v43
    v_sin_f32 v43, v43
    v_lshl_add_u32 v61, v61, 4, v12
    v_pk_mul_f32 v[26:27], v[42:43], v[42:43] op_sel:[0,0] op_sel_hi:[1,0]
    v_lshrrev_b32 v12, 4, v61
    v_pk_fma_f32 v[26:27], v[42:43], v[42:43], v[26:27] op_sel:[1,1,0] op_sel_hi:[0,1,1] neg_lo:[1,0,0]
    v_add_u32 v61, v61, v12
    v_pk_mul_f32 v[96:97], v[42:43], v[26:27] op_sel:[0,0] op_sel_hi:[1,0]
    v_pk_mul_f32 v[18:19], v[26:27], v[26:27] op_sel:[0,0] op_sel_hi:[1,0]
    v_lshl_add_u32 v61, v61, 3, v8
    v_pk_fma_f32 v[96:97], v[42:43], v[26:27], v[96:97] op_sel:[1,1,0] op_sel_hi:[0,1,1] neg_lo:[1,0,0]
    v_pk_fma_f32 v[18:19], v[26:27], v[26:27], v[18:19] op_sel:[1,1,0] op_sel_hi:[0,1,1] neg_lo:[1,0,0]
    v_pk_mul_f32 v[104:105], v[26:27], v[96:97] op_sel:[0,0] op_sel_hi:[1,0]
    v_pk_mul_f32 v[98:99], v[96:97], v[96:97] op_sel:[0,0] op_sel_hi:[1,0]
    v_pk_mul_f32 v[108:109], v[96:97], v[18:19] op_sel:[0,0] op_sel_hi:[1,0]
    v_pk_mul_f32 v[14:15], v[18:19], v[18:19] op_sel:[0,0] op_sel_hi:[1,0]
    v_pk_fma_f32 v[104:105], v[26:27], v[96:97], v[104:105] op_sel:[1,1,0] op_sel_hi:[0,1,1] neg_lo:[1,0,0]
    v_pk_fma_f32 v[98:99], v[96:97], v[96:97], v[98:99] op_sel:[1,1,0] op_sel_hi:[0,1,1] neg_lo:[1,0,0]
    v_pk_fma_f32 v[108:109], v[96:97], v[18:19], v[108:109] op_sel:[1,1,0] op_sel_hi:[0,1,1] neg_lo:[1,0,0]
    v_pk_fma_f32 v[14:15], v[18:19], v[18:19], v[14:15] op_sel:[1,1,0] op_sel_hi:[0,1,1] neg_lo:[1,0,0]
    v_pk_mul_f32 v[112:113], v[18:19], v[104:105] op_sel:[0,0] op_sel_hi:[1,0]
    v_pk_mul_f32 v[114:115], v[104:105], v[104:105] op_sel:[0,0] op_sel_hi:[1,0]
    v_pk_mul_f32 v[116:117], v[104:105], v[98:99] op_sel:[0,0] op_sel_hi:[1,0]
    v_pk_mul_f32 v[102:103], v[98:99], v[98:99] op_sel:[0,0] op_sel_hi:[1,0]
    v_pk_fma_f32 v[112:113], v[18:19], v[104:105], v[112:113] op_sel:[1,1,0] op_sel_hi:[0,1,1] neg_lo:[1,0,0]
    v_pk_fma_f32 v[114:115], v[104:105], v[104:105], v[114:115] op_sel:[1,1,0] op_sel_hi:[0,1,1] neg_lo:[1,0,0]
    v_pk_fma_f32 v[116:117], v[104:105], v[98:99], v[116:117] op_sel:[1,1,0] op_sel_hi:[0,1,1] neg_lo:[1,0,0]
    v_pk_fma_f32 v[102:103], v[98:99], v[98:99], v[102:103] op_sel:[1,1,0] op_sel_hi:[0,1,1] neg_lo:[1,0,0]
    v_pk_mul_f32 v[120:121], v[98:99], v[108:109] op_sel:[0,0] op_sel_hi:[1,0]
    v_pk_mul_f32 v[122:123], v[108:109], v[108:109] op_sel:[0,0] op_sel_hi:[1,0]
    v_pk_mul_f32 v[28:29], v[108:109], v[14:15] op_sel:[0,0] op_sel_hi:[1,0]
    v_pk_fma_f32 v[120:121], v[98:99], v[108:109], v[120:121] op_sel:[1,1,0] op_sel_hi:[0,1,1] neg_lo:[1,0,0]
    v_pk_fma_f32 v[122:123], v[108:109], v[108:109], v[122:123] op_sel:[1,1,0] op_sel_hi:[0,1,1] neg_lo:[1,0,0]
    v_pk_fma_f32 v[28:29], v[108:109], v[14:15], v[28:29] op_sel:[1,1,0] op_sel_hi:[0,1,1] neg_lo:[1,0,0]
    s_waitcnt lgkmcnt(0)
    v_pk_mul_f32 v[62:63], v[20:21], v[42:43] op_sel:[0,0] op_sel_hi:[1,0]
    v_pk_mul_f32 v[66:67], v[64:65], v[26:27] op_sel:[0,0] op_sel_hi:[1,0]
    v_pk_mul_f32 v[68:69], v[32:33], v[96:97] op_sel:[0,0] op_sel_hi:[1,0]
    v_pk_mul_f32 v[78:79], v[40:41], v[18:19] op_sel:[0,0] op_sel_hi:[1,0]
    v_pk_fma_f32 v[62:63], v[20:21], v[42:43], v[62:63] op_sel:[1,1,0] op_sel_hi:[0,1,1] neg_lo:[1,0,0]
    v_pk_fma_f32 v[66:67], v[64:65], v[26:27], v[66:67] op_sel:[1,1,0] op_sel_hi:[0,1,1] neg_lo:[1,0,0]
    v_pk_fma_f32 v[68:69], v[32:33], v[96:97], v[68:69] op_sel:[1,1,0] op_sel_hi:[0,1,1] neg_lo:[1,0,0]
    v_pk_fma_f32 v[78:79], v[40:41], v[18:19], v[78:79] op_sel:[1,1,0] op_sel_hi:[0,1,1] neg_lo:[1,0,0]
    v_pk_mul_f32 v[70:71], v[24:25], v[104:105] op_sel:[0,0] op_sel_hi:[1,0]
    v_pk_mul_f32 v[82:83], v[72:73], v[98:99] op_sel:[0,0] op_sel_hi:[1,0]
    v_pk_mul_f32 v[76:77], v[16:17], v[108:109] op_sel:[0,0] op_sel_hi:[1,0]
    v_pk_mul_f32 v[110:111], v[80:81], v[14:15] op_sel:[0,0] op_sel_hi:[1,0]
    v_pk_fma_f32 v[70:71], v[24:25], v[104:105], v[70:71] op_sel:[1,1,0] op_sel_hi:[0,1,1] neg_lo:[1,0,0]
    v_pk_fma_f32 v[82:83], v[72:73], v[98:99], v[82:83] op_sel:[1,1,0] op_sel_hi:[0,1,1] neg_lo:[1,0,0]
    v_pk_fma_f32 v[76:77], v[16:17], v[108:109], v[76:77] op_sel:[1,1,0] op_sel_hi:[0,1,1] neg_lo:[1,0,0]
    v_pk_fma_f32 v[110:111], v[80:81], v[14:15], v[110:111] op_sel:[1,1,0] op_sel_hi:[0,1,1] neg_lo:[1,0,0]
    v_pk_mul_f32 v[86:87], v[74:75], v[112:113] op_sel:[0,0] op_sel_hi:[1,0]
    v_pk_mul_f32 v[90:91], v[84:85], v[114:115] op_sel:[0,0] op_sel_hi:[1,0]
    v_pk_mul_f32 v[92:93], v[30:31], v[116:117] op_sel:[0,0] op_sel_hi:[1,0]
    v_pk_mul_f32 v[118:119], v[38:39], v[102:103] op_sel:[0,0] op_sel_hi:[1,0]
    v_pk_fma_f32 v[86:87], v[74:75], v[112:113], v[86:87] op_sel:[1,1,0] op_sel_hi:[0,1,1] neg_lo:[1,0,0]
    v_pk_fma_f32 v[90:91], v[84:85], v[114:115], v[90:91] op_sel:[1,1,0] op_sel_hi:[0,1,1] neg_lo:[1,0,0]
    v_pk_fma_f32 v[92:93], v[30:31], v[116:117], v[92:93] op_sel:[1,1,0] op_sel_hi:[0,1,1] neg_lo:[1,0,0]
    v_pk_fma_f32 v[118:119], v[38:39], v[102:103], v[118:119] op_sel:[1,1,0] op_sel_hi:[0,1,1] neg_lo:[1,0,0]
    v_pk_mul_f32 v[94:95], v[22:23], v[120:121] op_sel:[0,0] op_sel_hi:[1,0]
    v_pk_mul_f32 v[106:107], v[88:89], v[122:123] op_sel:[0,0] op_sel_hi:[1,0]
    v_pk_mul_f32 v[100:101], v[34:35], v[28:29] op_sel:[0,0] op_sel_hi:[1,0]
    v_pk_add_f32 v[12:13], v[36:37], v[110:111] neg_lo:[0,1] neg_hi:[0,1]
    v_pk_fma_f32 v[94:95], v[22:23], v[120:121], v[94:95] op_sel:[1,1,0] op_sel_hi:[0,1,1] neg_lo:[1,0,0]
    v_pk_fma_f32 v[106:107], v[88:89], v[122:123], v[106:107] op_sel:[1,1,0] op_sel_hi:[0,1,1] neg_lo:[1,0,0]
    v_pk_fma_f32 v[100:101], v[34:35], v[28:29], v[100:101] op_sel:[1,1,0] op_sel_hi:[0,1,1] neg_lo:[1,0,0]
    v_pk_add_f32 v[36:37], v[36:37], v[110:111]
    v_pk_add_f32 v[20:21], v[78:79], v[118:119] neg_lo:[0,1] neg_hi:[0,1]
    v_pk_add_f32 v[78:79], v[78:79], v[118:119]
    v_pk_add_f32 v[26:27], v[66:67], v[90:91] neg_lo:[0,1] neg_hi:[0,1]
    v_pk_add_f32 v[66:67], v[66:67], v[90:91]
    v_pk_add_f32 v[64:65], v[12:13], v[20:21] op_sel:[0,1] op_sel_hi:[1,0] neg_lo:[0,1]
    v_pk_add_f32 v[42:43], v[36:37], v[78:79] neg_lo:[0,1] neg_hi:[0,1]
    v_pk_add_f32 v[36:37], v[36:37], v[78:79]
    v_pk_add_f32 v[12:13], v[12:13], v[20:21] op_sel:[0,1] op_sel_hi:[1,0] neg_hi:[0,1]
    v_pk_add_f32 v[32:33], v[82:83], v[106:107] neg_lo:[0,1] neg_hi:[0,1]
    v_pk_add_f32 v[82:83], v[82:83], v[106:107]
    v_pk_add_f32 v[98:99], v[62:63], v[86:87] neg_lo:[0,1] neg_hi:[0,1]
    v_pk_add_f32 v[62:63], v[62:63], v[86:87]
    v_pk_add_f32 v[40:41], v[26:27], v[32:33] op_sel:[0,1] op_sel_hi:[1,0] neg_lo:[0,1]
    v_pk_add_f32 v[96:97], v[66:67], v[82:83] neg_lo:[0,1] neg_hi:[0,1]
    v_pk_add_f32 v[66:67], v[66:67], v[82:83]
    v_pk_add_f32 v[26:27], v[26:27], v[32:33] op_sel:[0,1] op_sel_hi:[1,0] neg_hi:[0,1]
    v_pk_add_f32 v[72:73], v[40:41], v[40:41] op_sel:[0,1] op_sel_hi:[1,0] neg_lo:[1,0] neg_hi:[1,1]
    v_pk_add_f32 v[104:105], v[42:43], v[96:97] op_sel:[0,1] op_sel_hi:[1,0] neg_lo:[0,1]
    v_pk_add_f32 v[18:19], v[36:37], v[66:67] neg_lo:[0,1] neg_hi:[0,1]
    v_pk_add_f32 v[36:37], v[36:37], v[66:67]
    v_pk_add_f32 v[24:25], v[26:27], v[26:27] op_sel:[0,1] op_sel_hi:[1,0] neg_lo:[0,0] neg_hi:[0,1]
    v_pk_add_f32 v[42:43], v[42:43], v[96:97] op_sel:[0,1] op_sel_hi:[1,0] neg_hi:[0,1]
    v_pk_fma_f32 v[40:41], v[72:73], s[36:37], v[64:65] neg_lo:[1,0,0] neg_hi:[1,0,0]
    v_pk_fma_f32 v[64:65], v[72:73], s[36:37], v[64:65]
    v_pk_fma_f32 v[26:27], v[24:25], s[36:37], v[12:13] neg_lo:[1,0,0] neg_hi:[1,0,0]
    v_pk_fma_f32 v[12:13], v[24:25], s[36:37], v[12:13]
    v_pk_add_f32 v[16:17], v[70:71], v[94:95] neg_lo:[0,1] neg_hi:[0,1]
    v_pk_add_f32 v[70:71], v[70:71], v[94:95]
    v_pk_add_f32 v[14:15], v[68:69], v[92:93] neg_lo:[0,1] neg_hi:[0,1]
    v_pk_add_f32 v[68:69], v[68:69], v[92:93]
    v_pk_add_f32 v[80:81], v[98:99], v[16:17] op_sel:[0,1] op_sel_hi:[1,0] neg_lo:[0,1]
    v_pk_add_f32 v[108:109], v[62:63], v[70:71] neg_lo:[0,1] neg_hi:[0,1]
    v_pk_add_f32 v[62:63], v[62:63], v[70:71]
    v_pk_add_f32 v[98:99], v[98:99], v[16:17] op_sel:[0,1] op_sel_hi:[1,0] neg_hi:[0,1]
    v_pk_add_f32 v[74:75], v[76:77], v[100:101] neg_lo:[0,1] neg_hi:[0,1]
    v_pk_add_f32 v[76:77], v[76:77], v[100:101]
    v_pk_add_f32 v[84:85], v[14:15], v[74:75] op_sel:[0,1] op_sel_hi:[1,0] neg_lo:[0,1]
    v_pk_add_f32 v[14:15], v[14:15], v[74:75] op_sel:[0,1] op_sel_hi:[1,0] neg_hi:[0,1]
    v_pk_add_f32 v[112:113], v[68:69], v[76:77] neg_lo:[0,1] neg_hi:[0,1]
    v_pk_add_f32 v[68:69], v[68:69], v[76:77]
    v_pk_add_f32 v[38:39], v[84:85], v[84:85] op_sel:[0,1] op_sel_hi:[1,0] neg_lo:[1,0] neg_hi:[1,1]
    v_pk_add_f32 v[30:31], v[14:15], v[14:15] op_sel:[0,1] op_sel_hi:[1,0] neg_lo:[0,0] neg_hi:[0,1]
    v_pk_add_f32 v[116:117], v[108:109], v[112:113] op_sel:[0,1] op_sel_hi:[1,0] neg_lo:[0,1]
    v_pk_add_f32 v[114:115], v[62:63], v[68:69] neg_lo:[0,1] neg_hi:[0,1]
    v_pk_add_f32 v[62:63], v[62:63], v[68:69]
    v_pk_fma_f32 v[14:15], v[30:31], s[36:37], v[98:99] neg_lo:[1,0,0] neg_hi:[1,0,0]
    v_pk_fma_f32 v[98:99], v[30:31], s[36:37], v[98:99]
    v_pk_add_f32 v[108:109], v[108:109], v[112:113] op_sel:[0,1] op_sel_hi:[1,0] neg_hi:[0,1]
    v_pk_fma_f32 v[84:85], v[38:39], s[36:37], v[80:81] neg_lo:[1,0,0] neg_hi:[1,0,0]
    v_pk_fma_f32 v[80:81], v[38:39], s[36:37], v[80:81]
    v_pk_add_f32 v[102:103], v[36:37], v[62:63] neg_lo:[0,1] neg_hi:[0,1]
    v_pk_add_f32 v[36:37], v[36:37], v[62:63]
    v_pk_mul_f32 v[22:23], v[98:99], s[38:39] op_sel:[0,0] op_sel_hi:[1,0] neg_lo:[0,0] neg_hi:[0,0]
    v_pk_add_f32 v[120:121], v[108:109], v[108:109] op_sel:[0,1] op_sel_hi:[1,0] neg_lo:[0,0] neg_hi:[0,1]
    v_pk_mul_f32 v[88:89], v[80:81], s[38:39] op_sel:[0,1] op_sel_hi:[1,1] neg_lo:[0,0] neg_hi:[0,0]
    v_pk_add_f32 v[122:123], v[18:19], v[114:115] op_sel:[0,1] op_sel_hi:[1,0] neg_lo:[0,1]
    v_pk_fma_f32 v[22:23], v[98:99], s[38:39], v[22:23] op_sel:[1,1,0] op_sel_hi:[0,1,1] neg_lo:[1,1,0] neg_hi:[0,1,0]
    v_pk_fma_f32 v[108:109], v[120:121], s[36:37], v[42:43] neg_lo:[1,0,0] neg_hi:[1,0,0]
    v_pk_fma_f32 v[42:43], v[120:121], s[36:37], v[42:43]
    v_pk_fma_f32 v[88:89], v[80:81], s[38:39], v[88:89] op_sel:[1,0,0] op_sel_hi:[0,0,1] neg_lo:[1,1,0] neg_hi:[0,1,0]
    v_pk_add_f32 v[98:99], v[12:13], v[22:23] neg_lo:[0,1] neg_hi:[0,1]
    v_pk_add_f32 v[12:13], v[12:13], v[22:23]
    v_pk_add_f32 v[18:19], v[18:19], v[114:115] op_sel:[0,1] op_sel_hi:[1,0] neg_hi:[0,1]
    v_pk_add_f32 v[80:81], v[64:65], v[88:89] neg_lo:[0,1] neg_hi:[0,1]
    v_pk_add_f32 v[64:65], v[64:65], v[88:89]
    v_pk_mul_f32 v[34:35], v[14:15], s[38:39] op_sel:[0,1] op_sel_hi:[1,1] neg_lo:[0,1] neg_hi:[0,1]
    v_pk_add_f32 v[28:29], v[116:117], v[116:117] op_sel:[0,1] op_sel_hi:[1,0] neg_lo:[1,0] neg_hi:[1,1]
    v_pk_mul_f32 v[110:111], v[84:85], s[38:39] op_sel:[0,0] op_sel_hi:[1,0] neg_lo:[0,1] neg_hi:[0,1]
    ds_write_b64 v61, v[36:37] offset:17408
    v_pk_fma_f32 v[34:35], v[14:15], s[38:39], v[34:35] op_sel:[1,0,0] op_sel_hi:[0,0,1] neg_lo:[1,1,0] neg_hi:[0,1,0]
    v_pk_fma_f32 v[116:117], v[28:29], s[36:37], v[104:105] neg_lo:[1,0,0] neg_hi:[1,0,0]
    v_pk_fma_f32 v[104:105], v[28:29], s[36:37], v[104:105]
    v_pk_fma_f32 v[110:111], v[84:85], s[38:39], v[110:111] op_sel:[1,1,0] op_sel_hi:[0,1,1] neg_lo:[1,1,0] neg_hi:[0,1,0]
    v_pk_add_f32 v[14:15], v[26:27], v[34:35] neg_lo:[0,1] neg_hi:[0,1]
    v_pk_add_f32 v[26:27], v[26:27], v[34:35]
    ds_write_b64 v61, v[12:13] offset:17544
    v_pk_add_f32 v[84:85], v[40:41], v[110:111] neg_lo:[0,1] neg_hi:[0,1]
    v_pk_add_f32 v[40:41], v[40:41], v[110:111]
    ds_write_b64 v61, v[42:43] offset:17680
    ds_write_b64 v61, v[64:65] offset:17816
    ds_write_b64 v61, v[18:19] offset:17952
    ds_write_b64 v61, v[26:27] offset:18088
    ds_write_b64 v61, v[104:105] offset:18224
    ds_write_b64 v61, v[40:41] offset:18360
    ds_write_b64 v61, v[102:103] offset:18496
    ds_write_b64 v61, v[98:99] offset:18632
    ds_write_b64 v61, v[108:109] offset:18768
    ds_write_b64 v61, v[80:81] offset:18904
    ds_write_b64 v61, v[122:123] offset:19040
    ds_write_b64 v61, v[14:15] offset:19176
    ds_write_b64 v61, v[116:117] offset:19312
    ds_write_b64 v61, v[84:85] offset:19448
    s_waitcnt lgkmcnt(0)
    s_barrier
    ds_read_b64 v[60:61], v9 offset:17408
    ds_read_b64 v[118:119], v9 offset:19584
    ds_read_b64 v[78:79], v9 offset:21760
    ds_read_b64 v[20:21], v9 offset:23936
    ds_read_b64 v[90:91], v9 offset:26112
    ds_read_b64 v[106:107], v9 offset:28288
    ds_read_b64 v[82:83], v9 offset:30464
    ds_read_b64 v[32:33], v9 offset:32640
    ds_read_b64 v[66:67], v9 offset:18496
    ds_read_b64 v[24:25], v9 offset:20672
    ds_read_b64 v[96:97], v9 offset:22848
    ds_read_b64 v[72:73], v9 offset:25024
    ds_read_b64 v[86:87], v9 offset:27200
    ds_read_b64 v[94:95], v9 offset:29376
    ds_read_b64 v[70:71], v9 offset:31552
    ds_read_b64 v[16:17], v9 offset:33728
    v_and_b32 v11, 0xff, v0
    v_add_u32 v38, 128, v0
    v_cvt_f32_u32 v11, v11
    v_and_b32 v38, 0xff, v38
    v_mul_f32 v93, 0xba000000, v11
    v_cvt_f32_u32 v38, v38
    v_cos_f32 v92, v93
    v_sin_f32 v93, v93
    v_mul_f32 v63, 0xba000000, v38
    v_pk_mul_f32 v[100:101], v[92:93], v[92:93] op_sel:[0,0] op_sel_hi:[1,0]
    v_cos_f32 v62, v63
    v_sin_f32 v63, v63
    v_pk_fma_f32 v[100:101], v[92:93], v[92:93], v[100:101] op_sel:[1,1,0] op_sel_hi:[0,1,1] neg_lo:[1,0,0]
    v_pk_mul_f32 v[76:77], v[92:93], v[100:101] op_sel:[0,0] op_sel_hi:[1,0]
    v_pk_mul_f32 v[74:75], v[100:101], v[100:101] op_sel:[0,0] op_sel_hi:[1,0]
    v_pk_mul_f32 v[22:23], v[62:63], v[62:63] op_sel:[0,0] op_sel_hi:[1,0]
    v_pk_fma_f32 v[76:77], v[92:93], v[100:101], v[76:77] op_sel:[1,1,0] op_sel_hi:[0,1,1] neg_lo:[1,0,0]
    v_pk_fma_f32 v[74:75], v[100:101], v[100:101], v[74:75] op_sel:[1,1,0] op_sel_hi:[0,1,1] neg_lo:[1,0,0]
    v_pk_fma_f32 v[22:23], v[62:63], v[62:63], v[22:23] op_sel:[1,1,0] op_sel_hi:[0,1,1] neg_lo:[1,0,0]
    v_pk_mul_f32 v[68:69], v[100:101], v[76:77] op_sel:[0,0] op_sel_hi:[1,0]
    v_pk_mul_f32 v[30:31], v[76:77], v[76:77] op_sel:[0,0] op_sel_hi:[1,0]
    v_pk_mul_f32 v[112:113], v[76:77], v[74:75] op_sel:[0,0] op_sel_hi:[1,0]
    v_pk_mul_f32 v[120:121], v[62:63], v[22:23] op_sel:[0,0] op_sel_hi:[1,0]
    v_pk_fma_f32 v[68:69], v[100:101], v[76:77], v[68:69] op_sel:[1,1,0] op_sel_hi:[0,1,1] neg_lo:[1,0,0]
    v_pk_fma_f32 v[30:31], v[76:77], v[76:77], v[30:31] op_sel:[1,1,0] op_sel_hi:[0,1,1] neg_lo:[1,0,0]
    v_pk_fma_f32 v[112:113], v[76:77], v[74:75], v[112:113] op_sel:[1,1,0] op_sel_hi:[0,1,1] neg_lo:[1,0,0]
    v_pk_fma_f32 v[120:121], v[62:63], v[22:23], v[120:121] op_sel:[1,1,0] op_sel_hi:[0,1,1] neg_lo:[1,0,0]
    v_pk_mul_f32 v[88:89], v[22:23], v[22:23] op_sel:[0,0] op_sel_hi:[1,0]
    v_pk_mul_f32 v[114:115], v[22:23], v[120:121] op_sel:[0,0] op_sel_hi:[1,0]
    v_pk_mul_f32 v[34:35], v[120:121], v[120:121] op_sel:[0,0] op_sel_hi:[1,0]
    v_pk_fma_f32 v[88:89], v[22:23], v[22:23], v[88:89] op_sel:[1,1,0] op_sel_hi:[0,1,1] neg_lo:[1,0,0]
    v_pk_fma_f32 v[114:115], v[22:23], v[120:121], v[114:115] op_sel:[1,1,0] op_sel_hi:[0,1,1] neg_lo:[1,0,0]
    v_pk_fma_f32 v[34:35], v[120:121], v[120:121], v[34:35] op_sel:[1,1,0] op_sel_hi:[0,1,1] neg_lo:[1,0,0]
    v_pk_mul_f32 v[28:29], v[120:121], v[88:89] op_sel:[0,0] op_sel_hi:[1,0]
    v_pk_fma_f32 v[28:29], v[120:121], v[88:89], v[28:29] op_sel:[1,1,0] op_sel_hi:[0,1,1] neg_lo:[1,0,0]
    s_waitcnt lgkmcnt(0)
    v_pk_mul_f32 v[110:111], v[118:119], v[92:93] op_sel:[0,0] op_sel_hi:[1,0]
    v_pk_mul_f32 v[36:37], v[78:79], v[100:101] op_sel:[0,0] op_sel_hi:[1,0]
    v_pk_mul_f32 v[12:13], v[20:21], v[76:77] op_sel:[0,0] op_sel_hi:[1,0]
    v_pk_mul_f32 v[42:43], v[90:91], v[74:75] op_sel:[0,0] op_sel_hi:[1,0]
    v_pk_fma_f32 v[110:111], v[118:119], v[92:93], v[110:111] op_sel:[1,1,0] op_sel_hi:[0,1,1] neg_lo:[1,0,0]
    v_pk_fma_f32 v[36:37], v[78:79], v[100:101], v[36:37] op_sel:[1,1,0] op_sel_hi:[0,1,1] neg_lo:[1,0,0]
    v_pk_fma_f32 v[12:13], v[20:21], v[76:77], v[12:13] op_sel:[1,1,0] op_sel_hi:[0,1,1] neg_lo:[1,0,0]
    v_pk_fma_f32 v[42:43], v[90:91], v[74:75], v[42:43] op_sel:[1,1,0] op_sel_hi:[0,1,1] neg_lo:[1,0,0]
    v_pk_mul_f32 v[64:65], v[106:107], v[68:69] op_sel:[0,0] op_sel_hi:[1,0]
    v_pk_mul_f32 v[18:19], v[82:83], v[30:31] op_sel:[0,0] op_sel_hi:[1,0]
    v_pk_mul_f32 v[26:27], v[32:33], v[112:113] op_sel:[0,0] op_sel_hi:[1,0]
    v_pk_add_f32 v[104:105], v[60:61], v[42:43] neg_lo:[0,1] neg_hi:[0,1]
    v_pk_fma_f32 v[64:65], v[106:107], v[68:69], v[64:65] op_sel:[1,1,0] op_sel_hi:[0,1,1] neg_lo:[1,0,0]
    v_pk_fma_f32 v[18:19], v[82:83], v[30:31], v[18:19] op_sel:[1,1,0] op_sel_hi:[0,1,1] neg_lo:[1,0,0]
    v_pk_fma_f32 v[26:27], v[32:33], v[112:113], v[26:27] op_sel:[1,1,0] op_sel_hi:[0,1,1] neg_lo:[1,0,0]
    v_pk_add_f32 v[60:61], v[60:61], v[42:43]
    v_pk_add_f32 v[108:109], v[110:111], v[64:65] neg_lo:[0,1] neg_hi:[0,1]
    v_pk_add_f32 v[40:41], v[36:37], v[18:19] neg_lo:[0,1] neg_hi:[0,1]
    v_pk_add_f32 v[36:37], v[36:37], v[18:19]
    v_pk_add_f32 v[110:111], v[110:111], v[64:65]
    v_pk_add_f32 v[80:81], v[12:13], v[26:27] neg_lo:[0,1] neg_hi:[0,1]
    v_pk_add_f32 v[98:99], v[104:105], v[40:41] op_sel:[0,1] op_sel_hi:[1,0] neg_lo:[0,1]
    v_pk_add_f32 v[102:103], v[60:61], v[36:37] neg_lo:[0,1] neg_hi:[0,1]
    v_pk_add_f32 v[60:61], v[60:61], v[36:37]
    v_pk_add_f32 v[104:105], v[104:105], v[40:41] op_sel:[0,1] op_sel_hi:[1,0] neg_hi:[0,1]
    v_pk_add_f32 v[12:13], v[12:13], v[26:27]
    v_pk_add_f32 v[14:15], v[108:109], v[80:81] op_sel:[0,1] op_sel_hi:[1,0] neg_lo:[0,1]
    v_pk_add_f32 v[108:109], v[108:109], v[80:81] op_sel:[0,1] op_sel_hi:[1,0] neg_hi:[0,1]
    v_pk_mul_f32 v[92:93], v[24:25], v[62:63] op_sel:[0,0] op_sel_hi:[1,0]
    v_pk_add_f32 v[122:123], v[110:111], v[12:13] neg_lo:[0,1] neg_hi:[0,1]
    v_pk_add_f32 v[110:111], v[110:111], v[12:13]
    v_pk_add_f32 v[84:85], v[108:109], v[108:109] op_sel:[0,1] op_sel_hi:[1,0] neg_lo:[0,0] neg_hi:[0,1]
    v_pk_add_f32 v[118:119], v[14:15], v[14:15] op_sel:[0,1] op_sel_hi:[1,0] neg_lo:[1,0] neg_hi:[1,1]
    v_pk_add_f32 v[38:39], v[102:103], v[122:123] op_sel:[0,1] op_sel_hi:[1,0] neg_lo:[0,1]
    v_pk_add_f32 v[116:117], v[60:61], v[110:111] neg_lo:[0,1] neg_hi:[0,1]
    v_pk_add_f32 v[60:61], v[60:61], v[110:111]
    v_pk_fma_f32 v[108:109], v[84:85], s[36:37], v[104:105] neg_lo:[1,0,0] neg_hi:[1,0,0]
    v_pk_fma_f32 v[104:105], v[84:85], s[36:37], v[104:105]
    v_pk_add_f32 v[102:103], v[102:103], v[122:123] op_sel:[0,1] op_sel_hi:[1,0] neg_hi:[0,1]
    v_pk_fma_f32 v[14:15], v[118:119], s[36:37], v[98:99] neg_lo:[1,0,0] neg_hi:[1,0,0]
    v_pk_fma_f32 v[98:99], v[118:119], s[36:37], v[98:99]
    v_pk_fma_f32 v[92:93], v[24:25], v[62:63], v[92:93] op_sel:[1,1,0] op_sel_hi:[0,1,1] neg_lo:[1,0,0]
    v_pk_mul_f32 v[78:79], v[96:97], v[22:23] op_sel:[0,0] op_sel_hi:[1,0]
    v_pk_mul_f32 v[100:101], v[72:73], v[120:121] op_sel:[0,0] op_sel_hi:[1,0]
    v_pk_mul_f32 v[20:21], v[86:87], v[88:89] op_sel:[0,0] op_sel_hi:[1,0]
    v_pk_mul_f32 v[76:77], v[94:95], v[114:115] op_sel:[0,0] op_sel_hi:[1,0]
    v_pk_fma_f32 v[78:79], v[96:97], v[22:23], v[78:79] op_sel:[1,1,0] op_sel_hi:[0,1,1] neg_lo:[1,0,0]
    v_pk_fma_f32 v[100:101], v[72:73], v[120:121], v[100:101] op_sel:[1,1,0] op_sel_hi:[0,1,1] neg_lo:[1,0,0]
    v_pk_fma_f32 v[20:21], v[86:87], v[88:89], v[20:21] op_sel:[1,1,0] op_sel_hi:[0,1,1] neg_lo:[1,0,0]
    v_pk_fma_f32 v[76:77], v[94:95], v[114:115], v[76:77] op_sel:[1,1,0] op_sel_hi:[0,1,1] neg_lo:[1,0,0]
    v_pk_mul_f32 v[90:91], v[70:71], v[34:35] op_sel:[0,0] op_sel_hi:[1,0]
    v_pk_mul_f32 v[74:75], v[16:17], v[28:29] op_sel:[0,0] op_sel_hi:[1,0]
    v_pk_add_f32 v[106:107], v[66:67], v[20:21] neg_lo:[0,1] neg_hi:[0,1]
    v_pk_add_f32 v[66:67], v[66:67], v[20:21]
    v_pk_fma_f32 v[90:91], v[70:71], v[34:35], v[90:91] op_sel:[1,1,0] op_sel_hi:[0,1,1] neg_lo:[1,0,0]
    v_pk_fma_f32 v[74:75], v[16:17], v[28:29], v[74:75] op_sel:[1,1,0] op_sel_hi:[0,1,1] neg_lo:[1,0,0]
    v_pk_add_f32 v[32:33], v[92:93], v[76:77] neg_lo:[0,1] neg_hi:[0,1]
    v_pk_add_f32 v[92:93], v[92:93], v[76:77]
    v_pk_add_f32 v[68:69], v[78:79], v[90:91] neg_lo:[0,1] neg_hi:[0,1]
    v_pk_add_f32 v[78:79], v[78:79], v[90:91]
    v_pk_add_f32 v[112:113], v[100:101], v[74:75] neg_lo:[0,1] neg_hi:[0,1]
    v_pk_add_f32 v[100:101], v[100:101], v[74:75]
    v_pk_add_f32 v[30:31], v[106:107], v[68:69] op_sel:[0,1] op_sel_hi:[1,0] neg_lo:[0,1]
    v_pk_add_f32 v[82:83], v[66:67], v[78:79] neg_lo:[0,1] neg_hi:[0,1]
    v_pk_add_f32 v[66:67], v[66:67], v[78:79]
    v_pk_add_f32 v[106:107], v[106:107], v[68:69] op_sel:[0,1] op_sel_hi:[1,0] neg_hi:[0,1]
    v_pk_add_f32 v[42:43], v[92:93], v[100:101] neg_lo:[0,1] neg_hi:[0,1]
    v_pk_add_f32 v[92:93], v[92:93], v[100:101]
    v_pk_add_f32 v[18:19], v[32:33], v[112:113] op_sel:[0,1] op_sel_hi:[1,0] neg_lo:[0,1]
    v_pk_add_f32 v[32:33], v[32:33], v[112:113] op_sel:[0,1] op_sel_hi:[1,0] neg_hi:[0,1]
    v_pk_add_f32 v[64:65], v[82:83], v[42:43] op_sel:[0,1] op_sel_hi:[1,0] neg_lo:[0,1]
    v_pk_add_f32 v[36:37], v[66:67], v[92:93] neg_lo:[0,1] neg_hi:[0,1]
    v_pk_add_f32 v[66:67], v[66:67], v[92:93]
    v_pk_add_f32 v[40:41], v[32:33], v[32:33] op_sel:[0,1] op_sel_hi:[1,0] neg_lo:[0,0] neg_hi:[0,1]
    v_pk_add_f32 v[82:83], v[82:83], v[42:43] op_sel:[0,1] op_sel_hi:[1,0] neg_hi:[0,1]
    v_pk_add_f32 v[26:27], v[18:19], v[18:19] op_sel:[0,1] op_sel_hi:[1,0] neg_lo:[1,0] neg_hi:[1,1]
    v_pk_fma_f32 v[32:33], v[40:41], s[36:37], v[106:107] neg_lo:[1,0,0] neg_hi:[1,0,0]
    v_pk_fma_f32 v[106:107], v[40:41], s[36:37], v[106:107]
    v_pk_fma_f32 v[18:19], v[26:27], s[36:37], v[30:31] neg_lo:[1,0,0] neg_hi:[1,0,0]
    v_pk_fma_f32 v[30:31], v[26:27], s[36:37], v[30:31]
    s_waitcnt vmcnt(0)
    v_lshlrev_b32 v12, 16, v44
    v_and_b32 v13, 0xffff0000, v44
    v_mul_f32 v12, 0x34800000, v12
    v_mul_f32 v13, 0x34800000, v13
    v_pk_mul_f32 v[80:81], v[60:61], v[12:13] op_sel:[0,0] op_sel_hi:[1,0]
    v_pk_fma_f32 v[80:81], v[60:61], v[12:13], v[80:81] op_sel:[1,1,0] op_sel_hi:[0,1,1] neg_lo:[1,0,0]
    v_lshlrev_b32 v110, 16, v45
    v_and_b32 v111, 0xffff0000, v45
    v_mul_f32 v110, 0x34800000, v110
    v_mul_f32 v111, 0x34800000, v111
    v_pk_mul_f32 v[84:85], v[104:105], v[110:111] op_sel:[0,0] op_sel_hi:[1,0]
    v_pk_fma_f32 v[84:85], v[104:105], v[110:111], v[84:85] op_sel:[1,1,0] op_sel_hi:[0,1,1] neg_lo:[1,0,0]
    v_lshlrev_b32 v122, 16, v46
    v_and_b32 v123, 0xffff0000, v46
    v_mul_f32 v122, 0x34800000, v122
    v_mul_f32 v123, 0x34800000, v123
    v_pk_mul_f32 v[118:119], v[102:103], v[122:123] op_sel:[0,0] op_sel_hi:[1,0]
    v_pk_fma_f32 v[118:119], v[102:103], v[122:123], v[118:119] op_sel:[1,1,0] op_sel_hi:[0,1,1] neg_lo:[1,0,0]
    v_lshlrev_b32 v24, 16, v47
    v_and_b32 v25, 0xffff0000, v47
    v_mul_f32 v24, 0x34800000, v24
    v_mul_f32 v25, 0x34800000, v25
    v_pk_mul_f32 v[62:63], v[98:99], v[24:25] op_sel:[0,0] op_sel_hi:[1,0]
    v_pk_fma_f32 v[62:63], v[98:99], v[24:25], v[62:63] op_sel:[1,1,0] op_sel_hi:[0,1,1] neg_lo:[1,0,0]
    v_lshlrev_b32 v96, 16, v48
    v_and_b32 v97, 0xffff0000, v48
    v_mul_f32 v96, 0x34800000, v96
    v_mul_f32 v97, 0x34800000, v97
    v_pk_mul_f32 v[22:23], v[116:117], v[96:97] op_sel:[0,0] op_sel_hi:[1,0]
    v_pk_fma_f32 v[22:23], v[116:117], v[96:97], v[22:23] op_sel:[1,1,0] op_sel_hi:[0,1,1] neg_lo:[1,0,0]
    v_lshlrev_b32 v72, 16, v49
    v_and_b32 v73, 0xffff0000, v49
    v_mul_f32 v72, 0x34800000, v72
    v_mul_f32 v73, 0x34800000, v73
    v_pk_mul_f32 v[120:121], v[108:109], v[72:73] op_sel:[0,0] op_sel_hi:[1,0]
    v_pk_fma_f32 v[120:121], v[108:109], v[72:73], v[120:121] op_sel:[1,1,0] op_sel_hi:[0,1,1] neg_lo:[1,0,0]
    v_lshlrev_b32 v86, 16, v50
    v_and_b32 v87, 0xffff0000, v50
    v_mul_f32 v86, 0x34800000, v86
    v_mul_f32 v87, 0x34800000, v87
    v_pk_mul_f32 v[88:89], v[38:39], v[86:87] op_sel:[0,0] op_sel_hi:[1,0]
    v_pk_fma_f32 v[88:89], v[38:39], v[86:87], v[88:89] op_sel:[1,1,0] op_sel_hi:[0,1,1] neg_lo:[1,0,0]
    v_lshlrev_b32 v94, 16, v51
    v_and_b32 v95, 0xffff0000, v51
    v_mul_f32 v94, 0x34800000, v94
    v_mul_f32 v95, 0x34800000, v95
    v_pk_mul_f32 v[114:115], v[14:15], v[94:95] op_sel:[0,0] op_sel_hi:[1,0]
    v_pk_fma_f32 v[114:115], v[14:15], v[94:95], v[114:115] op_sel:[1,1,0] op_sel_hi:[0,1,1] neg_lo:[1,0,0]
    v_lshlrev_b32 v70, 16, v52
    v_and_b32 v71, 0xffff0000, v52
    v_mul_f32 v70, 0x34800000, v70
    v_mul_f32 v71, 0x34800000, v71
    v_pk_mul_f32 v[34:35], v[66:67], v[70:71] op_sel:[0,0] op_sel_hi:[1,0]
    v_pk_fma_f32 v[34:35], v[66:67], v[70:71], v[34:35] op_sel:[1,1,0] op_sel_hi:[0,1,1] neg_lo:[1,0,0]
    v_lshlrev_b32 v16, 16, v53
    v_and_b32 v17, 0xffff0000, v53
    v_mul_f32 v16, 0x34800000, v16
    v_mul_f32 v17, 0x34800000, v17
    v_pk_mul_f32 v[28:29], v[106:107], v[16:17] op_sel:[0,0] op_sel_hi:[1,0]
    v_pk_fma_f32 v[28:29], v[106:107], v[16:17], v[28:29] op_sel:[1,1,0] op_sel_hi:[0,1,1] neg_lo:[1,0,0]
    v_lshlrev_b32 v20, 16, v54
    v_and_b32 v21, 0xffff0000, v54
    v_mul_f32 v20, 0x34800000, v20
    v_mul_f32 v21, 0x34800000, v21
    v_pk_mul_f32 v[90:91], v[82:83], v[20:21] op_sel:[0,0] op_sel_hi:[1,0]
    v_pk_fma_f32 v[90:91], v[82:83], v[20:21], v[90:91] op_sel:[1,1,0] op_sel_hi:[0,1,1] neg_lo:[1,0,0]
    v_lshlrev_b32 v78, 16, v55
    v_and_b32 v79, 0xffff0000, v55
    v_mul_f32 v78, 0x34800000, v78
    v_mul_f32 v79, 0x34800000, v79
    v_pk_mul_f32 v[68:69], v[30:31], v[78:79] op_sel:[0,0] op_sel_hi:[1,0]
    v_pk_fma_f32 v[68:69], v[30:31], v[78:79], v[68:69] op_sel:[1,1,0] op_sel_hi:[0,1,1] neg_lo:[1,0,0]
    v_lshlrev_b32 v76, 16, v56
    v_and_b32 v77, 0xffff0000, v56
    v_mul_f32 v76, 0x34800000, v76
    v_mul_f32 v77, 0x34800000, v77
    v_pk_mul_f32 v[74:75], v[36:37], v[76:77] op_sel:[0,0] op_sel_hi:[1,0]
    v_pk_fma_f32 v[74:75], v[36:37], v[76:77], v[74:75] op_sel:[1,1,0] op_sel_hi:[0,1,1] neg_lo:[1,0,0]
    v_lshlrev_b32 v100, 16, v57
    v_and_b32 v101, 0xffff0000, v57
    v_mul_f32 v100, 0x34800000, v100
    v_mul_f32 v101, 0x34800000, v101
    v_pk_mul_f32 v[112:113], v[32:33], v[100:101] op_sel:[0,0] op_sel_hi:[1,0]
    v_pk_fma_f32 v[112:113], v[32:33], v[100:101], v[112:113] op_sel:[1,1,0] op_sel_hi:[0,1,1] neg_lo:[1,0,0]
    v_lshlrev_b32 v92, 16, v58
    v_and_b32 v93, 0xffff0000, v58
    v_mul_f32 v92, 0x34800000, v92
    v_mul_f32 v93, 0x34800000, v93
    v_pk_mul_f32 v[40:41], v[64:65], v[92:93] op_sel:[0,0] op_sel_hi:[1,0]
    v_pk_fma_f32 v[40:41], v[64:65], v[92:93], v[40:41] op_sel:[1,1,0] op_sel_hi:[0,1,1] neg_lo:[1,0,0]
    v_lshlrev_b32 v42, 16, v59
    v_and_b32 v43, 0xffff0000, v59
    v_mul_f32 v42, 0x34800000, v42
    v_mul_f32 v43, 0x34800000, v43
    v_pk_mul_f32 v[26:27], v[18:19], v[42:43] op_sel:[0,0] op_sel_hi:[1,0]
    v_pk_fma_f32 v[26:27], v[18:19], v[42:43], v[26:27] op_sel:[1,1,0] op_sel_hi:[0,1,1] neg_lo:[1,0,0]
    v_add_u32 v11, 0, v0
    v_add_u32 v61, 128, v0
    v_lshlrev_b32 v11, 3, v11
    v_lshlrev_b32 v61, 3, v61
    v_lshrrev_b32 v60, 4, v11
    v_lshrrev_b32 v12, 4, v61
    v_add_u32 v11, v11, v60
    v_add_u32 v61, v61, v12
    v_lshl_add_u32 v11, v11, 3, v8
    v_lshl_add_u32 v61, v61, 3, v8
    s_nop 0
    v_pk_add_f32 v[44:45], v[80:81], v[22:23] neg_lo:[0,1] neg_hi:[0,1]
    v_pk_add_f32 v[80:81], v[80:81], v[22:23]
    v_pk_add_f32 v[104:105], v[118:119], v[88:89] neg_lo:[0,1] neg_hi:[0,1]
    v_pk_add_f32 v[118:119], v[118:119], v[88:89]
    v_pk_add_f32 v[122:123], v[84:85], v[120:121] neg_lo:[0,1] neg_hi:[0,1]
    v_pk_add_f32 v[84:85], v[84:85], v[120:121]
    v_pk_add_f32 v[102:103], v[44:45], v[104:105] op_sel:[0,1] op_sel_hi:[1,0] neg_hi:[0,1]
    v_pk_add_f32 v[110:111], v[80:81], v[118:119] neg_lo:[0,1] neg_hi:[0,1]
    v_pk_add_f32 v[80:81], v[80:81], v[118:119]
    v_pk_add_f32 v[44:45], v[44:45], v[104:105] op_sel:[0,1] op_sel_hi:[1,0] neg_lo:[0,1]
    v_pk_add_f32 v[46:47], v[62:63], v[114:115] neg_lo:[0,1] neg_hi:[0,1]
    v_pk_add_f32 v[62:63], v[62:63], v[114:115]
    v_pk_add_f32 v[72:73], v[34:35], v[74:75] neg_lo:[0,1] neg_hi:[0,1]
    v_pk_add_f32 v[34:35], v[34:35], v[74:75]
    v_pk_add_f32 v[24:25], v[122:123], v[46:47] op_sel:[0,1] op_sel_hi:[1,0] neg_hi:[0,1]
    v_pk_add_f32 v[98:99], v[84:85], v[62:63] neg_lo:[0,1] neg_hi:[0,1]
    v_pk_add_f32 v[84:85], v[84:85], v[62:63]
    v_pk_add_f32 v[122:123], v[122:123], v[46:47] op_sel:[0,1] op_sel_hi:[1,0] neg_lo:[0,1]
    v_pk_add_f32 v[108:109], v[24:25], v[24:25] op_sel:[0,1] op_sel_hi:[1,0] neg_lo:[1,1] neg_hi:[1,0]
    v_pk_add_f32 v[48:49], v[110:111], v[98:99] op_sel:[0,1] op_sel_hi:[1,0] neg_hi:[0,1]
    v_pk_add_f32 v[116:117], v[80:81], v[84:85] neg_lo:[0,1] neg_hi:[0,1]
    v_pk_add_f32 v[80:81], v[80:81], v[84:85]
    v_pk_add_f32 v[96:97], v[122:123], v[122:123] op_sel:[0,1] op_sel_hi:[1,0] neg_lo:[0,1] neg_hi:[0,0]
    v_pk_add_f32 v[110:111], v[110:111], v[98:99] op_sel:[0,1] op_sel_hi:[1,0] neg_lo:[0,1]
    v_pk_fma_f32 v[24:25], v[108:109], s[36:37], v[102:103] neg_lo:[1,0,0] neg_hi:[1,0,0]
    v_pk_fma_f32 v[102:103], v[108:109], s[36:37], v[102:103]
    v_pk_fma_f32 v[122:123], v[96:97], s[36:37], v[44:45] neg_lo:[1,0,0] neg_hi:[1,0,0]
    v_pk_fma_f32 v[44:45], v[96:97], s[36:37], v[44:45]
    v_pk_add_f32 v[38:39], v[90:91], v[40:41] neg_lo:[0,1] neg_hi:[0,1]
    v_pk_add_f32 v[90:91], v[90:91], v[40:41]
    v_pk_add_f32 v[14:15], v[28:29], v[112:113] neg_lo:[0,1] neg_hi:[0,1]
    v_pk_add_f32 v[28:29], v[28:29], v[112:113]
    v_pk_add_f32 v[50:51], v[72:73], v[38:39] op_sel:[0,1] op_sel_hi:[1,0] neg_hi:[0,1]
    v_pk_add_f32 v[86:87], v[34:35], v[90:91] neg_lo:[0,1] neg_hi:[0,1]
    v_pk_add_f32 v[34:35], v[34:35], v[90:91]
    v_pk_add_f32 v[72:73], v[72:73], v[38:39] op_sel:[0,1] op_sel_hi:[1,0] neg_lo:[0,1]
    v_pk_add_f32 v[94:95], v[68:69], v[26:27] neg_lo:[0,1] neg_hi:[0,1]
    v_pk_add_f32 v[68:69], v[68:69], v[26:27]
    ds_write_b64 v11, v[80:81] offset:0
    ds_write_b64 v11, v[44:45] offset:8
    v_pk_add_f32 v[70:71], v[14:15], v[94:95] op_sel:[0,1] op_sel_hi:[1,0] neg_hi:[0,1]
    v_pk_add_f32 v[66:67], v[28:29], v[68:69] neg_lo:[0,1] neg_hi:[0,1]
    v_pk_add_f32 v[28:29], v[28:29], v[68:69]
    v_pk_add_f32 v[14:15], v[14:15], v[94:95] op_sel:[0,1] op_sel_hi:[1,0] neg_lo:[0,1]
    v_pk_add_f32 v[82:83], v[70:71], v[70:71] op_sel:[0,1] op_sel_hi:[1,0] neg_lo:[1,1] neg_hi:[1,0]
    v_pk_add_f32 v[16:17], v[86:87], v[66:67] op_sel:[0,1] op_sel_hi:[1,0] neg_hi:[0,1]
    v_pk_add_f32 v[52:53], v[34:35], v[28:29] neg_lo:[0,1] neg_hi:[0,1]
    v_pk_add_f32 v[34:35], v[34:35], v[28:29]
    v_pk_add_f32 v[106:107], v[14:15], v[14:15] op_sel:[0,1] op_sel_hi:[1,0] neg_lo:[0,1] neg_hi:[0,0]
    v_pk_add_f32 v[86:87], v[86:87], v[66:67] op_sel:[0,1] op_sel_hi:[1,0] neg_lo:[0,1]
    v_pk_fma_f32 v[70:71], v[82:83], s[36:37], v[50:51] neg_lo:[1,0,0] neg_hi:[1,0,0]
    v_pk_fma_f32 v[50:51], v[82:83], s[36:37], v[50:51]
    v_pk_fma_f32 v[14:15], v[106:107], s[36:37], v[72:73] neg_lo:[1,0,0] neg_hi:[1,0,0]
    v_pk_fma_f32 v[72:73], v[106:107], s[36:37], v[72:73]
    ds_write_b64 v11, v[110:111] offset:16
    ds_write_b64 v11, v[102:103] offset:24
    ds_write_b64 v11, v[116:117] offset:32
    ds_write_b64 v11, v[122:123] offset:40
    ds_write_b64 v11, v[48:49] offset:48
    ds_write_b64 v11, v[24:25] offset:56
    ds_write_b64 v61, v[34:35] offset:0
    ds_write_b64 v61, v[72:73] offset:8
    ds_write_b64 v61, v[86:87] offset:16
    ds_write_b64 v61, v[50:51] offset:24
    ds_write_b64 v61, v[52:53] offset:32
    ds_write_b64 v61, v[14:15] offset:40
    ds_write_b64 v61, v[16:17] offset:48
    ds_write_b64 v61, v[70:71] offset:56
    s_waitcnt lgkmcnt(0)
    s_barrier
    ds_read_b64 v[20:21], v9 offset:0
    ds_read_b64 v[54:55], v9 offset:1088
    ds_read_b64 v[30:31], v9 offset:2176
    ds_read_b64 v[78:79], v9 offset:3264
    ds_read_b64 v[36:37], v9 offset:4352
    ds_read_b64 v[76:77], v9 offset:5440
    ds_read_b64 v[56:57], v9 offset:6528
    ds_read_b64 v[32:33], v9 offset:7616
    ds_read_b64 v[100:101], v9 offset:8704
    ds_read_b64 v[64:65], v9 offset:9792
    ds_read_b64 v[92:93], v9 offset:10880
    ds_read_b64 v[58:59], v9 offset:11968
    ds_read_b64 v[18:19], v9 offset:13056
    ds_read_b64 v[42:43], v9 offset:14144
    ds_read_b64 v[60:61], v9 offset:15232
    ds_read_b64 v[12:13], v9 offset:16320
    v_and_b32 v22, 0x7, v0
    v_add_u32 v23, 0, v0
    v_cvt_f32_u32 v22, v22
    v_and_b32 v112, 0x7, v23
    v_mul_f32 v89, 0x3c000000, v22
    v_sub_u32 v23, v23, v112
    v_cos_f32 v88, v89
    v_sin_f32 v89, v89
    v_lshl_add_u32 v23, v23, 4, v112
    v_pk_mul_f32 v[118:119], v[88:89], v[88:89] op_sel:[0,0] op_sel_hi:[1,0]
    v_lshrrev_b32 v112, 4, v23
    v_pk_fma_f32 v[118:119], v[88:89], v[88:89], v[118:119] op_sel:[1,1,0] op_sel_hi:[0,1,1] neg_lo:[1,0,0]
    v_add_u32 v23, v23, v112
    v_pk_mul_f32 v[104:105], v[88:89], v[118:119] op_sel:[0,0] op_sel_hi:[1,0]
    v_pk_mul_f32 v[120:121], v[118:119], v[118:119] op_sel:[0,0] op_sel_hi:[1,0]
    v_lshl_add_u32 v23, v23, 3, v8
    v_pk_fma_f32 v[104:105], v[88:89], v[118:119], v[104:105] op_sel:[1,1,0] op_sel_hi:[0,1,1] neg_lo:[1,0,0]
    v_pk_fma_f32 v[120:121], v[118:119], v[118:119], v[120:121] op_sel:[1,1,0] op_sel_hi:[0,1,1] neg_lo:[1,0,0]
    v_pk_mul_f32 v[114:115], v[118:119], v[104:105] op_sel:[0,0] op_sel_hi:[1,0]
    v_pk_mul_f32 v[62:63], v[104:105], v[104:105] op_sel:[0,0] op_sel_hi:[1,0]
    v_pk_mul_f32 v[46:47], v[104:105], v[120:121] op_sel:[0,0] op_sel_hi:[1,0]
    v_pk_mul_f32 v[84:85], v[120:121], v[120:121] op_sel:[0,0] op_sel_hi:[1,0]
    v_pk_fma_f32 v[114:115], v[118:119], v[104:105], v[114:115] op_sel:[1,1,0] op_sel_hi:[0,1,1] neg_lo:[1,0,0]
    v_pk_fma_f32 v[62:63], v[104:105], v[104:105], v[62:63] op_sel:[1,1,0] op_sel_hi:[0,1,1] neg_lo:[1,0,0]
    v_pk_fma_f32 v[46:47], v[104:105], v[120:121], v[46:47] op_sel:[1,1,0] op_sel_hi:[0,1,1] neg_lo:[1,0,0]
    v_pk_fma_f32 v[84:85], v[120:121], v[120:121], v[84:85] op_sel:[1,1,0] op_sel_hi:[0,1,1] neg_lo:[1,0,0]
    v_pk_mul_f32 v[96:97], v[120:121], v[114:115] op_sel:[0,0] op_sel_hi:[1,0]
    v_pk_mul_f32 v[98:99], v[114:115], v[114:115] op_sel:[0,0] op_sel_hi:[1,0]
    v_pk_mul_f32 v[108:109], v[114:115], v[62:63] op_sel:[0,0] op_sel_hi:[1,0]
    v_pk_mul_f32 v[74:75], v[62:63], v[62:63] op_sel:[0,0] op_sel_hi:[1,0]
    v_pk_fma_f32 v[96:97], v[120:121], v[114:115], v[96:97] op_sel:[1,1,0] op_sel_hi:[0,1,1] neg_lo:[1,0,0]
    v_pk_fma_f32 v[98:99], v[114:115], v[114:115], v[98:99] op_sel:[1,1,0] op_sel_hi:[0,1,1] neg_lo:[1,0,0]
    v_pk_fma_f32 v[108:109], v[114:115], v[62:63], v[108:109] op_sel:[1,1,0] op_sel_hi:[0,1,1] neg_lo:[1,0,0]
    v_pk_fma_f32 v[74:75], v[62:63], v[62:63], v[74:75] op_sel:[1,1,0] op_sel_hi:[0,1,1] neg_lo:[1,0,0]
    v_pk_mul_f32 v[40:41], v[62:63], v[46:47] op_sel:[0,0] op_sel_hi:[1,0]
    v_pk_mul_f32 v[90:91], v[46:47], v[46:47] op_sel:[0,0] op_sel_hi:[1,0]
    v_pk_mul_f32 v[38:39], v[46:47], v[84:85] op_sel:[0,0] op_sel_hi:[1,0]
    v_pk_fma_f32 v[40:41], v[62:63], v[46:47], v[40:41] op_sel:[1,1,0] op_sel_hi:[0,1,1] neg_lo:[1,0,0]
    v_pk_fma_f32 v[90:91], v[46:47], v[46:47], v[90:91] op_sel:[1,1,0] op_sel_hi:[0,1,1] neg_lo:[1,0,0]
    v_pk_fma_f32 v[38:39], v[46:47], v[84:85], v[38:39] op_sel:[1,1,0] op_sel_hi:[0,1,1] neg_lo:[1,0,0]
    s_waitcnt lgkmcnt(0)
    v_pk_mul_f32 v[26:27], v[54:55], v[88:89] op_sel:[0,0] op_sel_hi:[1,0]
    v_pk_mul_f32 v[68:69], v[30:31], v[118:119] op_sel:[0,0] op_sel_hi:[1,0]
    v_pk_mul_f32 v[94:95], v[78:79], v[104:105] op_sel:[0,0] op_sel_hi:[1,0]
    v_pk_mul_f32 v[28:29], v[36:37], v[120:121] op_sel:[0,0] op_sel_hi:[1,0]
    v_pk_fma_f32 v[26:27], v[54:55], v[88:89], v[26:27] op_sel:[1,1,0] op_sel_hi:[0,1,1] neg_lo:[1,0,0]
    v_pk_fma_f32 v[68:69], v[30:31], v[118:119], v[68:69] op_sel:[1,1,0] op_sel_hi:[0,1,1] neg_lo:[1,0,0]
    v_pk_fma_f32 v[94:95], v[78:79], v[104:105], v[94:95] op_sel:[1,1,0] op_sel_hi:[0,1,1] neg_lo:[1,0,0]
    v_pk_fma_f32 v[28:29], v[36:37], v[120:121], v[28:29] op_sel:[1,1,0] op_sel_hi:[0,1,1] neg_lo:[1,0,0]
    v_pk_mul_f32 v[106:107], v[76:77], v[114:115] op_sel:[0,0] op_sel_hi:[1,0]
    v_pk_mul_f32 v[66:67], v[56:57], v[62:63] op_sel:[0,0] op_sel_hi:[1,0]
    v_pk_mul_f32 v[82:83], v[32:33], v[46:47] op_sel:[0,0] op_sel_hi:[1,0]
    v_pk_mul_f32 v[80:81], v[100:101], v[84:85] op_sel:[0,0] op_sel_hi:[1,0]
    v_pk_fma_f32 v[106:107], v[76:77], v[114:115], v[106:107] op_sel:[1,1,0] op_sel_hi:[0,1,1] neg_lo:[1,0,0]
    v_pk_fma_f32 v[66:67], v[56:57], v[62:63], v[66:67] op_sel:[1,1,0] op_sel_hi:[0,1,1] neg_lo:[1,0,0]
    v_pk_fma_f32 v[82:83], v[32:33], v[46:47], v[82:83] op_sel:[1,1,0] op_sel_hi:[0,1,1] neg_lo:[1,0,0]
    v_pk_fma_f32 v[80:81], v[100:101], v[84:85], v[80:81] op_sel:[1,1,0] op_sel_hi:[0,1,1] neg_lo:[1,0,0]
    v_pk_mul_f32 v[44:45], v[64:65], v[96:97] op_sel:[0,0] op_sel_hi:[1,0]
    v_pk_mul_f32 v[110:111], v[92:93], v[98:99] op_sel:[0,0] op_sel_hi:[1,0]
    v_pk_mul_f32 v[102:103], v[58:59], v[108:109] op_sel:[0,0] op_sel_hi:[1,0]
    v_pk_mul_f32 v[116:117], v[18:19], v[74:75] op_sel:[0,0] op_sel_hi:[1,0]
    v_pk_fma_f32 v[44:45], v[64:65], v[96:97], v[44:45] op_sel:[1,1,0] op_sel_hi:[0,1,1] neg_lo:[1,0,0]
    v_pk_fma_f32 v[110:111], v[92:93], v[98:99], v[110:111] op_sel:[1,1,0] op_sel_hi:[0,1,1] neg_lo:[1,0,0]
    v_pk_fma_f32 v[102:103], v[58:59], v[108:109], v[102:103] op_sel:[1,1,0] op_sel_hi:[0,1,1] neg_lo:[1,0,0]
    v_pk_fma_f32 v[116:117], v[18:19], v[74:75], v[116:117] op_sel:[1,1,0] op_sel_hi:[0,1,1] neg_lo:[1,0,0]
    v_pk_mul_f32 v[122:123], v[42:43], v[40:41] op_sel:[0,0] op_sel_hi:[1,0]
    v_pk_mul_f32 v[48:49], v[60:61], v[90:91] op_sel:[0,0] op_sel_hi:[1,0]
    v_pk_mul_f32 v[24:25], v[12:13], v[38:39] op_sel:[0,0] op_sel_hi:[1,0]
    v_pk_add_f32 v[34:35], v[20:21], v[80:81] neg_lo:[0,1] neg_hi:[0,1]
    v_pk_fma_f32 v[122:123], v[42:43], v[40:41], v[122:123] op_sel:[1,1,0] op_sel_hi:[0,1,1] neg_lo:[1,0,0]
    v_pk_fma_f32 v[48:49], v[60:61], v[90:91], v[48:49] op_sel:[1,1,0] op_sel_hi:[0,1,1] neg_lo:[1,0,0]
    v_pk_fma_f32 v[24:25], v[12:13], v[38:39], v[24:25] op_sel:[1,1,0] op_sel_hi:[0,1,1] neg_lo:[1,0,0]
    v_pk_add_f32 v[20:21], v[20:21], v[80:81]
    v_pk_add_f32 v[72:73], v[28:29], v[116:117] neg_lo:[0,1] neg_hi:[0,1]
    v_pk_add_f32 v[28:29], v[28:29], v[116:117]
    v_pk_add_f32 v[52:53], v[68:69], v[110:111] neg_lo:[0,1] neg_hi:[0,1]
    v_pk_add_f32 v[68:69], v[68:69], v[110:111]
    v_pk_add_f32 v[50:51], v[34:35], v[72:73] op_sel:[0,1] op_sel_hi:[1,0] neg_hi:[0,1]
    v_pk_add_f32 v[86:87], v[20:21], v[28:29] neg_lo:[0,1] neg_hi:[0,1]
    v_pk_add_f32 v[20:21], v[20:21], v[28:29]
    v_pk_add_f32 v[34:35], v[34:35], v[72:73] op_sel:[0,1] op_sel_hi:[1,0] neg_lo:[0,1]
    v_pk_add_f32 v[14:15], v[66:67], v[48:49] neg_lo:[0,1] neg_hi:[0,1]
    v_pk_add_f32 v[66:67], v[66:67], v[48:49]
    v_pk_add_f32 v[118:119], v[26:27], v[44:45] neg_lo:[0,1] neg_hi:[0,1]
    v_pk_add_f32 v[26:27], v[26:27], v[44:45]
    v_pk_add_f32 v[70:71], v[52:53], v[14:15] op_sel:[0,1] op_sel_hi:[1,0] neg_hi:[0,1]
    v_pk_add_f32 v[16:17], v[68:69], v[66:67] neg_lo:[0,1] neg_hi:[0,1]
    v_pk_add_f32 v[68:69], v[68:69], v[66:67]
    v_pk_add_f32 v[52:53], v[52:53], v[14:15] op_sel:[0,1] op_sel_hi:[1,0] neg_lo:[0,1]
    v_pk_add_f32 v[30:31], v[70:71], v[70:71] op_sel:[0,1] op_sel_hi:[1,0] neg_lo:[1,1] neg_hi:[1,0]
    v_pk_add_f32 v[88:89], v[86:87], v[16:17] op_sel:[0,1] op_sel_hi:[1,0] neg_hi:[0,1]
    v_pk_add_f32 v[112:113], v[20:21], v[68:69] neg_lo:[0,1] neg_hi:[0,1]
    v_pk_add_f32 v[20:21], v[20:21], v[68:69]
    v_pk_add_f32 v[54:55], v[52:53], v[52:53] op_sel:[0,1] op_sel_hi:[1,0] neg_lo:[0,1] neg_hi:[0,0]
    v_pk_add_f32 v[86:87], v[86:87], v[16:17] op_sel:[0,1] op_sel_hi:[1,0] neg_lo:[0,1]
    v_pk_fma_f32 v[70:71], v[30:31], s[36:37], v[50:51] neg_lo:[1,0,0] neg_hi:[1,0,0]
    v_pk_fma_f32 v[50:51], v[30:31], s[36:37], v[50:51]
    v_pk_fma_f32 v[52:53], v[54:55], s[36:37], v[34:35] neg_lo:[1,0,0] neg_hi:[1,0,0]
    v_pk_fma_f32 v[34:35], v[54:55], s[36:37], v[34:35]
    v_pk_add_f32 v[78:79], v[106:107], v[122:123] neg_lo:[0,1] neg_hi:[0,1]
    v_pk_add_f32 v[106:107], v[106:107], v[122:123]
    v_pk_add_f32 v[120:121], v[94:95], v[102:103] neg_lo:[0,1] neg_hi:[0,1]
    v_pk_add_f32 v[94:95], v[94:95], v[102:103]
    v_pk_add_f32 v[36:37], v[118:119], v[78:79] op_sel:[0,1] op_sel_hi:[1,0] neg_hi:[0,1]
    v_pk_add_f32 v[104:105], v[26:27], v[106:107] neg_lo:[0,1] neg_hi:[0,1]
    v_pk_add_f32 v[26:27], v[26:27], v[106:107]
    v_pk_add_f32 v[118:119], v[118:119], v[78:79] op_sel:[0,1] op_sel_hi:[1,0] neg_lo:[0,1]
    v_pk_add_f32 v[76:77], v[82:83], v[24:25] neg_lo:[0,1] neg_hi:[0,1]
    v_pk_add_f32 v[82:83], v[82:83], v[24:25]
    v_pk_add_f32 v[56:57], v[120:121], v[76:77] op_sel:[0,1] op_sel_hi:[1,0] neg_hi:[0,1]
    v_pk_add_f32 v[120:121], v[120:121], v[76:77] op_sel:[0,1] op_sel_hi:[1,0] neg_lo:[0,1]
    v_pk_add_f32 v[114:115], v[94:95], v[82:83] neg_lo:[0,1] neg_hi:[0,1]
    v_pk_add_f32 v[94:95], v[94:95], v[82:83]
    v_pk_add_f32 v[100:101], v[56:57], v[56:57] op_sel:[0,1] op_sel_hi:[1,0] neg_lo:[1,1] neg_hi:[1,0]
    v_pk_add_f32 v[32:33], v[120:121], v[120:121] op_sel:[0,1] op_sel_hi:[1,0] neg_lo:[0,1] neg_hi:[0,0]
    v_pk_add_f32 v[46:47], v[104:105], v[114:115] op_sel:[0,1] op_sel_hi:[1,0] neg_hi:[0,1]
    v_pk_add_f32 v[62:63], v[26:27], v[94:95] neg_lo:[0,1] neg_hi:[0,1]
    v_pk_add_f32 v[26:27], v[26:27], v[94:95]
    v_pk_fma_f32 v[120:121], v[32:33], s[36:37], v[118:119] neg_lo:[1,0,0] neg_hi:[1,0,0]
    v_pk_fma_f32 v[118:119], v[32:33], s[36:37], v[118:119]
    v_pk_add_f32 v[104:105], v[104:105], v[114:115] op_sel:[0,1] op_sel_hi:[1,0] neg_lo:[0,1]
    v_pk_fma_f32 v[56:57], v[100:101], s[36:37], v[36:37] neg_lo:[1,0,0] neg_hi:[1,0,0]
    v_pk_fma_f32 v[36:37], v[100:101], s[36:37], v[36:37]
    v_pk_add_f32 v[84:85], v[20:21], v[26:27] neg_lo:[0,1] neg_hi:[0,1]
    v_pk_add_f32 v[20:21], v[20:21], v[26:27]
    v_pk_mul_f32 v[64:65], v[118:119], s[38:39] op_sel:[0,0] op_sel_hi:[1,0] neg_lo:[0,0] neg_hi:[0,0]
    v_pk_add_f32 v[96:97], v[104:105], v[104:105] op_sel:[0,1] op_sel_hi:[1,0] neg_lo:[0,1] neg_hi:[0,0]
    v_pk_mul_f32 v[92:93], v[36:37], s[38:39] op_sel:[0,1] op_sel_hi:[1,1] neg_lo:[0,0] neg_hi:[0,0]
    v_pk_add_f32 v[98:99], v[112:113], v[62:63] op_sel:[0,1] op_sel_hi:[1,0] neg_hi:[0,1]
    v_pk_fma_f32 v[64:65], v[118:119], s[38:39], v[64:65] op_sel:[1,1,0] op_sel_hi:[0,1,1] neg_lo:[1,0,0] neg_hi:[0,0,0]
    v_pk_fma_f32 v[104:105], v[96:97], s[36:37], v[86:87] neg_lo:[1,0,0] neg_hi:[1,0,0]
    v_pk_fma_f32 v[86:87], v[96:97], s[36:37], v[86:87]
    v_pk_fma_f32 v[92:93], v[36:37], s[38:39], v[92:93] op_sel:[1,0,0] op_sel_hi:[0,0,1] neg_lo:[1,0,0] neg_hi:[0,0,0]
    v_pk_add_f32 v[118:119], v[34:35], v[64:65] neg_lo:[0,1] neg_hi:[0,1]
    v_pk_add_f32 v[34:35], v[34:35], v[64:65]
    v_pk_add_f32 v[112:113], v[112:113], v[62:63] op_sel:[0,1] op_sel_hi:[1,0] neg_lo:[0,1]
    v_pk_add_f32 v[36:37], v[50:51], v[92:93] neg_lo:[0,1] neg_hi:[0,1]
    v_pk_add_f32 v[50:51], v[50:51], v[92:93]
    v_pk_mul_f32 v[58:59], v[120:121], s[38:39] op_sel:[0,1] op_sel_hi:[1,1] neg_lo:[0,1] neg_hi:[0,1]
    v_pk_add_f32 v[108:109], v[46:47], v[46:47] op_sel:[0,1] op_sel_hi:[1,0] neg_lo:[1,1] neg_hi:[1,0]
    v_pk_mul_f32 v[18:19], v[56:57], s[38:39] op_sel:[0,0] op_sel_hi:[1,0] neg_lo:[0,1] neg_hi:[0,1]
    ds_write_b64 v23, v[20:21] offset:17408
    v_pk_fma_f32 v[58:59], v[120:121], s[38:39], v[58:59] op_sel:[1,0,0] op_sel_hi:[0,0,1] neg_lo:[1,0,0] neg_hi:[0,0,0]
    v_pk_fma_f32 v[46:47], v[108:109], s[36:37], v[88:89] neg_lo:[1,0,0] neg_hi:[1,0,0]
    v_pk_fma_f32 v[88:89], v[108:109], s[36:37], v[88:89]
    v_pk_fma_f32 v[18:19], v[56:57], s[38:39], v[18:19] op_sel:[1,1,0] op_sel_hi:[0,1,1] neg_lo:[1,0,0] neg_hi:[0,0,0]
    v_pk_add_f32 v[120:121], v[52:53], v[58:59] neg_lo:[0,1] neg_hi:[0,1]
    v_pk_add_f32 v[52:53], v[52:53], v[58:59]
    ds_write_b64 v23, v[34:35] offset:17472
    v_pk_add_f32 v[56:57], v[70:71], v[18:19] neg_lo:[0,1] neg_hi:[0,1]
    v_pk_add_f32 v[70:71], v[70:71], v[18:19]
    ds_write_b64 v23, v[86:87] offset:17544
    ds_write_b64 v23, v[50:51] offset:17608
    ds_write_b64 v23, v[112:113] offset:17680
    ds_write_b64 v23, v[52:53] offset:17744
    ds_write_b64 v23, v[88:89] offset:17816
    ds_write_b64 v23, v[70:71] offset:17880
    ds_write_b64 v23, v[84:85] offset:17952
    ds_write_b64 v23, v[118:119] offset:18016
    ds_write_b64 v23, v[104:105] offset:18088
    ds_write_b64 v23, v[36:37] offset:18152
    ds_write_b64 v23, v[98:99] offset:18224
    ds_write_b64 v23, v[120:121] offset:18288
    ds_write_b64 v23, v[46:47] offset:18360
    ds_write_b64 v23, v[56:57] offset:18424
    s_waitcnt lgkmcnt(0)
    s_barrier
    ds_read_b64 v[22:23], v9 offset:17408
    ds_read_b64 v[74:75], v9 offset:18496
    ds_read_b64 v[42:43], v9 offset:19584
    ds_read_b64 v[40:41], v9 offset:20672
    ds_read_b64 v[60:61], v9 offset:21760
    ds_read_b64 v[90:91], v9 offset:22848
    ds_read_b64 v[12:13], v9 offset:23936
    ds_read_b64 v[38:39], v9 offset:25024
    ds_read_b64 v[80:81], v9 offset:26112
    ds_read_b64 v[116:117], v9 offset:27200
    ds_read_b64 v[28:29], v9 offset:28288
    ds_read_b64 v[72:73], v9 offset:29376
    ds_read_b64 v[110:111], v9 offset:30464
    ds_read_b64 v[48:49], v9 offset:31552
    ds_read_b64 v[66:67], v9 offset:32640
    ds_read_b64 v[14:15], v9 offset:33728
    v_and_b32 v11, 0x7f, v0
    v_cvt_f32_u32 v11, v11
    v_mul_f32 v69, 0x3a000000, v11
    v_cos_f32 v68, v69
    v_sin_f32 v69, v69
    s_nop 0
    v_pk_mul_f32 v[54:55], v[68:69], v[68:69] op_sel:[0,0] op_sel_hi:[1,0]
    v_pk_fma_f32 v[54:55], v[68:69], v[68:69], v[54:55] op_sel:[1,1,0] op_sel_hi:[0,1,1] neg_lo:[1,0,0]
    v_pk_mul_f32 v[16:17], v[68:69], v[54:55] op_sel:[0,0] op_sel_hi:[1,0]
    v_pk_mul_f32 v[30:31], v[54:55], v[54:55] op_sel:[0,0] op_sel_hi:[1,0]
    v_pk_fma_f32 v[16:17], v[68:69], v[54:55], v[16:17] op_sel:[1,1,0] op_sel_hi:[0,1,1] neg_lo:[1,0,0]
    v_pk_fma_f32 v[30:31], v[54:55], v[54:55], v[30:31] op_sel:[1,1,0] op_sel_hi:[0,1,1] neg_lo:[1,0,0]
    v_pk_mul_f32 v[44:45], v[54:55], v[16:17] op_sel:[0,0] op_sel_hi:[1,0]
    v_pk_mul_f32 v[122:123], v[16:17], v[16:17] op_sel:[0,0] op_sel_hi:[1,0]
    v_pk_mul_f32 v[106:107], v[16:17], v[30:31] op_sel:[0,0] op_sel_hi:[1,0]
    v_pk_mul_f32 v[78:79], v[30:31], v[30:31] op_sel:[0,0] op_sel_hi:[1,0]
    v_pk_fma_f32 v[44:45], v[54:55], v[16:17], v[44:45] op_sel:[1,1,0] op_sel_hi:[0,1,1] neg_lo:[1,0,0]
    v_pk_fma_f32 v[122:123], v[16:17], v[16:17], v[122:123] op_sel:[1,1,0] op_sel_hi:[0,1,1] neg_lo:[1,0,0]
    v_pk_fma_f32 v[106:107], v[16:17], v[30:31], v[106:107] op_sel:[1,1,0] op_sel_hi:[0,1,1] neg_lo:[1,0,0]
    v_pk_fma_f32 v[78:79], v[30:31], v[30:31], v[78:79] op_sel:[1,1,0] op_sel_hi:[0,1,1] neg_lo:[1,0,0]
    v_pk_mul_f32 v[102:103], v[30:31], v[44:45] op_sel:[0,0] op_sel_hi:[1,0]
    v_pk_mul_f32 v[24:25], v[44:45], v[44:45] op_sel:[0,0] op_sel_hi:[1,0]
    v_pk_mul_f32 v[82:83], v[44:45], v[122:123] op_sel:[0,0] op_sel_hi:[1,0]
    v_pk_mul_f32 v[76:77], v[122:123], v[122:123] op_sel:[0,0] op_sel_hi:[1,0]
    v_pk_fma_f32 v[102:103], v[30:31], v[44:45], v[102:103] op_sel:[1,1,0] op_sel_hi:[0,1,1] neg_lo:[1,0,0]
    v_pk_fma_f32 v[24:25], v[44:45], v[44:45], v[24:25] op_sel:[1,1,0] op_sel_hi:[0,1,1] neg_lo:[1,0,0]
    v_pk_fma_f32 v[82:83], v[44:45], v[122:123], v[82:83] op_sel:[1,1,0] op_sel_hi:[0,1,1] neg_lo:[1,0,0]
    v_pk_fma_f32 v[76:77], v[122:123], v[122:123], v[76:77] op_sel:[1,1,0] op_sel_hi:[0,1,1] neg_lo:[1,0,0]
    v_pk_mul_f32 v[94:95], v[122:123], v[106:107] op_sel:[0,0] op_sel_hi:[1,0]
    v_pk_mul_f32 v[32:33], v[106:107], v[106:107] op_sel:[0,0] op_sel_hi:[1,0]
    v_pk_mul_f32 v[114:115], v[106:107], v[78:79] op_sel:[0,0] op_sel_hi:[1,0]
    v_pk_fma_f32 v[94:95], v[122:123], v[106:107], v[94:95] op_sel:[1,1,0] op_sel_hi:[0,1,1] neg_lo:[1,0,0]
    v_pk_fma_f32 v[32:33], v[106:107], v[106:107], v[32:33] op_sel:[1,1,0] op_sel_hi:[0,1,1] neg_lo:[1,0,0]
    v_pk_fma_f32 v[114:115], v[106:107], v[78:79], v[114:115] op_sel:[1,1,0] op_sel_hi:[0,1,1] neg_lo:[1,0,0]
    s_waitcnt lgkmcnt(0)
    v_pk_mul_f32 v[100:101], v[74:75], v[68:69] op_sel:[0,0] op_sel_hi:[1,0]
    v_pk_mul_f32 v[26:27], v[42:43], v[54:55] op_sel:[0,0] op_sel_hi:[1,0]
    v_pk_mul_f32 v[64:65], v[40:41], v[16:17] op_sel:[0,0] op_sel_hi:[1,0]
    v_pk_mul_f32 v[96:97], v[60:61], v[30:31] op_sel:[0,0] op_sel_hi:[1,0]
    v_pk_fma_f32 v[100:101], v[74:75], v[68:69], v[100:101] op_sel:[1,1,0] op_sel_hi:[0,1,1] neg_lo:[1,0,0]
    v_pk_fma_f32 v[26:27], v[42:43], v[54:55], v[26:27] op_sel:[1,1,0] op_sel_hi:[0,1,1] neg_lo:[1,0,0]
    v_pk_fma_f32 v[64:65], v[40:41], v[16:17], v[64:65] op_sel:[1,1,0] op_sel_hi:[0,1,1] neg_lo:[1,0,0]
    v_pk_fma_f32 v[96:97], v[60:61], v[30:31], v[96:97] op_sel:[1,1,0] op_sel_hi:[0,1,1] neg_lo:[1,0,0]
    v_pk_mul_f32 v[92:93], v[90:91], v[44:45] op_sel:[0,0] op_sel_hi:[1,0]
    v_pk_mul_f32 v[62:63], v[12:13], v[122:123] op_sel:[0,0] op_sel_hi:[1,0]
    v_pk_mul_f32 v[58:59], v[38:39], v[106:107] op_sel:[0,0] op_sel_hi:[1,0]
    v_pk_mul_f32 v[108:109], v[80:81], v[78:79] op_sel:[0,0] op_sel_hi:[1,0]
    v_pk_fma_f32 v[92:93], v[90:91], v[44:45], v[92:93] op_sel:[1,1,0] op_sel_hi:[0,1,1] neg_lo:[1,0,0]
    v_pk_fma_f32 v[62:63], v[12:13], v[122:123], v[62:63] op_sel:[1,1,0] op_sel_hi:[0,1,1] neg_lo:[1,0,0]
    v_pk_fma_f32 v[58:59], v[38:39], v[106:107], v[58:59] op_sel:[1,1,0] op_sel_hi:[0,1,1] neg_lo:[1,0,0]
    v_pk_fma_f32 v[108:109], v[80:81], v[78:79], v[108:109] op_sel:[1,1,0] op_sel_hi:[0,1,1] neg_lo:[1,0,0]
    v_pk_mul_f32 v[18:19], v[116:117], v[102:103] op_sel:[0,0] op_sel_hi:[1,0]
    v_pk_mul_f32 v[20:21], v[28:29], v[24:25] op_sel:[0,0] op_sel_hi:[1,0]
    v_pk_mul_f32 v[34:35], v[72:73], v[82:83] op_sel:[0,0] op_sel_hi:[1,0]
    v_pk_mul_f32 v[86:87], v[110:111], v[76:77] op_sel:[0,0] op_sel_hi:[1,0]
    v_pk_fma_f32 v[18:19], v[116:117], v[102:103], v[18:19] op_sel:[1,1,0] op_sel_hi:[0,1,1] neg_lo:[1,0,0]
    v_pk_fma_f32 v[20:21], v[28:29], v[24:25], v[20:21] op_sel:[1,1,0] op_sel_hi:[0,1,1] neg_lo:[1,0,0]
    v_pk_fma_f32 v[34:35], v[72:73], v[82:83], v[34:35] op_sel:[1,1,0] op_sel_hi:[0,1,1] neg_lo:[1,0,0]
    v_pk_fma_f32 v[86:87], v[110:111], v[76:77], v[86:87] op_sel:[1,1,0] op_sel_hi:[0,1,1] neg_lo:[1,0,0]
    v_pk_mul_f32 v[50:51], v[48:49], v[94:95] op_sel:[0,0] op_sel_hi:[1,0]
    v_pk_mul_f32 v[112:113], v[66:67], v[32:33] op_sel:[0,0] op_sel_hi:[1,0]
    v_pk_mul_f32 v[52:53], v[14:15], v[114:115] op_sel:[0,0] op_sel_hi:[1,0]
    v_pk_add_f32 v[88:89], v[22:23], v[108:109] neg_lo:[0,1] neg_hi:[0,1]
    v_pk_fma_f32 v[50:51], v[48:49], v[94:95], v[50:51] op_sel:[1,1,0] op_sel_hi:[0,1,1] neg_lo:[1,0,0]
    v_pk_fma_f32 v[112:113], v[66:67], v[32:33], v[112:113] op_sel:[1,1,0] op_sel_hi:[0,1,1] neg_lo:[1,0,0]
    v_pk_fma_f32 v[52:53], v[14:15], v[114:115], v[52:53] op_sel:[1,1,0] op_sel_hi:[0,1,1] neg_lo:[1,0,0]
    v_pk_add_f32 v[22:23], v[22:23], v[108:109]
    v_pk_add_f32 v[70:71], v[96:97], v[86:87] neg_lo:[0,1] neg_hi:[0,1]
    v_pk_add_f32 v[96:97], v[96:97], v[86:87]
    v_pk_add_f32 v[104:105], v[26:27], v[20:21] neg_lo:[0,1] neg_hi:[0,1]
    v_pk_add_f32 v[26:27], v[26:27], v[20:21]
    v_pk_add_f32 v[118:119], v[88:89], v[70:71] op_sel:[0,1] op_sel_hi:[1,0] neg_hi:[0,1]
    v_pk_add_f32 v[84:85], v[22:23], v[96:97] neg_lo:[0,1] neg_hi:[0,1]
    v_pk_add_f32 v[22:23], v[22:23], v[96:97]
    v_pk_add_f32 v[88:89], v[88:89], v[70:71] op_sel:[0,1] op_sel_hi:[1,0] neg_lo:[0,1]
    v_pk_add_f32 v[36:37], v[62:63], v[112:113] neg_lo:[0,1] neg_hi:[0,1]
    v_pk_add_f32 v[62:63], v[62:63], v[112:113]
    v_pk_add_f32 v[42:43], v[100:101], v[18:19] neg_lo:[0,1] neg_hi:[0,1]
    v_pk_add_f32 v[100:101], v[100:101], v[18:19]
    v_pk_add_f32 v[120:121], v[104:105], v[36:37] op_sel:[0,1] op_sel_hi:[1,0] neg_hi:[0,1]
    v_pk_add_f32 v[98:99], v[26:27], v[62:63] neg_lo:[0,1] neg_hi:[0,1]
    v_pk_add_f32 v[26:27], v[26:27], v[62:63]
    v_pk_add_f32 v[104:105], v[104:105], v[36:37] op_sel:[0,1] op_sel_hi:[1,0] neg_lo:[0,1]
    v_pk_add_f32 v[68:69], v[120:121], v[120:121] op_sel:[0,1] op_sel_hi:[1,0] neg_lo:[1,1] neg_hi:[1,0]
    v_pk_add_f32 v[74:75], v[84:85], v[98:99] op_sel:[0,1] op_sel_hi:[1,0] neg_hi:[0,1]
    v_pk_add_f32 v[46:47], v[22:23], v[26:27] neg_lo:[0,1] neg_hi:[0,1]
    v_pk_add_f32 v[22:23], v[22:23], v[26:27]
    v_pk_add_f32 v[56:57], v[104:105], v[104:105] op_sel:[0,1] op_sel_hi:[1,0] neg_lo:[0,1] neg_hi:[0,0]
    v_pk_add_f32 v[84:85], v[84:85], v[98:99] op_sel:[0,1] op_sel_hi:[1,0] neg_lo:[0,1]
    v_pk_fma_f32 v[120:121], v[68:69], s[36:37], v[118:119] neg_lo:[1,0,0] neg_hi:[1,0,0]
    v_pk_fma_f32 v[118:119], v[68:69], s[36:37], v[118:119]
    v_pk_fma_f32 v[104:105], v[56:57], s[36:37], v[88:89] neg_lo:[1,0,0] neg_hi:[1,0,0]
    v_pk_fma_f32 v[88:89], v[56:57], s[36:37], v[88:89]
    v_pk_add_f32 v[54:55], v[92:93], v[50:51] neg_lo:[0,1] neg_hi:[0,1]
    v_pk_add_f32 v[92:93], v[92:93], v[50:51]
    v_pk_add_f32 v[60:61], v[64:65], v[34:35] neg_lo:[0,1] neg_hi:[0,1]
    v_pk_add_f32 v[64:65], v[64:65], v[34:35]
    v_pk_add_f32 v[16:17], v[42:43], v[54:55] op_sel:[0,1] op_sel_hi:[1,0] neg_hi:[0,1]
    v_pk_add_f32 v[40:41], v[100:101], v[92:93] neg_lo:[0,1] neg_hi:[0,1]
    v_pk_add_f32 v[100:101], v[100:101], v[92:93]
    v_pk_add_f32 v[42:43], v[42:43], v[54:55] op_sel:[0,1] op_sel_hi:[1,0] neg_lo:[0,1]
    v_pk_add_f32 v[30:31], v[58:59], v[52:53] neg_lo:[0,1] neg_hi:[0,1]
    v_pk_add_f32 v[58:59], v[58:59], v[52:53]
    v_pk_add_f32 v[44:45], v[60:61], v[30:31] op_sel:[0,1] op_sel_hi:[1,0] neg_hi:[0,1]
    v_pk_add_f32 v[60:61], v[60:61], v[30:31] op_sel:[0,1] op_sel_hi:[1,0] neg_lo:[0,1]
    v_pk_add_f32 v[90:91], v[64:65], v[58:59] neg_lo:[0,1] neg_hi:[0,1]
    v_pk_add_f32 v[64:65], v[64:65], v[58:59]
    v_pk_add_f32 v[106:107], v[44:45], v[44:45] op_sel:[0,1] op_sel_hi:[1,0] neg_lo:[1,1] neg_hi:[1,0]
    v_pk_add_f32 v[122:123], v[60:61], v[60:61] op_sel:[0,1] op_sel_hi:[1,0] neg_lo:[0,1] neg_hi:[0,0]
    v_pk_add_f32 v[38:39], v[40:41], v[90:91] op_sel:[0,1] op_sel_hi:[1,0] neg_hi:[0,1]
    v_pk_add_f32 v[12:13], v[100:101], v[64:65] neg_lo:[0,1] neg_hi:[0,1]
    v_pk_add_f32 v[100:101], v[100:101], v[64:65]
    v_pk_fma_f32 v[60:61], v[122:123], s[36:37], v[42:43] neg_lo:[1,0,0] neg_hi:[1,0,0]
    v_pk_fma_f32 v[42:43], v[122:123], s[36:37], v[42:43]
    v_pk_add_f32 v[40:41], v[40:41], v[90:91] op_sel:[0,1] op_sel_hi:[1,0] neg_lo:[0,1]
    v_pk_fma_f32 v[44:45], v[106:107], s[36:37], v[16:17] neg_lo:[1,0,0] neg_hi:[1,0,0]
    v_pk_fma_f32 v[16:17], v[106:107], s[36:37], v[16:17]
    v_pk_add_f32 v[80:81], v[22:23], v[100:101] neg_lo:[0,1] neg_hi:[0,1]
    v_pk_add_f32 v[22:23], v[22:23], v[100:101]
    v_pk_mul_f32 v[78:79], v[42:43], s[38:39] op_sel:[0,0] op_sel_hi:[1,0] neg_lo:[0,0] neg_hi:[0,0]
    v_pk_add_f32 v[116:117], v[40:41], v[40:41] op_sel:[0,1] op_sel_hi:[1,0] neg_lo:[0,1] neg_hi:[0,0]
    v_pk_mul_f32 v[102:103], v[16:17], s[38:39] op_sel:[0,1] op_sel_hi:[1,1] neg_lo:[0,0] neg_hi:[0,0]
    v_pk_add_f32 v[28:29], v[46:47], v[12:13] op_sel:[0,1] op_sel_hi:[1,0] neg_hi:[0,1]
    v_pk_fma_f32 v[78:79], v[42:43], s[38:39], v[78:79] op_sel:[1,1,0] op_sel_hi:[0,1,1] neg_lo:[1,0,0] neg_hi:[0,0,0]
    v_pk_fma_f32 v[40:41], v[116:117], s[36:37], v[84:85] neg_lo:[1,0,0] neg_hi:[1,0,0]
    v_pk_fma_f32 v[84:85], v[116:117], s[36:37], v[84:85]
    v_pk_fma_f32 v[102:103], v[16:17], s[38:39], v[102:103] op_sel:[1,0,0] op_sel_hi:[0,0,1] neg_lo:[1,0,0] neg_hi:[0,0,0]
    v_pk_add_f32 v[42:43], v[88:89], v[78:79] neg_lo:[0,1] neg_hi:[0,1]
    v_pk_add_f32 v[88:89], v[88:89], v[78:79]
    v_pk_add_f32 v[46:47], v[46:47], v[12:13] op_sel:[0,1] op_sel_hi:[1,0] neg_lo:[0,1]
    v_pk_add_f32 v[16:17], v[118:119], v[102:103] neg_lo:[0,1] neg_hi:[0,1]
    v_pk_add_f32 v[118:119], v[118:119], v[102:103]
    v_pk_mul_f32 v[24:25], v[60:61], s[38:39] op_sel:[0,1] op_sel_hi:[1,1] neg_lo:[0,1] neg_hi:[0,1]
    v_pk_add_f32 v[72:73], v[38:39], v[38:39] op_sel:[0,1] op_sel_hi:[1,0] neg_lo:[1,1] neg_hi:[1,0]
    v_pk_mul_f32 v[82:83], v[44:45], s[38:39] op_sel:[0,0] op_sel_hi:[1,0] neg_lo:[0,1] neg_hi:[0,1]
    v_pk_fma_f32 v[24:25], v[60:61], s[38:39], v[24:25] op_sel:[1,0,0] op_sel_hi:[0,0,1] neg_lo:[1,0,0] neg_hi:[0,0,0]
    v_pk_fma_f32 v[38:39], v[72:73], s[36:37], v[74:75] neg_lo:[1,0,0] neg_hi:[1,0,0]
    v_pk_fma_f32 v[74:75], v[72:73], s[36:37], v[74:75]
    v_pk_fma_f32 v[82:83], v[44:45], s[38:39], v[82:83] op_sel:[1,1,0] op_sel_hi:[0,1,1] neg_lo:[1,0,0] neg_hi:[0,0,0]
    v_pk_add_f32 v[60:61], v[104:105], v[24:25] neg_lo:[0,1] neg_hi:[0,1]
    v_pk_add_f32 v[104:105], v[104:105], v[24:25]
    v_pk_add_f32 v[44:45], v[120:121], v[82:83] neg_lo:[0,1] neg_hi:[0,1]
    v_pk_add_f32 v[120:121], v[120:121], v[82:83]
    s_add_u32 s5, s3, 0
    buffer_store_dwordx2 v[22:23], v10, s[28:31], s5 offen sc1
    s_add_u32 s5, s3, 1024
    buffer_store_dwordx2 v[88:89], v10, s[28:31], s5 offen sc1
    s_add_u32 s5, s3, 2048
    buffer_store_dwordx2 v[84:85], v10, s[28:31], s5 offen sc1
    s_add_u32 s5, s3, 3072
    buffer_store_dwordx2 v[118:119], v10, s[28:31], s5 offen sc1
    s_add_u32 s5, s3, 4096
    buffer_store_dwordx2 v[46:47], v10, s[28:31], s5 offen sc1
    s_add_u32 s5, s3, 5120
    buffer_store_dwordx2 v[104:105], v10, s[28:31], s5 offen sc1
    s_add_u32 s5, s3, 6144
    buffer_store_dwordx2 v[74:75], v10, s[28:31], s5 offen sc1
    s_add_u32 s5, s3, 7168
    buffer_store_dwordx2 v[120:121], v10, s[28:31], s5 offen sc1
    s_add_u32 s5, s3, 8192
    buffer_store_dwordx2 v[80:81], v10, s[28:31], s5 offen sc1
    s_add_u32 s5, s3, 9216
    buffer_store_dwordx2 v[42:43], v10, s[28:31], s5 offen sc1
    s_add_u32 s5, s3, 10240
    buffer_store_dwordx2 v[40:41], v10, s[28:31], s5 offen sc1
    s_add_u32 s5, s3, 11264
    buffer_store_dwordx2 v[16:17], v10, s[28:31], s5 offen sc1
    s_add_u32 s5, s3, 12288
    buffer_store_dwordx2 v[28:29], v10, s[28:31], s5 offen sc1
    s_add_u32 s5, s3, 13312
    buffer_store_dwordx2 v[60:61], v10, s[28:31], s5 offen sc1
    s_add_u32 s5, s3, 14336
    buffer_store_dwordx2 v[38:39], v10, s[28:31], s5 offen sc1
    s_add_u32 s5, s3, 15360
    buffer_store_dwordx2 v[44:45], v10, s[28:31], s5 offen sc1
    s_branch k2_end
k2_tr:
    s_mov_b32 s16, s10
    s_mov_b32 s17, s11
    s_mov_b32 s18, 0x700000
    s_mov_b32 s19, 0x00020000
    s_add_u32 s20, s12, 0x3800000
    s_addc_u32 s21, s13, 0
    s_mov_b32 s22, 0x700000
    s_mov_b32 s23, 0x00020000
    v_lshrrev_b32 v1, 6, v0
    s_nop 0
    v_readfirstlane_b32 s40, v1
    s_sub_u32 s41, s2, 513
    s_lshl_b32 s41, s41, 1
    s_add_u32 s41, s41, s40
    s_mov_b32 s60, 0x10000001
    s_mul_hi_u32 s61, s41, s60
    s_mul_i32 s62, s61, 16
    s_sub_u32 s62, s41, s62
    s_mul_i32 s63, s61, 131072
    s_lshl_b32 s64, s62, 7
    s_add_u32 s63, s63, s64
    s_mul_i32 s64, s62, 458752
    s_lshl_b32 s65, s61, 7
    s_add_u32 s64, s64, s65
    v_and_b32 v8, 63, v0
    v_and_b32 v9, 7, v8
    v_lshrrev_b32 v10, 3, v8
    v_mul_u32_u24 v11, 16384, v10
    v_lshl_add_u32 v11, v9, 4, v11
    v_mul_u32_u24 v12, 57344, v9
    v_lshl_add_u32 v12, v10, 4, v12
    s_add_u32 s65, s63, 0
    buffer_load_dwordx4 v[16:19], v11, s[16:19], s65 offen
    s_add_u32 s65, s63, 2048
    buffer_load_dwordx4 v[20:23], v11, s[16:19], s65 offen
    s_add_u32 s65, s63, 4096
    buffer_load_dwordx4 v[24:27], v11, s[16:19], s65 offen
    s_add_u32 s65, s63, 6144
    buffer_load_dwordx4 v[28:31], v11, s[16:19], s65 offen
    s_add_u32 s65, s63, 8192
    buffer_load_dwordx4 v[32:35], v11, s[16:19], s65 offen
    s_add_u32 s65, s63, 10240
    buffer_load_dwordx4 v[36:39], v11, s[16:19], s65 offen
    s_add_u32 s65, s63, 12288
    buffer_load_dwordx4 v[40:43], v11, s[16:19], s65 offen
    s_add_u32 s65, s63, 14336
    buffer_load_dwordx4 v[44:47], v11, s[16:19], s65 offen
    s_mov_b32 s66, 0x05040100
    s_mov_b32 s67, 0x07060302
    s_waitcnt vmcnt(0)
    v_perm_b32 v48, v20, v16, s66
    v_perm_b32 v49, v28, v24, s66
    v_perm_b32 v50, v36, v32, s66
    v_perm_b32 v51, v44, v40, s66
    v_perm_b32 v52, v20, v16, s67
    v_perm_b32 v53, v28, v24, s67
    v_perm_b32 v54, v36, v32, s67
    v_perm_b32 v55, v44, v40, s67
    v_perm_b32 v56, v21, v17, s66
    v_perm_b32 v57, v29, v25, s66
    v_perm_b32 v58, v37, v33, s66
    v_perm_b32 v59, v45, v41, s66
    v_perm_b32 v60, v21, v17, s67
    v_perm_b32 v61, v29, v25, s67
    v_perm_b32 v62, v37, v33, s67
    v_perm_b32 v63, v45, v41, s67
    v_perm_b32 v64, v22, v18, s66
    v_perm_b32 v65, v30, v26, s66
    v_perm_b32 v66, v38, v34, s66
    v_perm_b32 v67, v46, v42, s66
    v_perm_b32 v68, v22, v18, s67
    v_perm_b32 v69, v30, v26, s67
    v_perm_b32 v70, v38, v34, s67
    v_perm_b32 v71, v46, v42, s67
    v_perm_b32 v72, v23, v19, s66
    v_perm_b32 v73, v31, v27, s66
    v_perm_b32 v74, v39, v35, s66
    v_perm_b32 v75, v47, v43, s66
    v_perm_b32 v76, v23, v19, s67
    v_perm_b32 v77, v31, v27, s67
    v_perm_b32 v78, v39, v35, s67
    v_perm_b32 v79, v47, v43, s67
    s_add_u32 s65, s64, 0
    buffer_store_dwordx4 v[48:51], v12, s[20:23], s65 offen sc1
    s_add_u32 s65, s64, 7168
    buffer_store_dwordx4 v[52:55], v12, s[20:23], s65 offen sc1
    s_add_u32 s65, s64, 14336
    buffer_store_dwordx4 v[56:59], v12, s[20:23], s65 offen sc1
    s_add_u32 s65, s64, 21504
    buffer_store_dwordx4 v[60:63], v12, s[20:23], s65 offen sc1
    s_add_u32 s65, s64, 28672
    buffer_store_dwordx4 v[64:67], v12, s[20:23], s65 offen sc1
    s_add_u32 s65, s64, 35840
    buffer_store_dwordx4 v[68:71], v12, s[20:23], s65 offen sc1
    s_add_u32 s65, s64, 43008
    buffer_store_dwordx4 v[72:75], v12, s[20:23], s65 offen sc1
    s_add_u32 s65, s64, 50176
    buffer_store_dwordx4 v[76:79], v12, s[20:23], s65 offen sc1
k2_end:
    s_endpgm
.p2align 8
.globl k3_kernel
.type k3_kernel,@function
k3_kernel:
    s_cmp_ge_u32 s2, 480
    s_cbranch_scc1 k3_end
    s_load_dwordx2 s[4:5], s[0:1], 0
    s_load_dwordx2 s[10:11], s[0:1], 32
    s_load_dwordx2 s[12:13], s[0:1], 72
    s_waitcnt lgkmcnt(0)
    s_cmp_ge_u32 s2, 256
    s_cbranch_scc1 k3_tr
    s_mov_b32 s16, s4
    s_mov_b32 s17, s5
    s_mov_b32 s18, 0x400000
    s_mov_b32 s19, 0x00020000
    s_mov_b32 s28, s12
    s_mov_b32 s29, s13
    s_mov_b32 s30, 0x824100
    s_mov_b32 s31, 0x00020000
    s_add_u32 s20, s12, 0x1800000
    s_addc_u32 s21, s13, 0
    s_mov_b32 s22, 0x400000
    s_mov_b32 s23, 0x00020000
    s_add_u32 s24, s12, 0x1c00000
    s_addc_u32 s25, s13, 0
    s_mov_b32 s26, 0x400000
    s_mov_b32 s27, 0x00020000
    s_lshl_b32 s3, s2, 3
    v_and_b32 v1, 63, v0
    v_lshrrev_b32 v2, 6, v0
    v_lshrrev_b32 v24, 2, v0
    v_mul_u32_u24 v24, 16640, v24
    v_and_b32 v26, 3, v0
    v_lshl_add_u32 v24, v26, 4, v24
    v_lshlrev_b32 v25, 4, v0
    v_add_u32 v25, 34816, v25
    s_lshl_b32 s41, s3, 3
    s_add_u32 s42, s41, 0
    buffer_load_dwordx4 v[28:31], v24, s[28:31], s42 offen
    s_add_u32 s42, s41, 1064960
    buffer_load_dwordx4 v[32:35], v24, s[28:31], s42 offen
    s_add_u32 s42, s41, 2129920
    buffer_load_dwordx4 v[36:39], v24, s[28:31], s42 offen
    s_add_u32 s42, s41, 3194880
    buffer_load_dwordx4 v[40:43], v24, s[28:31], s42 offen
    s_add_u32 s42, s41, 4259840
    buffer_load_dwordx4 v[44:47], v24, s[28:31], s42 offen
    s_add_u32 s42, s41, 5324800
    buffer_load_dwordx4 v[48:51], v24, s[28:31], s42 offen
    s_add_u32 s42, s41, 6389760
    buffer_load_dwordx4 v[52:55], v24, s[28:31], s42 offen
    s_add_u32 s42, s41, 7454720
    buffer_load_dwordx4 v[56:59], v24, s[28:31], s42 offen
    v_cmp_gt_u32 vcc, 4, v0
    s_and_saveexec_b64 s[44:45], vcc
    s_cbranch_execz k3_s512
    s_add_u32 s42, s41, 8519680
    buffer_load_dwordx4 v[60:63], v24, s[28:31], s42 offen
    s_waitcnt vmcnt(0)
    ds_write_b128 v25, v[60:63] offset:32768
k3_s512:
    s_or_b64 exec, exec, s[44:45]
    v_lshlrev_b32 v3, 1, v2
    v_add_u32 v3, s3, v3
    v_lshlrev_b32 v3, 11, v3
    v_lshl_add_u32 v3, v1, 4, v3
    buffer_load_dwordx4 v[8:11], v3, s[16:19], 0 offen
    buffer_load_dwordx4 v[12:15], v3, s[16:19], 0 offen offset:1024
    buffer_load_dwordx4 v[16:19], v3, s[16:19], 0 offen offset:2048
    buffer_load_dwordx4 v[20:23], v3, s[16:19], 0 offen offset:3072
    s_waitcnt vmcnt(4)
    ds_write_b128 v25, v[28:31] offset:0
    ds_write_b128 v25, v[32:35] offset:4096
    ds_write_b128 v25, v[36:39] offset:8192
    ds_write_b128 v25, v[40:43] offset:12288
    ds_write_b128 v25, v[44:47] offset:16384
    ds_write_b128 v25, v[48:51] offset:20480
    ds_write_b128 v25, v[52:55] offset:24576
    ds_write_b128 v25, v[56:59] offset:28672
    s_mov_b32 s36, 0x3f3504f3
    s_mov_b32 s37, 0x3f3504f3
    s_mov_b32 s38, 0x3f6c835e
    s_mov_b32 s39, 0x3ec3ef15
    v_mul_u32_u24 v27, 8704, v2
    v_lshrrev_b32 v64, 4, v1
    v_add_u32 v64, v64, v1
    v_lshl_add_u32 v64, v64, 3, v27
    v_lshrrev_b32 v65, 1, v1
    v_lshl_add_u32 v65, v1, 3, v65
    v_lshl_add_u32 v65, v65, 3, v27
    v_lshlrev_b32 v66, 6, v1
    v_lshl_add_u32 v66, v2, 4, v66
    v_add_u32 v66, 34816, v66
    v_sub_u32 v67, 64, v1
    v_lshlrev_b32 v67, 6, v67
    v_lshl_add_u32 v67, v2, 4, v67
    v_add_u32 v67, 34816, v67
    s_waitcnt lgkmcnt(0)
    s_barrier
    v_cmp_ne_u32 vcc, 0, v1
    ds_read_b128 v[68:71], v66 offset:0
    ds_read_b128 v[72:75], v66 offset:4096
    ds_read_b128 v[76:79], v66 offset:8192
    ds_read_b128 v[80:83], v66 offset:12288
    ds_read_b128 v[84:87], v66 offset:16384
    ds_read_b128 v[88:91], v66 offset:20480
    ds_read_b128 v[92:95], v66 offset:24576
    ds_read_b128 v[96:99], v66 offset:28672
    s_waitcnt lgkmcnt(0)
    v_cndmask_b32 v69, 0, v69, vcc
    v_cndmask_b32 v71, 0, v71, vcc
    v_sub_f32 v100, v68, v71
    v_add_f32 v101, v69, v70
    v_sub_f32 v102, v72, v75
    v_add_f32 v103, v73, v74
    v_sub_f32 v104, v76, v79
    v_add_f32 v105, v77, v78
    v_sub_f32 v106, v80, v83
    v_add_f32 v107, v81, v82
    v_sub_f32 v108, v84, v87
    v_add_f32 v109, v85, v86
    v_sub_f32 v110, v88, v91
    v_add_f32 v111, v89, v90
    v_sub_f32 v112, v92, v95
    v_add_f32 v113, v93, v94
    v_sub_f32 v114, v96, v99
    v_add_f32 v115, v97, v98
    ds_read_b128 v[116:119], v67 offset:28672
    ds_read_b128 v[120:123], v67 offset:24576
    ds_read_b128 v[124:127], v67 offset:20480
    ds_read_b128 v[28:31], v67 offset:16384
    ds_read_b128 v[32:35], v67 offset:12288
    ds_read_b128 v[36:39], v67 offset:8192
    ds_read_b128 v[40:43], v67 offset:4096
    ds_read_b128 v[44:47], v67 offset:0
    s_waitcnt lgkmcnt(0)
    v_cndmask_b32 v117, 0, v117, vcc
    v_cndmask_b32 v119, 0, v119, vcc
    v_add_f32 v48, v116, v119
    v_sub_f32 v49, v118, v117
    v_add_f32 v50, v120, v123
    v_sub_f32 v51, v122, v121
    v_add_f32 v52, v124, v127
    v_sub_f32 v53, v126, v125
    v_add_f32 v54, v28, v31
    v_sub_f32 v55, v30, v29
    v_add_f32 v56, v32, v35
    v_sub_f32 v57, v34, v33
    v_add_f32 v58, v36, v39
    v_sub_f32 v59, v38, v37
    v_add_f32 v60, v40, v43
    v_sub_f32 v61, v42, v41
    v_add_f32 v62, v44, v47
    v_sub_f32 v63, v46, v45
    v_add_u32 v24, 0, v1
    v_lshlrev_b32 v24, 4, v24
    v_lshrrev_b32 v25, 4, v24
    v_add_u32 v24, v24, v25
    v_lshl_add_u32 v24, v24, 3, v27
    s_nop 0
    v_pk_add_f32 v[68:69], v[100:101], v[48:49] neg_lo:[0,1] neg_hi:[0,1]
    v_pk_add_f32 v[100:101], v[100:101], v[48:49]
    v_pk_add_f32 v[70:71], v[108:109], v[56:57] neg_lo:[0,1] neg_hi:[0,1]
    v_pk_add_f32 v[108:109], v[108:109], v[56:57]
    v_pk_add_f32 v[76:77], v[104:105], v[52:53] neg_lo:[0,1] neg_hi:[0,1]
    v_pk_add_f32 v[104:105], v[104:105], v[52:53]
    v_pk_add_f32 v[74:75], v[68:69], v[70:71] op_sel:[0,1] op_sel_hi:[1,0] neg_hi:[0,1]
    v_pk_add_f32 v[72:73], v[100:101], v[108:109] neg_lo:[0,1] neg_hi:[0,1]
    v_pk_add_f32 v[100:101], v[100:101], v[108:109]
    v_pk_add_f32 v[68:69], v[68:69], v[70:71] op_sel:[0,1] op_sel_hi:[1,0] neg_lo:[0,1]
    v_pk_add_f32 v[78:79], v[112:113], v[60:61] neg_lo:[0,1] neg_hi:[0,1]
    v_pk_add_f32 v[112:113], v[112:113], v[60:61]
    v_pk_add_f32 v[92:93], v[102:103], v[50:51] neg_lo:[0,1] neg_hi:[0,1]
    v_pk_add_f32 v[102:103], v[102:103], v[50:51]
    v_pk_add_f32 v[82:83], v[76:77], v[78:79] op_sel:[0,1] op_sel_hi:[1,0] neg_hi:[0,1]
    v_pk_add_f32 v[80:81], v[104:105], v[112:113] neg_lo:[0,1] neg_hi:[0,1]
    v_pk_add_f32 v[104:105], v[104:105], v[112:113]
    v_pk_add_f32 v[76:77], v[76:77], v[78:79] op_sel:[0,1] op_sel_hi:[1,0] neg_lo:[0,1]
    v_pk_add_f32 v[90:91], v[82:83], v[82:83] op_sel:[0,1] op_sel_hi:[1,0] neg_lo:[1,1] neg_hi:[1,0]
    v_pk_add_f32 v[88:89], v[72:73], v[80:81] op_sel:[0,1] op_sel_hi:[1,0] neg_hi:[0,1]
    v_pk_add_f32 v[84:85], v[100:101], v[104:105] neg_lo:[0,1] neg_hi:[0,1]
    v_pk_add_f32 v[100:101], v[100:101], v[104:105]
    v_pk_add_f32 v[86:87], v[76:77], v[76:77] op_sel:[0,1] op_sel_hi:[1,0] neg_lo:[0,1] neg_hi:[0,0]
    v_pk_add_f32 v[72:73], v[72:73], v[80:81] op_sel:[0,1] op_sel_hi:[1,0] neg_lo:[0,1]
    v_pk_fma_f32 v[82:83], v[90:91], s[36:37], v[74:75] neg_lo:[1,0,0] neg_hi:[1,0,0]
    v_pk_fma_f32 v[74:75], v[90:91], s[36:37], v[74:75]
    v_pk_fma_f32 v[76:77], v[86:87], s[36:37], v[68:69] neg_lo:[1,0,0] neg_hi:[1,0,0]
    v_pk_fma_f32 v[68:69], v[86:87], s[36:37], v[68:69]
    v_pk_add_f32 v[94:95], v[110:111], v[58:59] neg_lo:[0,1] neg_hi:[0,1]
    v_pk_add_f32 v[110:111], v[110:111], v[58:59]
    v_pk_add_f32 v[116:117], v[106:107], v[54:55] neg_lo:[0,1] neg_hi:[0,1]
    v_pk_add_f32 v[106:107], v[106:107], v[54:55]
    v_pk_add_f32 v[98:99], v[92:93], v[94:95] op_sel:[0,1] op_sel_hi:[1,0] neg_hi:[0,1]
    v_pk_add_f32 v[96:97], v[102:103], v[110:111] neg_lo:[0,1] neg_hi:[0,1]
    v_pk_add_f32 v[102:103], v[102:103], v[110:111]
    v_pk_add_f32 v[92:93], v[92:93], v[94:95] op_sel:[0,1] op_sel_hi:[1,0] neg_lo:[0,1]
    v_pk_add_f32 v[118:119], v[114:115], v[62:63] neg_lo:[0,1] neg_hi:[0,1]
    v_pk_add_f32 v[114:115], v[114:115], v[62:63]
    v_pk_add_f32 v[122:123], v[116:117], v[118:119] op_sel:[0,1] op_sel_hi:[1,0] neg_hi:[0,1]
    v_pk_add_f32 v[116:117], v[116:117], v[118:119] op_sel:[0,1] op_sel_hi:[1,0] neg_lo:[0,1]
    v_pk_add_f32 v[120:121], v[106:107], v[114:115] neg_lo:[0,1] neg_hi:[0,1]
    v_pk_add_f32 v[106:107], v[106:107], v[114:115]
    v_pk_add_f32 v[30:31], v[122:123], v[122:123] op_sel:[0,1] op_sel_hi:[1,0] neg_lo:[1,1] neg_hi:[1,0]
    v_pk_add_f32 v[126:127], v[116:117], v[116:117] op_sel:[0,1] op_sel_hi:[1,0] neg_lo:[0,1] neg_hi:[0,0]
    v_pk_add_f32 v[28:29], v[96:97], v[120:121] op_sel:[0,1] op_sel_hi:[1,0] neg_hi:[0,1]
    v_pk_add_f32 v[124:125], v[102:103], v[106:107] neg_lo:[0,1] neg_hi:[0,1]
    v_pk_add_f32 v[102:103], v[102:103], v[106:107]
    v_pk_fma_f32 v[116:117], v[126:127], s[36:37], v[92:93] neg_lo:[1,0,0] neg_hi:[1,0,0]
    v_pk_fma_f32 v[92:93], v[126:127], s[36:37], v[92:93]
    v_pk_add_f32 v[96:97], v[96:97], v[120:121] op_sel:[0,1] op_sel_hi:[1,0] neg_lo:[0,1]
    v_pk_fma_f32 v[122:123], v[30:31], s[36:37], v[98:99] neg_lo:[1,0,0] neg_hi:[1,0,0]
    v_pk_fma_f32 v[98:99], v[30:31], s[36:37], v[98:99]
    v_pk_add_f32 v[32:33], v[100:101], v[102:103] neg_lo:[0,1] neg_hi:[0,1]
    v_pk_add_f32 v[100:101], v[100:101], v[102:103]
    v_pk_mul_f32 v[34:35], v[92:93], s[38:39] op_sel:[0,0] op_sel_hi:[1,0] neg_lo:[0,0] neg_hi:[0,0]
    v_pk_add_f32 v[36:37], v[96:97], v[96:97] op_sel:[0,1] op_sel_hi:[1,0] neg_lo:[0,1] neg_hi:[0,0]
    v_pk_mul_f32 v[38:39], v[98:99], s[38:39] op_sel:[0,1] op_sel_hi:[1,1] neg_lo:[0,0] neg_hi:[0,0]
    v_pk_add_f32 v[40:41], v[84:85], v[124:125] op_sel:[0,1] op_sel_hi:[1,0] neg_hi:[0,1]
    v_pk_fma_f32 v[34:35], v[92:93], s[38:39], v[34:35] op_sel:[1,1,0] op_sel_hi:[0,1,1] neg_lo:[1,0,0] neg_hi:[0,0,0]
    v_pk_fma_f32 v[96:97], v[36:37], s[36:37], v[72:73] neg_lo:[1,0,0] neg_hi:[1,0,0]
    v_pk_fma_f32 v[72:73], v[36:37], s[36:37], v[72:73]
    v_pk_fma_f32 v[38:39], v[98:99], s[38:39], v[38:39] op_sel:[1,0,0] op_sel_hi:[0,0,1] neg_lo:[1,0,0] neg_hi:[0,0,0]
    v_pk_add_f32 v[92:93], v[68:69], v[34:35] neg_lo:[0,1] neg_hi:[0,1]
    v_pk_add_f32 v[68:69], v[68:69], v[34:35]
    v_pk_add_f32 v[84:85], v[84:85], v[124:125] op_sel:[0,1] op_sel_hi:[1,0] neg_lo:[0,1]
    v_pk_add_f32 v[98:99], v[74:75], v[38:39] neg_lo:[0,1] neg_hi:[0,1]
    v_pk_add_f32 v[74:75], v[74:75], v[38:39]
    v_pk_mul_f32 v[42:43], v[116:117], s[38:39] op_sel:[0,1] op_sel_hi:[1,1] neg_lo:[0,1] neg_hi:[0,1]
    v_pk_add_f32 v[44:45], v[28:29], v[28:29] op_sel:[0,1] op_sel_hi:[1,0] neg_lo:[1,1] neg_hi:[1,0]
    v_pk_mul_f32 v[46:47], v[122:123], s[38:39] op_sel:[0,0] op_sel_hi:[1,0] neg_lo:[0,1] neg_hi:[0,1]
    ds_write_b64 v24, v[100:101] offset:0
    v_pk_fma_f32 v[42:43], v[116:117], s[38:39], v[42:43] op_sel:[1,0,0] op_sel_hi:[0,0,1] neg_lo:[1,0,0] neg_hi:[0,0,0]
    v_pk_fma_f32 v[28:29], v[44:45], s[36:37], v[88:89] neg_lo:[1,0,0] neg_hi:[1,0,0]
    v_pk_fma_f32 v[88:89], v[44:45], s[36:37], v[88:89]
    v_pk_fma_f32 v[46:47], v[122:123], s[38:39], v[46:47] op_sel:[1,1,0] op_sel_hi:[0,1,1] neg_lo:[1,0,0] neg_hi:[0,0,0]
    v_pk_add_f32 v[116:117], v[76:77], v[42:43] neg_lo:[0,1] neg_hi:[0,1]
    v_pk_add_f32 v[76:77], v[76:77], v[42:43]
    ds_write_b64 v24, v[68:69] offset:8
    v_pk_add_f32 v[122:123], v[82:83], v[46:47] neg_lo:[0,1] neg_hi:[0,1]
    v_pk_add_f32 v[82:83], v[82:83], v[46:47]
    ds_write_b64 v24, v[72:73] offset:16
    ds_write_b64 v24, v[74:75] offset:24
    ds_write_b64 v24, v[84:85] offset:32
    ds_write_b64 v24, v[76:77] offset:40
    ds_write_b64 v24, v[88:89] offset:48
    ds_write_b64 v24, v[82:83] offset:56
    ds_write_b64 v24, v[32:33] offset:64
    ds_write_b64 v24, v[92:93] offset:72
    ds_write_b64 v24, v[96:97] offset:80
    ds_write_b64 v24, v[98:99] offset:88
    ds_write_b64 v24, v[40:41] offset:96
    ds_write_b64 v24, v[116:117] offset:104
    ds_write_b64 v24, v[28:29] offset:112
    ds_write_b64 v24, v[122:123] offset:120
    ds_read_b64 v[66:67], v64 offset:0
    ds_read_b64 v[48:49], v64 offset:544
    ds_read_b64 v[56:57], v64 offset:1088
    ds_read_b64 v[108:109], v64 offset:1632
    ds_read_b64 v[70:71], v64 offset:2176
    ds_read_b64 v[52:53], v64 offset:2720
    ds_read_b64 v[60:61], v64 offset:3264
    ds_read_b64 v[112:113], v64 offset:3808
    ds_read_b64 v[78:79], v64 offset:4352
    ds_read_b64 v[104:105], v64 offset:4896
    ds_read_b64 v[86:87], v64 offset:5440
    ds_read_b64 v[80:81], v64 offset:5984
    ds_read_b64 v[90:91], v64 offset:6528
    ds_read_b64 v[50:51], v64 offset:7072
    ds_read_b64 v[58:59], v64 offset:7616
    ds_read_b64 v[110:111], v64 offset:8160
    v_and_b32 v26, 0xf, v1
    v_add_u32 v25, 0, v1
    v_cvt_f32_u32 v26, v26
    v_and_b32 v44, 0xf, v25
    v_mul_f32 v95, 0x3b800000, v26
    v_sub_u32 v25, v25, v44
    v_cos_f32 v94, v95
    v_sin_f32 v95, v95
    v_lshl_add_u32 v25, v25, 4, v44
    v_pk_mul_f32 v[54:55], v[94:95], v[94:95] op_sel:[0,0] op_sel_hi:[1,0]
    v_lshrrev_b32 v44, 4, v25
    v_pk_fma_f32 v[54:55], v[94:95], v[94:95], v[54:55] op_sel:[1,1,0] op_sel_hi:[0,1,1] neg_lo:[1,0,0]
    v_add_u32 v25, v25, v44
    v_pk_mul_f32 v[62:63], v[94:95], v[54:55] op_sel:[0,0] op_sel_hi:[1,0]
    v_pk_mul_f32 v[114:115], v[54:55], v[54:55] op_sel:[0,0] op_sel_hi:[1,0]
    v_lshl_add_u32 v25, v25, 3, v27
    v_pk_fma_f32 v[62:63], v[94:95], v[54:55], v[62:63] op_sel:[1,1,0] op_sel_hi:[0,1,1] neg_lo:[1,0,0]
    v_pk_fma_f32 v[114:115], v[54:55], v[54:55], v[114:115] op_sel:[1,1,0] op_sel_hi:[0,1,1] neg_lo:[1,0,0]
    v_pk_mul_f32 v[118:119], v[54:55], v[62:63] op_sel:[0,0] op_sel_hi:[1,0]
    v_pk_mul_f32 v[106:107], v[62:63], v[62:63] op_sel:[0,0] op_sel_hi:[1,0]
    v_pk_mul_f32 v[126:127], v[62:63], v[114:115] op_sel:[0,0] op_sel_hi:[1,0]
    v_pk_mul_f32 v[120:121], v[114:115], v[114:115] op_sel:[0,0] op_sel_hi:[1,0]
    v_pk_fma_f32 v[118:119], v[54:55], v[62:63], v[118:119] op_sel:[1,1,0] op_sel_hi:[0,1,1] neg_lo:[1,0,0]
    v_pk_fma_f32 v[106:107], v[62:63], v[62:63], v[106:107] op_sel:[1,1,0] op_sel_hi:[0,1,1] neg_lo:[1,0,0]
    v_pk_fma_f32 v[126:127], v[62:63], v[114:115], v[126:127] op_sel:[1,1,0] op_sel_hi:[0,1,1] neg_lo:[1,0,0]
    v_pk_fma_f32 v[120:121], v[114:115], v[114:115], v[120:121] op_sel:[1,1,0] op_sel_hi:[0,1,1] neg_lo:[1,0,0]
    v_pk_mul_f32 v[30:31], v[114:115], v[118:119] op_sel:[0,0] op_sel_hi:[1,0]
    v_pk_mul_f32 v[102:103], v[118:119], v[118:119] op_sel:[0,0] op_sel_hi:[1,0]
    v_pk_mul_f32 v[34:35], v[118:119], v[106:107] op_sel:[0,0] op_sel_hi:[1,0]
    v_pk_mul_f32 v[36:37], v[106:107], v[106:107] op_sel:[0,0] op_sel_hi:[1,0]
    v_pk_fma_f32 v[30:31], v[114:115], v[118:119], v[30:31] op_sel:[1,1,0] op_sel_hi:[0,1,1] neg_lo:[1,0,0]
    v_pk_fma_f32 v[102:103], v[118:119], v[118:119], v[102:103] op_sel:[1,1,0] op_sel_hi:[0,1,1] neg_lo:[1,0,0]
    v_pk_fma_f32 v[34:35], v[118:119], v[106:107], v[34:35] op_sel:[1,1,0] op_sel_hi:[0,1,1] neg_lo:[1,0,0]
    v_pk_fma_f32 v[36:37], v[106:107], v[106:107], v[36:37] op_sel:[1,1,0] op_sel_hi:[0,1,1] neg_lo:[1,0,0]
    v_pk_mul_f32 v[38:39], v[106:107], v[126:127] op_sel:[0,0] op_sel_hi:[1,0]
    v_pk_mul_f32 v[124:125], v[126:127], v[126:127] op_sel:[0,0] op_sel_hi:[1,0]
    v_pk_mul_f32 v[42:43], v[126:127], v[120:121] op_sel:[0,0] op_sel_hi:[1,0]
    v_pk_fma_f32 v[38:39], v[106:107], v[126:127], v[38:39] op_sel:[1,1,0] op_sel_hi:[0,1,1] neg_lo:[1,0,0]
    v_pk_fma_f32 v[124:125], v[126:127], v[126:127], v[124:125] op_sel:[1,1,0] op_sel_hi:[0,1,1] neg_lo:[1,0,0]
    v_pk_fma_f32 v[42:43], v[126:127], v[120:121], v[42:43] op_sel:[1,1,0] op_sel_hi:[0,1,1] neg_lo:[1,0,0]
    s_waitcnt lgkmcnt(0)
    v_pk_mul_f32 v[46:47], v[48:49], v[94:95] op_sel:[0,0] op_sel_hi:[1,0]
    v_pk_mul_f32 v[100:101], v[56:57], v[54:55] op_sel:[0,0] op_sel_hi:[1,0]
    v_pk_mul_f32 v[68:69], v[108:109], v[62:63] op_sel:[0,0] op_sel_hi:[1,0]
    v_pk_mul_f32 v[72:73], v[70:71], v[114:115] op_sel:[0,0] op_sel_hi:[1,0]
    v_pk_fma_f32 v[46:47], v[48:49], v[94:95], v[46:47] op_sel:[1,1,0] op_sel_hi:[0,1,1] neg_lo:[1,0,0]
    v_pk_fma_f32 v[100:101], v[56:57], v[54:55], v[100:101] op_sel:[1,1,0] op_sel_hi:[0,1,1] neg_lo:[1,0,0]
    v_pk_fma_f32 v[68:69], v[108:109], v[62:63], v[68:69] op_sel:[1,1,0] op_sel_hi:[0,1,1] neg_lo:[1,0,0]
    v_pk_fma_f32 v[72:73], v[70:71], v[114:115], v[72:73] op_sel:[1,1,0] op_sel_hi:[0,1,1] neg_lo:[1,0,0]
    v_pk_mul_f32 v[74:75], v[52:53], v[118:119] op_sel:[0,0] op_sel_hi:[1,0]
    v_pk_mul_f32 v[84:85], v[60:61], v[106:107] op_sel:[0,0] op_sel_hi:[1,0]
    v_pk_mul_f32 v[76:77], v[112:113], v[126:127] op_sel:[0,0] op_sel_hi:[1,0]
    v_pk_mul_f32 v[88:89], v[78:79], v[120:121] op_sel:[0,0] op_sel_hi:[1,0]
    v_pk_fma_f32 v[74:75], v[52:53], v[118:119], v[74:75] op_sel:[1,1,0] op_sel_hi:[0,1,1] neg_lo:[1,0,0]
    v_pk_fma_f32 v[84:85], v[60:61], v[106:107], v[84:85] op_sel:[1,1,0] op_sel_hi:[0,1,1] neg_lo:[1,0,0]
    v_pk_fma_f32 v[76:77], v[112:113], v[126:127], v[76:77] op_sel:[1,1,0] op_sel_hi:[0,1,1] neg_lo:[1,0,0]
    v_pk_fma_f32 v[88:89], v[78:79], v[120:121], v[88:89] op_sel:[1,1,0] op_sel_hi:[0,1,1] neg_lo:[1,0,0]
    v_pk_mul_f32 v[82:83], v[104:105], v[30:31] op_sel:[0,0] op_sel_hi:[1,0]
    v_pk_mul_f32 v[32:33], v[86:87], v[102:103] op_sel:[0,0] op_sel_hi:[1,0]
    v_pk_mul_f32 v[92:93], v[80:81], v[34:35] op_sel:[0,0] op_sel_hi:[1,0]
    v_pk_mul_f32 v[96:97], v[90:91], v[36:37] op_sel:[0,0] op_sel_hi:[1,0]
    v_pk_fma_f32 v[82:83], v[104:105], v[30:31], v[82:83] op_sel:[1,1,0] op_sel_hi:[0,1,1] neg_lo:[1,0,0]
    v_pk_fma_f32 v[32:33], v[86:87], v[102:103], v[32:33] op_sel:[1,1,0] op_sel_hi:[0,1,1] neg_lo:[1,0,0]
    v_pk_fma_f32 v[92:93], v[80:81], v[34:35], v[92:93] op_sel:[1,1,0] op_sel_hi:[0,1,1] neg_lo:[1,0,0]
    v_pk_fma_f32 v[96:97], v[90:91], v[36:37], v[96:97] op_sel:[1,1,0] op_sel_hi:[0,1,1] neg_lo:[1,0,0]
    v_pk_mul_f32 v[98:99], v[50:51], v[38:39] op_sel:[0,0] op_sel_hi:[1,0]
    v_pk_mul_f32 v[40:41], v[58:59], v[124:125] op_sel:[0,0] op_sel_hi:[1,0]
    v_pk_mul_f32 v[116:117], v[110:111], v[42:43] op_sel:[0,0] op_sel_hi:[1,0]
    v_pk_add_f32 v[28:29], v[66:67], v[88:89] neg_lo:[0,1] neg_hi:[0,1]
    v_pk_fma_f32 v[98:99], v[50:51], v[38:39], v[98:99] op_sel:[1,1,0] op_sel_hi:[0,1,1] neg_lo:[1,0,0]
    v_pk_fma_f32 v[40:41], v[58:59], v[124:125], v[40:41] op_sel:[1,1,0] op_sel_hi:[0,1,1] neg_lo:[1,0,0]
    v_pk_fma_f32 v[116:117], v[110:111], v[42:43], v[116:117] op_sel:[1,1,0] op_sel_hi:[0,1,1] neg_lo:[1,0,0]
    v_pk_add_f32 v[66:67], v[66:67], v[88:89]
    v_pk_add_f32 v[122:123], v[72:73], v[96:97] neg_lo:[0,1] neg_hi:[0,1]
    v_pk_add_f32 v[72:73], v[72:73], v[96:97]
    v_pk_add_f32 v[94:95], v[100:101], v[32:33] neg_lo:[0,1] neg_hi:[0,1]
    v_pk_add_f32 v[100:101], v[100:101], v[32:33]
    v_pk_add_f32 v[48:49], v[28:29], v[122:123] op_sel:[0,1] op_sel_hi:[1,0] neg_hi:[0,1]
    v_pk_add_f32 v[44:45], v[66:67], v[72:73] neg_lo:[0,1] neg_hi:[0,1]
    v_pk_add_f32 v[66:67], v[66:67], v[72:73]
    v_pk_add_f32 v[28:29], v[28:29], v[122:123] op_sel:[0,1] op_sel_hi:[1,0] neg_lo:[0,1]
    v_pk_add_f32 v[56:57], v[84:85], v[40:41] neg_lo:[0,1] neg_hi:[0,1]
    v_pk_add_f32 v[84:85], v[84:85], v[40:41]
    v_pk_add_f32 v[118:119], v[46:47], v[82:83] neg_lo:[0,1] neg_hi:[0,1]
    v_pk_add_f32 v[46:47], v[46:47], v[82:83]
    v_pk_add_f32 v[108:109], v[94:95], v[56:57] op_sel:[0,1] op_sel_hi:[1,0] neg_hi:[0,1]
    v_pk_add_f32 v[54:55], v[100:101], v[84:85] neg_lo:[0,1] neg_hi:[0,1]
    v_pk_add_f32 v[100:101], v[100:101], v[84:85]
    v_pk_add_f32 v[94:95], v[94:95], v[56:57] op_sel:[0,1] op_sel_hi:[1,0] neg_lo:[0,1]
    v_pk_add_f32 v[52:53], v[108:109], v[108:109] op_sel:[0,1] op_sel_hi:[1,0] neg_lo:[1,1] neg_hi:[1,0]
    v_pk_add_f32 v[114:115], v[44:45], v[54:55] op_sel:[0,1] op_sel_hi:[1,0] neg_hi:[0,1]
    v_pk_add_f32 v[62:63], v[66:67], v[100:101] neg_lo:[0,1] neg_hi:[0,1]
    v_pk_add_f32 v[66:67], v[66:67], v[100:101]
    v_pk_add_f32 v[70:71], v[94:95], v[94:95] op_sel:[0,1] op_sel_hi:[1,0] neg_lo:[0,1] neg_hi:[0,0]
    v_pk_add_f32 v[44:45], v[44:45], v[54:55] op_sel:[0,1] op_sel_hi:[1,0] neg_lo:[0,1]
    v_pk_fma_f32 v[108:109], v[52:53], s[36:37], v[48:49] neg_lo:[1,0,0] neg_hi:[1,0,0]
    v_pk_fma_f32 v[48:49], v[52:53], s[36:37], v[48:49]
    v_pk_fma_f32 v[94:95], v[70:71], s[36:37], v[28:29] neg_lo:[1,0,0] neg_hi:[1,0,0]
    v_pk_fma_f32 v[28:29], v[70:71], s[36:37], v[28:29]
    v_pk_add_f32 v[60:61], v[74:75], v[98:99] neg_lo:[0,1] neg_hi:[0,1]
    v_pk_add_f32 v[74:75], v[74:75], v[98:99]
    v_pk_add_f32 v[126:127], v[68:69], v[92:93] neg_lo:[0,1] neg_hi:[0,1]
    v_pk_add_f32 v[68:69], v[68:69], v[92:93]
    v_pk_add_f32 v[112:113], v[118:119], v[60:61] op_sel:[0,1] op_sel_hi:[1,0] neg_hi:[0,1]
    v_pk_add_f32 v[106:107], v[46:47], v[74:75] neg_lo:[0,1] neg_hi:[0,1]
    v_pk_add_f32 v[46:47], v[46:47], v[74:75]
    v_pk_add_f32 v[118:119], v[118:119], v[60:61] op_sel:[0,1] op_sel_hi:[1,0] neg_lo:[0,1]
    v_pk_add_f32 v[78:79], v[76:77], v[116:117] neg_lo:[0,1] neg_hi:[0,1]
    v_pk_add_f32 v[76:77], v[76:77], v[116:117]
    v_pk_add_f32 v[104:105], v[126:127], v[78:79] op_sel:[0,1] op_sel_hi:[1,0] neg_hi:[0,1]
    v_pk_add_f32 v[126:127], v[126:127], v[78:79] op_sel:[0,1] op_sel_hi:[1,0] neg_lo:[0,1]
    v_pk_add_f32 v[120:121], v[68:69], v[76:77] neg_lo:[0,1] neg_hi:[0,1]
    v_pk_add_f32 v[68:69], v[68:69], v[76:77]
    v_pk_add_f32 v[80:81], v[104:105], v[104:105] op_sel:[0,1] op_sel_hi:[1,0] neg_lo:[1,1] neg_hi:[1,0]
    v_pk_add_f32 v[86:87], v[126:127], v[126:127] op_sel:[0,1] op_sel_hi:[1,0] neg_lo:[0,1] neg_hi:[0,0]
    v_pk_add_f32 v[102:103], v[106:107], v[120:121] op_sel:[0,1] op_sel_hi:[1,0] neg_hi:[0,1]
    v_pk_add_f32 v[30:31], v[46:47], v[68:69] neg_lo:[0,1] neg_hi:[0,1]
    v_pk_add_f32 v[46:47], v[46:47], v[68:69]
    v_pk_fma_f32 v[126:127], v[86:87], s[36:37], v[118:119] neg_lo:[1,0,0] neg_hi:[1,0,0]
    v_pk_fma_f32 v[118:119], v[86:87], s[36:37], v[118:119]
    v_pk_add_f32 v[106:107], v[106:107], v[120:121] op_sel:[0,1] op_sel_hi:[1,0] neg_lo:[0,1]
    v_pk_fma_f32 v[104:105], v[80:81], s[36:37], v[112:113] neg_lo:[1,0,0] neg_hi:[1,0,0]
    v_pk_fma_f32 v[112:113], v[80:81], s[36:37], v[112:113]
    v_pk_add_f32 v[34:35], v[66:67], v[46:47] neg_lo:[0,1] neg_hi:[0,1]
    v_pk_add_f32 v[66:67], v[66:67], v[46:47]
    v_pk_mul_f32 v[90:91], v[118:119], s[38:39] op_sel:[0,0] op_sel_hi:[1,0] neg_lo:[0,0] neg_hi:[0,0]
    v_pk_add_f32 v[36:37], v[106:107], v[106:107] op_sel:[0,1] op_sel_hi:[1,0] neg_lo:[0,1] neg_hi:[0,0]
    v_pk_mul_f32 v[50:51], v[112:113], s[38:39] op_sel:[0,1] op_sel_hi:[1,1] neg_lo:[0,0] neg_hi:[0,0]
    v_pk_add_f32 v[38:39], v[62:63], v[30:31] op_sel:[0,1] op_sel_hi:[1,0] neg_hi:[0,1]
    v_pk_fma_f32 v[90:91], v[118:119], s[38:39], v[90:91] op_sel:[1,1,0] op_sel_hi:[0,1,1] neg_lo:[1,0,0] neg_hi:[0,0,0]
    v_pk_fma_f32 v[106:107], v[36:37], s[36:37], v[44:45] neg_lo:[1,0,0] neg_hi:[1,0,0]
    v_pk_fma_f32 v[44:45], v[36:37], s[36:37], v[44:45]
    v_pk_fma_f32 v[50:51], v[112:113], s[38:39], v[50:51] op_sel:[1,0,0] op_sel_hi:[0,0,1] neg_lo:[1,0,0] neg_hi:[0,0,0]
    v_pk_add_f32 v[118:119], v[28:29], v[90:91] neg_lo:[0,1] neg_hi:[0,1]
    v_pk_add_f32 v[28:29], v[28:29], v[90:91]
    v_pk_add_f32 v[62:63], v[62:63], v[30:31] op_sel:[0,1] op_sel_hi:[1,0] neg_lo:[0,1]
    v_pk_add_f32 v[112:113], v[48:49], v[50:51] neg_lo:[0,1] neg_hi:[0,1]
    v_pk_add_f32 v[48:49], v[48:49], v[50:51]
    v_pk_mul_f32 v[58:59], v[126:127], s[38:39] op_sel:[0,1] op_sel_hi:[1,1] neg_lo:[0,1] neg_hi:[0,1]
    v_pk_add_f32 v[124:125], v[102:103], v[102:103] op_sel:[0,1] op_sel_hi:[1,0] neg_lo:[1,1] neg_hi:[1,0]
    v_pk_mul_f32 v[110:111], v[104:105], s[38:39] op_sel:[0,0] op_sel_hi:[1,0] neg_lo:[0,1] neg_hi:[0,1]
    ds_write_b64 v25, v[66:67] offset:0
    v_pk_fma_f32 v[58:59], v[126:127], s[38:39], v[58:59] op_sel:[1,0,0] op_sel_hi:[0,0,1] neg_lo:[1,0,0] neg_hi:[0,0,0]
    v_pk_fma_f32 v[102:103], v[124:125], s[36:37], v[114:115] neg_lo:[1,0,0] neg_hi:[1,0,0]
    v_pk_fma_f32 v[114:115], v[124:125], s[36:37], v[114:115]
    v_pk_fma_f32 v[110:111], v[104:105], s[38:39], v[110:111] op_sel:[1,1,0] op_sel_hi:[0,1,1] neg_lo:[1,0,0] neg_hi:[0,0,0]
    v_pk_add_f32 v[126:127], v[94:95], v[58:59] neg_lo:[0,1] neg_hi:[0,1]
    v_pk_add_f32 v[94:95], v[94:95], v[58:59]
    ds_write_b64 v25, v[28:29] offset:136
    v_pk_add_f32 v[104:105], v[108:109], v[110:111] neg_lo:[0,1] neg_hi:[0,1]
    v_pk_add_f32 v[108:109], v[108:109], v[110:111]
    ds_write_b64 v25, v[44:45] offset:272
    ds_write_b64 v25, v[48:49] offset:408
    ds_write_b64 v25, v[62:63] offset:544
    ds_write_b64 v25, v[94:95] offset:680
    ds_write_b64 v25, v[114:115] offset:816
    ds_write_b64 v25, v[108:109] offset:952
    ds_write_b64 v25, v[34:35] offset:1088
    ds_write_b64 v25, v[118:119] offset:1224
    ds_write_b64 v25, v[106:107] offset:1360
    ds_write_b64 v25, v[112:113] offset:1496
    ds_write_b64 v25, v[38:39] offset:1632
    ds_write_b64 v25, v[126:127] offset:1768
    ds_write_b64 v25, v[102:103] offset:1904
    ds_write_b64 v25, v[104:105] offset:2040
    ds_read_b64 v[24:25], v64 offset:0
    ds_read_b64 v[42:43], v64 offset:2176
    ds_read_b64 v[88:89], v64 offset:4352
    ds_read_b64 v[96:97], v64 offset:6528
    ds_read_b64 v[72:73], v64 offset:544
    ds_read_b64 v[122:123], v64 offset:2720
    ds_read_b64 v[32:33], v64 offset:4896
    ds_read_b64 v[40:41], v64 offset:7072
    ds_read_b64 v[84:85], v64 offset:1088
    ds_read_b64 v[56:57], v64 offset:3264
    ds_read_b64 v[100:101], v64 offset:5440
    ds_read_b64 v[70:71], v64 offset:7616
    ds_read_b64 v[54:55], v64 offset:1632
    ds_read_b64 v[52:53], v64 offset:3808
    ds_read_b64 v[82:83], v64 offset:5984
    ds_read_b64 v[98:99], v64 offset:8160
    v_and_b32 v26, 0xff, v1
    v_add_u32 v116, 64, v1
    v_add_u32 v117, 128, v1
    v_add_u32 v46, 192, v1
    v_cvt_f32_u32 v26, v26
    v_and_b32 v116, 0xff, v116
    v_and_b32 v117, 0xff, v117
    v_and_b32 v46, 0xff, v46
    v_mul_f32 v75, 0x3a800000, v26
    v_cvt_f32_u32 v116, v116
    v_cvt_f32_u32 v117, v117
    v_cvt_f32_u32 v46, v46
    v_cos_f32 v74, v75
    v_sin_f32 v75, v75
    v_mul_f32 v77, 0x3a800000, v116
    v_mul_f32 v87, 0x3a800000, v117
    v_mul_f32 v91, 0x3a800000, v46
    v_add_u32 v47, 0, v1
    v_pk_mul_f32 v[60:61], v[74:75], v[74:75] op_sel:[0,0] op_sel_hi:[1,0]
    v_cos_f32 v76, v77
    v_sin_f32 v77, v77
    v_cos_f32 v86, v87
    v_pk_fma_f32 v[60:61], v[74:75], v[74:75], v[60:61] op_sel:[1,1,0] op_sel_hi:[0,1,1] neg_lo:[1,0,0]
    v_sin_f32 v87, v87
    v_cos_f32 v90, v91
    v_pk_mul_f32 v[78:79], v[76:77], v[76:77] op_sel:[0,0] op_sel_hi:[1,0]
    v_pk_mul_f32 v[92:93], v[74:75], v[60:61] op_sel:[0,0] op_sel_hi:[1,0]
    v_sin_f32 v91, v91
    v_pk_mul_f32 v[120:121], v[86:87], v[86:87] op_sel:[0,0] op_sel_hi:[1,0]
    v_pk_fma_f32 v[78:79], v[76:77], v[76:77], v[78:79] op_sel:[1,1,0] op_sel_hi:[0,1,1] neg_lo:[1,0,0]
    v_pk_fma_f32 v[92:93], v[74:75], v[60:61], v[92:93] op_sel:[1,1,0] op_sel_hi:[0,1,1] neg_lo:[1,0,0]
    v_and_b32 v30, 0xff, v47
    v_pk_fma_f32 v[120:121], v[86:87], v[86:87], v[120:121] op_sel:[1,1,0] op_sel_hi:[0,1,1] neg_lo:[1,0,0]
    v_pk_mul_f32 v[68:69], v[76:77], v[78:79] op_sel:[0,0] op_sel_hi:[1,0]
    v_pk_mul_f32 v[36:37], v[90:91], v[90:91] op_sel:[0,0] op_sel_hi:[1,0]
    v_sub_u32 v47, v47, v30
    v_pk_mul_f32 v[80:81], v[86:87], v[120:121] op_sel:[0,0] op_sel_hi:[1,0]
    v_pk_fma_f32 v[68:69], v[76:77], v[78:79], v[68:69] op_sel:[1,1,0] op_sel_hi:[0,1,1] neg_lo:[1,0,0]
    v_pk_fma_f32 v[36:37], v[90:91], v[90:91], v[36:37] op_sel:[1,1,0] op_sel_hi:[0,1,1] neg_lo:[1,0,0]
    v_lshl_add_u32 v47, v47, 2, v30
    v_pk_fma_f32 v[80:81], v[86:87], v[120:121], v[80:81] op_sel:[1,1,0] op_sel_hi:[0,1,1] neg_lo:[1,0,0]
    v_add_u32 v31, 64, v1
    v_pk_mul_f32 v[50:51], v[90:91], v[36:37] op_sel:[0,0] op_sel_hi:[1,0]
    v_lshrrev_b32 v30, 4, v47
    v_add_u32 v59, 128, v1
    v_and_b32 v58, 0xff, v31
    v_pk_fma_f32 v[50:51], v[90:91], v[36:37], v[50:51] op_sel:[1,1,0] op_sel_hi:[0,1,1] neg_lo:[1,0,0]
    v_add_u32 v47, v47, v30
    v_and_b32 v124, 0xff, v59
    v_sub_u32 v31, v31, v58
    v_add_u32 v125, 192, v1
    v_lshl_add_u32 v47, v47, 3, v27
    v_sub_u32 v59, v59, v124
    v_lshl_add_u32 v31, v31, 2, v58
    v_and_b32 v110, 0xff, v125
    v_lshl_add_u32 v59, v59, 2, v124
    v_lshrrev_b32 v58, 4, v31
    v_sub_u32 v125, v125, v110
    v_lshrrev_b32 v124, 4, v59
    v_add_u32 v31, v31, v58
    v_lshl_add_u32 v125, v125, 2, v110
    v_add_u32 v59, v59, v124
    v_lshl_add_u32 v31, v31, 3, v27
    v_lshrrev_b32 v110, 4, v125
    v_lshl_add_u32 v59, v59, 3, v27
    v_add_u32 v125, v125, v110
    v_lshl_add_u32 v125, v125, 3, v27
    s_waitcnt lgkmcnt(0)
    v_pk_mul_f32 v[66:67], v[42:43], v[74:75] op_sel:[0,0] op_sel_hi:[1,0]
    v_pk_mul_f32 v[28:29], v[88:89], v[60:61] op_sel:[0,0] op_sel_hi:[1,0]
    v_pk_mul_f32 v[44:45], v[96:97], v[92:93] op_sel:[0,0] op_sel_hi:[1,0]
    v_pk_mul_f32 v[108:109], v[122:123], v[76:77] op_sel:[0,0] op_sel_hi:[1,0]
    v_pk_fma_f32 v[66:67], v[42:43], v[74:75], v[66:67] op_sel:[1,1,0] op_sel_hi:[0,1,1] neg_lo:[1,0,0]
    v_pk_fma_f32 v[28:29], v[88:89], v[60:61], v[28:29] op_sel:[1,1,0] op_sel_hi:[0,1,1] neg_lo:[1,0,0]
    v_pk_fma_f32 v[44:45], v[96:97], v[92:93], v[44:45] op_sel:[1,1,0] op_sel_hi:[0,1,1] neg_lo:[1,0,0]
    v_pk_fma_f32 v[108:109], v[122:123], v[76:77], v[108:109] op_sel:[1,1,0] op_sel_hi:[0,1,1] neg_lo:[1,0,0]
    v_pk_mul_f32 v[34:35], v[32:33], v[78:79] op_sel:[0,0] op_sel_hi:[1,0]
    v_pk_add_f32 v[48:49], v[24:25], v[28:29] neg_lo:[0,1] neg_hi:[0,1]
    v_pk_add_f32 v[24:25], v[24:25], v[28:29]
    v_pk_add_f32 v[62:63], v[66:67], v[44:45] neg_lo:[0,1] neg_hi:[0,1]
    v_pk_add_f32 v[66:67], v[66:67], v[44:45]
    v_pk_fma_f32 v[34:35], v[32:33], v[78:79], v[34:35] op_sel:[1,1,0] op_sel_hi:[0,1,1] neg_lo:[1,0,0]
    v_pk_mul_f32 v[118:119], v[40:41], v[68:69] op_sel:[0,0] op_sel_hi:[1,0]
    v_pk_add_f32 v[114:115], v[48:49], v[62:63] op_sel:[0,1] op_sel_hi:[1,0] neg_hi:[0,1]
    v_pk_add_f32 v[94:95], v[24:25], v[66:67] neg_lo:[0,1] neg_hi:[0,1]
    v_pk_add_f32 v[24:25], v[24:25], v[66:67]
    v_pk_add_f32 v[48:49], v[48:49], v[62:63] op_sel:[0,1] op_sel_hi:[1,0] neg_lo:[0,1]
    v_pk_fma_f32 v[118:119], v[40:41], v[68:69], v[118:119] op_sel:[1,1,0] op_sel_hi:[0,1,1] neg_lo:[1,0,0]
    v_pk_add_f32 v[106:107], v[72:73], v[34:35] neg_lo:[0,1] neg_hi:[0,1]
    v_pk_add_f32 v[72:73], v[72:73], v[34:35]
    v_pk_mul_f32 v[102:103], v[56:57], v[86:87] op_sel:[0,0] op_sel_hi:[1,0]
    v_pk_add_f32 v[112:113], v[108:109], v[118:119] neg_lo:[0,1] neg_hi:[0,1]
    v_pk_add_f32 v[108:109], v[108:109], v[118:119]
    v_pk_mul_f32 v[104:105], v[100:101], v[120:121] op_sel:[0,0] op_sel_hi:[1,0]
    v_pk_fma_f32 v[102:103], v[56:57], v[86:87], v[102:103] op_sel:[1,1,0] op_sel_hi:[0,1,1] neg_lo:[1,0,0]
    v_pk_add_f32 v[126:127], v[106:107], v[112:113] op_sel:[0,1] op_sel_hi:[1,0] neg_hi:[0,1]
    v_pk_add_f32 v[38:39], v[72:73], v[108:109] neg_lo:[0,1] neg_hi:[0,1]
    v_pk_add_f32 v[72:73], v[72:73], v[108:109]
    v_pk_add_f32 v[106:107], v[106:107], v[112:113] op_sel:[0,1] op_sel_hi:[1,0] neg_lo:[0,1]
    v_pk_fma_f32 v[104:105], v[100:101], v[120:121], v[104:105] op_sel:[1,1,0] op_sel_hi:[0,1,1] neg_lo:[1,0,0]
    v_pk_mul_f32 v[116:117], v[70:71], v[80:81] op_sel:[0,0] op_sel_hi:[1,0]
    v_pk_mul_f32 v[60:61], v[52:53], v[90:91] op_sel:[0,0] op_sel_hi:[1,0]
    v_pk_mul_f32 v[96:97], v[82:83], v[36:37] op_sel:[0,0] op_sel_hi:[1,0]
    v_pk_add_f32 v[110:111], v[84:85], v[104:105] neg_lo:[0,1] neg_hi:[0,1]
    v_pk_fma_f32 v[116:117], v[70:71], v[80:81], v[116:117] op_sel:[1,1,0] op_sel_hi:[0,1,1] neg_lo:[1,0,0]
    v_pk_add_f32 v[84:85], v[84:85], v[104:105]
    v_pk_fma_f32 v[60:61], v[52:53], v[90:91], v[60:61] op_sel:[1,1,0] op_sel_hi:[0,1,1] neg_lo:[1,0,0]
    v_pk_fma_f32 v[96:97], v[82:83], v[36:37], v[96:97] op_sel:[1,1,0] op_sel_hi:[0,1,1] neg_lo:[1,0,0]
    v_pk_add_f32 v[42:43], v[102:103], v[116:117] neg_lo:[0,1] neg_hi:[0,1]
    v_pk_add_f32 v[102:103], v[102:103], v[116:117]
    v_pk_mul_f32 v[92:93], v[98:99], v[50:51] op_sel:[0,0] op_sel_hi:[1,0]
    v_pk_add_f32 v[28:29], v[54:55], v[96:97] neg_lo:[0,1] neg_hi:[0,1]
    v_pk_add_f32 v[88:89], v[110:111], v[42:43] op_sel:[0,1] op_sel_hi:[1,0] neg_hi:[0,1]
    v_pk_add_f32 v[74:75], v[84:85], v[102:103] neg_lo:[0,1] neg_hi:[0,1]
    v_pk_add_f32 v[84:85], v[84:85], v[102:103]
    v_pk_add_f32 v[110:111], v[110:111], v[42:43] op_sel:[0,1] op_sel_hi:[1,0] neg_lo:[0,1]
    v_pk_fma_f32 v[92:93], v[98:99], v[50:51], v[92:93] op_sel:[1,1,0] op_sel_hi:[0,1,1] neg_lo:[1,0,0]
    v_pk_add_f32 v[54:55], v[54:55], v[96:97]
    ds_write_b64 v47, v[24:25] offset:0
    ds_write_b64 v47, v[48:49] offset:2176
    v_pk_add_f32 v[44:45], v[60:61], v[92:93] neg_lo:[0,1] neg_hi:[0,1]
    v_pk_add_f32 v[60:61], v[60:61], v[92:93]
    ds_write_b64 v47, v[94:95] offset:4352
    ds_write_b64 v47, v[114:115] offset:6528
    v_pk_add_f32 v[62:63], v[28:29], v[44:45] op_sel:[0,1] op_sel_hi:[1,0] neg_hi:[0,1]
    v_pk_add_f32 v[66:67], v[54:55], v[60:61] neg_lo:[0,1] neg_hi:[0,1]
    v_pk_add_f32 v[54:55], v[54:55], v[60:61]
    v_pk_add_f32 v[28:29], v[28:29], v[44:45] op_sel:[0,1] op_sel_hi:[1,0] neg_lo:[0,1]
    ds_write_b64 v31, v[72:73] offset:0
    ds_write_b64 v31, v[106:107] offset:2176
    ds_write_b64 v31, v[38:39] offset:4352
    ds_write_b64 v31, v[126:127] offset:6528
    ds_write_b64 v59, v[84:85] offset:0
    ds_write_b64 v59, v[110:111] offset:2176
    ds_write_b64 v59, v[74:75] offset:4352
    ds_write_b64 v59, v[88:89] offset:6528
    ds_write_b64 v125, v[54:55] offset:0
    ds_write_b64 v125, v[28:29] offset:2176
    ds_write_b64 v125, v[66:67] offset:4352
    ds_write_b64 v125, v[62:63] offset:6528
    ds_read_b64 v[46:47], v65 offset:0
    ds_read_b64 v[40:41], v65 offset:4352
    ds_read_b64 v[30:31], v65 offset:8
    ds_read_b64 v[68:69], v65 offset:4360
    ds_read_b64 v[58:59], v65 offset:16
    ds_read_b64 v[34:35], v65 offset:4368
    ds_read_b64 v[124:125], v65 offset:24
    ds_read_b64 v[118:119], v65 offset:4376
    ds_read_b64 v[122:123], v65 offset:32
    ds_read_b64 v[108:109], v65 offset:4384
    ds_read_b64 v[76:77], v65 offset:40
    ds_read_b64 v[112:113], v65 offset:4392
    ds_read_b64 v[32:33], v65 offset:48
    ds_read_b64 v[56:57], v65 offset:4400
    ds_read_b64 v[78:79], v65 offset:56
    ds_read_b64 v[86:87], v65 offset:4408
    s_waitcnt vmcnt(0)
    v_lshlrev_b32 v100, 16, v8
    v_and_b32 v120, 0xffff0000, v8
    v_lshlrev_b32 v101, 16, v16
    v_and_b32 v121, 0xffff0000, v16
    v_lshlrev_b32 v70, 16, v9
    v_and_b32 v80, 0xffff0000, v9
    v_lshlrev_b32 v71, 16, v17
    v_and_b32 v81, 0xffff0000, v17
    v_lshlrev_b32 v104, 16, v10
    v_and_b32 v116, 0xffff0000, v10
    v_lshlrev_b32 v105, 16, v18
    v_and_b32 v117, 0xffff0000, v18
    v_lshlrev_b32 v102, 16, v11
    v_and_b32 v42, 0xffff0000, v11
    v_lshlrev_b32 v103, 16, v19
    v_and_b32 v43, 0xffff0000, v19
    v_lshlrev_b32 v52, 16, v12
    v_and_b32 v90, 0xffff0000, v12
    v_lshlrev_b32 v53, 16, v20
    v_and_b32 v91, 0xffff0000, v20
    v_lshlrev_b32 v82, 16, v13
    v_and_b32 v36, 0xffff0000, v13
    v_lshlrev_b32 v83, 16, v21
    v_and_b32 v37, 0xffff0000, v21
    v_lshlrev_b32 v98, 16, v14
    v_and_b32 v50, 0xffff0000, v14
    v_lshlrev_b32 v99, 16, v22
    v_and_b32 v51, 0xffff0000, v22
    v_lshlrev_b32 v96, 16, v15
    v_and_b32 v92, 0xffff0000, v15
    v_lshlrev_b32 v97, 16, v23
    v_and_b32 v93, 0xffff0000, v23
    s_waitcnt lgkmcnt(0)
    v_cvt_pk_bf16_f32 v26, v46, v47
    v_lshlrev_b32 v46, 16, v26
    v_and_b32 v47, 0xffff0000, v26
    v_pk_add_f32 v[100:101], v[100:101], v[46:47]
    v_cvt_pk_bf16_f32 v26, v100, v101
    v_lshlrev_b32 v100, 16, v26
    v_and_b32 v101, 0xffff0000, v26
    v_cvt_pk_bf16_f32 v26, v30, v31
    v_lshlrev_b32 v30, 16, v26
    v_and_b32 v31, 0xffff0000, v26
    v_pk_add_f32 v[120:121], v[120:121], v[30:31]
    v_cvt_pk_bf16_f32 v26, v120, v121
    v_lshlrev_b32 v120, 16, v26
    v_and_b32 v121, 0xffff0000, v26
    v_cvt_pk_bf16_f32 v26, v58, v59
    v_lshlrev_b32 v58, 16, v26
    v_and_b32 v59, 0xffff0000, v26
    v_pk_add_f32 v[70:71], v[70:71], v[58:59]
    v_cvt_pk_bf16_f32 v26, v70, v71
    v_lshlrev_b32 v70, 16, v26
    v_and_b32 v71, 0xffff0000, v26
    v_cvt_pk_bf16_f32 v26, v124, v125
    v_lshlrev_b32 v124, 16, v26
    v_and_b32 v125, 0xffff0000, v26
    v_pk_add_f32 v[80:81], v[80:81], v[124:125]
    v_cvt_pk_bf16_f32 v26, v80, v81
    v_lshlrev_b32 v80, 16, v26
    v_and_b32 v81, 0xffff0000, v26
    v_cvt_pk_bf16_f32 v26, v122, v123
    v_lshlrev_b32 v122, 16, v26
    v_and_b32 v123, 0xffff0000, v26
    v_pk_add_f32 v[104:105], v[104:105], v[122:123]
    v_cvt_pk_bf16_f32 v26, v104, v105
    v_lshlrev_b32 v104, 16, v26
    v_and_b32 v105, 0xffff0000, v26
    v_cvt_pk_bf16_f32 v26, v76, v77
    v_lshlrev_b32 v76, 16, v26
    v_and_b32 v77, 0xffff0000, v26
    v_pk_add_f32 v[116:117], v[116:117], v[76:77]
    v_cvt_pk_bf16_f32 v26, v116, v117
    v_lshlrev_b32 v116, 16, v26
    v_and_b32 v117, 0xffff0000, v26
    v_cvt_pk_bf16_f32 v26, v32, v33
    v_lshlrev_b32 v32, 16, v26
    v_and_b32 v33, 0xffff0000, v26
    v_pk_add_f32 v[102:103], v[102:103], v[32:33]
    v_cvt_pk_bf16_f32 v26, v102, v103
    v_lshlrev_b32 v102, 16, v26
    v_and_b32 v103, 0xffff0000, v26
    v_cvt_pk_bf16_f32 v26, v78, v79
    v_lshlrev_b32 v78, 16, v26
    v_and_b32 v79, 0xffff0000, v26
    v_pk_add_f32 v[42:43], v[42:43], v[78:79]
    v_cvt_pk_bf16_f32 v26, v42, v43
    v_lshlrev_b32 v42, 16, v26
    v_and_b32 v43, 0xffff0000, v26
    v_cvt_pk_bf16_f32 v26, v40, v41
    v_lshlrev_b32 v40, 16, v26
    v_and_b32 v41, 0xffff0000, v26
    v_pk_add_f32 v[52:53], v[52:53], v[40:41]
    v_cvt_pk_bf16_f32 v26, v52, v53
    v_lshlrev_b32 v52, 16, v26
    v_and_b32 v53, 0xffff0000, v26
    v_cvt_pk_bf16_f32 v26, v68, v69
    v_lshlrev_b32 v68, 16, v26
    v_and_b32 v69, 0xffff0000, v26
    v_pk_add_f32 v[90:91], v[90:91], v[68:69]
    v_cvt_pk_bf16_f32 v26, v90, v91
    v_lshlrev_b32 v90, 16, v26
    v_and_b32 v91, 0xffff0000, v26
    v_cvt_pk_bf16_f32 v26, v34, v35
    v_lshlrev_b32 v34, 16, v26
    v_and_b32 v35, 0xffff0000, v26
    v_pk_add_f32 v[82:83], v[82:83], v[34:35]
    v_cvt_pk_bf16_f32 v26, v82, v83
    v_lshlrev_b32 v82, 16, v26
    v_and_b32 v83, 0xffff0000, v26
    v_cvt_pk_bf16_f32 v26, v118, v119
    v_lshlrev_b32 v118, 16, v26
    v_and_b32 v119, 0xffff0000, v26
    v_pk_add_f32 v[36:37], v[36:37], v[118:119]
    v_cvt_pk_bf16_f32 v26, v36, v37
    v_lshlrev_b32 v36, 16, v26
    v_and_b32 v37, 0xffff0000, v26
    v_cvt_pk_bf16_f32 v26, v108, v109
    v_lshlrev_b32 v108, 16, v26
    v_and_b32 v109, 0xffff0000, v26
    v_pk_add_f32 v[98:99], v[98:99], v[108:109]
    v_cvt_pk_bf16_f32 v26, v98, v99
    v_lshlrev_b32 v98, 16, v26
    v_and_b32 v99, 0xffff0000, v26
    v_cvt_pk_bf16_f32 v26, v112, v113
    v_lshlrev_b32 v112, 16, v26
    v_and_b32 v113, 0xffff0000, v26
    v_pk_add_f32 v[50:51], v[50:51], v[112:113]
    v_cvt_pk_bf16_f32 v26, v50, v51
    v_lshlrev_b32 v50, 16, v26
    v_and_b32 v51, 0xffff0000, v26
    v_cvt_pk_bf16_f32 v26, v56, v57
    v_lshlrev_b32 v56, 16, v26
    v_and_b32 v57, 0xffff0000, v26
    v_pk_add_f32 v[96:97], v[96:97], v[56:57]
    v_cvt_pk_bf16_f32 v26, v96, v97
    v_lshlrev_b32 v96, 16, v26
    v_and_b32 v97, 0xffff0000, v26
    v_cvt_pk_bf16_f32 v26, v86, v87
    v_lshlrev_b32 v86, 16, v26
    v_and_b32 v87, 0xffff0000, v26
    v_pk_add_f32 v[92:93], v[92:93], v[86:87]
    v_cvt_pk_bf16_f32 v26, v92, v93
    v_lshlrev_b32 v92, 16, v26
    v_and_b32 v93, 0xffff0000, v26
    v_cvt_pk_bf16_f32 v8, v100, v120
    v_cvt_pk_bf16_f32 v16, v101, v121
    v_cvt_pk_bf16_f32 v9, v70, v80
    v_cvt_pk_bf16_f32 v17, v71, v81
    v_cvt_pk_bf16_f32 v10, v104, v116
    v_cvt_pk_bf16_f32 v18, v105, v117
    v_cvt_pk_bf16_f32 v11, v102, v42
    v_cvt_pk_bf16_f32 v19, v103, v43
    v_cvt_pk_bf16_f32 v12, v52, v90
    v_cvt_pk_bf16_f32 v20, v53, v91
    v_cvt_pk_bf16_f32 v13, v82, v36
    v_cvt_pk_bf16_f32 v21, v83, v37
    v_cvt_pk_bf16_f32 v14, v98, v50
    v_cvt_pk_bf16_f32 v22, v99, v51
    v_cvt_pk_bf16_f32 v15, v96, v92
    v_cvt_pk_bf16_f32 v23, v97, v93
    buffer_store_dwordx4 v[8:11], v3, s[20:23], 0 offen sc1
    buffer_store_dwordx4 v[12:15], v3, s[20:23], 0 offen offset:1024 sc1
    buffer_store_dwordx4 v[16:19], v3, s[20:23], 0 offen offset:2048 sc1
    buffer_store_dwordx4 v[20:23], v3, s[20:23], 0 offen offset:3072 sc1
    v_pk_add_f32 v[60:61], v[100:101], v[120:121]
    v_pk_add_f32 v[60:61], v[60:61], v[70:71]
    v_pk_add_f32 v[60:61], v[60:61], v[80:81]
    v_pk_add_f32 v[60:61], v[60:61], v[104:105]
    v_pk_add_f32 v[60:61], v[60:61], v[116:117]
    v_pk_add_f32 v[60:61], v[60:61], v[102:103]
    v_pk_add_f32 v[60:61], v[60:61], v[42:43]
    v_pk_add_f32 v[60:61], v[60:61], v[52:53]
    v_pk_add_f32 v[60:61], v[60:61], v[90:91]
    v_pk_add_f32 v[60:61], v[60:61], v[82:83]
    v_pk_add_f32 v[60:61], v[60:61], v[36:37]
    v_pk_add_f32 v[60:61], v[60:61], v[98:99]
    v_pk_add_f32 v[60:61], v[60:61], v[50:51]
    v_pk_add_f32 v[60:61], v[60:61], v[96:97]
    v_pk_add_f32 v[60:61], v[60:61], v[92:93]
    s_nop 1
    v_add_f32_dpp v60, v60, v60 row_shr:1 row_mask:0xf bank_mask:0xf bound_ctrl:0
    v_add_f32_dpp v61, v61, v61 row_shr:1 row_mask:0xf bank_mask:0xf bound_ctrl:0
    s_nop 0
    v_add_f32_dpp v60, v60, v60 row_shr:2 row_mask:0xf bank_mask:0xf bound_ctrl:0
    v_add_f32_dpp v61, v61, v61 row_shr:2 row_mask:0xf bank_mask:0xf bound_ctrl:0
    s_nop 0
    v_add_f32_dpp v60, v60, v60 row_shr:4 row_mask:0xf bank_mask:0xf bound_ctrl:0
    v_add_f32_dpp v61, v61, v61 row_shr:4 row_mask:0xf bank_mask:0xf bound_ctrl:0
    s_nop 0
    v_add_f32_dpp v60, v60, v60 row_shr:8 row_mask:0xf bank_mask:0xf bound_ctrl:0
    v_add_f32_dpp v61, v61, v61 row_shr:8 row_mask:0xf bank_mask:0xf bound_ctrl:0
    s_nop 0
    v_add_f32_dpp v60, v60, v60 row_bcast:15 row_mask:0xa bank_mask:0xf
    v_add_f32_dpp v61, v61, v61 row_bcast:15 row_mask:0xa bank_mask:0xf
    s_nop 0
    v_add_f32_dpp v60, v60, v60 row_bcast:31 row_mask:0xc bank_mask:0xf
    v_add_f32_dpp v61, v61, v61 row_bcast:31 row_mask:0xc bank_mask:0xf
    s_nop 0
    v_readlane_b32 s42, v60, 63
    v_readlane_b32 s43, v61, 63
    s_nop 1
    v_mov_b32 v60, s42
    v_mov_b32 v61, s43
    v_mul_f32 v24, 0x3a800000, v60
    v_mul_f32 v25, 0x3a800000, v61
    v_pk_add_f32 v[44:45], v[100:101], v[24:25] neg_lo:[0,1] neg_hi:[0,1]
    v_pk_mul_f32 v[60:61], v[44:45], v[44:45]
    v_pk_add_f32 v[44:45], v[120:121], v[24:25] neg_lo:[0,1] neg_hi:[0,1]
    v_pk_fma_f32 v[60:61], v[44:45], v[44:45], v[60:61]
    v_pk_add_f32 v[44:45], v[70:71], v[24:25] neg_lo:[0,1] neg_hi:[0,1]
    v_pk_fma_f32 v[60:61], v[44:45], v[44:45], v[60:61]
    v_pk_add_f32 v[44:45], v[80:81], v[24:25] neg_lo:[0,1] neg_hi:[0,1]
    v_pk_fma_f32 v[60:61], v[44:45], v[44:45], v[60:61]
    v_pk_add_f32 v[44:45], v[104:105], v[24:25] neg_lo:[0,1] neg_hi:[0,1]
    v_pk_fma_f32 v[60:61], v[44:45], v[44:45], v[60:61]
    v_pk_add_f32 v[44:45], v[116:117], v[24:25] neg_lo:[0,1] neg_hi:[0,1]
    v_pk_fma_f32 v[60:61], v[44:45], v[44:45], v[60:61]
    v_pk_add_f32 v[44:45], v[102:103], v[24:25] neg_lo:[0,1] neg_hi:[0,1]
    v_pk_fma_f32 v[60:61], v[44:45], v[44:45], v[60:61]
    v_pk_add_f32 v[44:45], v[42:43], v[24:25] neg_lo:[0,1] neg_hi:[0,1]
    v_pk_fma_f32 v[60:61], v[44:45], v[44:45], v[60:61]
    v_pk_add_f32 v[44:45], v[52:53], v[24:25] neg_lo:[0,1] neg_hi:[0,1]
    v_pk_fma_f32 v[60:61], v[44:45], v[44:45], v[60:61]
    v_pk_add_f32 v[44:45], v[90:91], v[24:25] neg_lo:[0,1] neg_hi:[0,1]
    v_pk_fma_f32 v[60:61], v[44:45], v[44:45], v[60:61]
    v_pk_add_f32 v[44:45], v[82:83], v[24:25] neg_lo:[0,1] neg_hi:[0,1]
    v_pk_fma_f32 v[60:61], v[44:45], v[44:45], v[60:61]
    v_pk_add_f32 v[44:45], v[36:37], v[24:25] neg_lo:[0,1] neg_hi:[0,1]
    v_pk_fma_f32 v[60:61], v[44:45], v[44:45], v[60:61]
    v_pk_add_f32 v[44:45], v[98:99], v[24:25] neg_lo:[0,1] neg_hi:[0,1]
    v_pk_fma_f32 v[60:61], v[44:45], v[44:45], v[60:61]
    v_pk_add_f32 v[44:45], v[50:51], v[24:25] neg_lo:[0,1] neg_hi:[0,1]
    v_pk_fma_f32 v[60:61], v[44:45], v[44:45], v[60:61]
    v_pk_add_f32 v[44:45], v[96:97], v[24:25] neg_lo:[0,1] neg_hi:[0,1]
    v_pk_fma_f32 v[60:61], v[44:45], v[44:45], v[60:61]
    v_pk_add_f32 v[44:45], v[92:93], v[24:25] neg_lo:[0,1] neg_hi:[0,1]
    v_pk_fma_f32 v[60:61], v[44:45], v[44:45], v[60:61]
    s_nop 1
    v_add_f32_dpp v60, v60, v60 row_shr:1 row_mask:0xf bank_mask:0xf bound_ctrl:0
    v_add_f32_dpp v61, v61, v61 row_shr:1 row_mask:0xf bank_mask:0xf bound_ctrl:0
    s_nop 0
    v_add_f32_dpp v60, v60, v60 row_shr:2 row_mask:0xf bank_mask:0xf bound_ctrl:0
    v_add_f32_dpp v61, v61, v61 row_shr:2 row_mask:0xf bank_mask:0xf bound_ctrl:0
    s_nop 0
    v_add_f32_dpp v60, v60, v60 row_shr:4 row_mask:0xf bank_mask:0xf bound_ctrl:0
    v_add_f32_dpp v61, v61, v61 row_shr:4 row_mask:0xf bank_mask:0xf bound_ctrl:0
    s_nop 0
    v_add_f32_dpp v60, v60, v60 row_shr:8 row_mask:0xf bank_mask:0xf bound_ctrl:0
    v_add_f32_dpp v61, v61, v61 row_shr:8 row_mask:0xf bank_mask:0xf bound_ctrl:0
    s_nop 0
    v_add_f32_dpp v60, v60, v60 row_bcast:15 row_mask:0xa bank_mask:0xf
    v_add_f32_dpp v61, v61, v61 row_bcast:15 row_mask:0xa bank_mask:0xf
    s_nop 0
    v_add_f32_dpp v60, v60, v60 row_bcast:31 row_mask:0xc bank_mask:0xf
    v_add_f32_dpp v61, v61, v61 row_bcast:31 row_mask:0xc bank_mask:0xf
    s_nop 0
    v_readlane_b32 s42, v60, 63
    v_readlane_b32 s43, v61, 63
    s_nop 1
    v_mov_b32 v60, s42
    v_mov_b32 v61, s43
    v_mul_f32 v60, 0x3a800000, v60
    v_cvt_pk_bf16_f32 v60, v60, v60
    v_and_b32 v60, 0xffff0000, v60
    v_add_f32 v60, 0x3727c5ac, v60
    v_cvt_pk_bf16_f32 v60, v60, v60
    v_and_b32 v60, 0xffff0000, v60
    v_sqrt_f32 v60, v60
    s_nop 0
    v_cvt_pk_bf16_f32 v60, v60, v60
    v_and_b32 v60, 0xffff0000, v60
    v_rcp_f32 v60, v60
    v_cvt_pk_bf16_f32 v24, v24, v24
    v_and_b32 v24, 0xffff0000, v24
    v_mul_f32 v61, 0x3a800000, v61
    v_cvt_pk_bf16_f32 v61, v61, v61
    v_and_b32 v61, 0xffff0000, v61
    v_add_f32 v61, 0x3727c5ac, v61
    v_cvt_pk_bf16_f32 v61, v61, v61
    v_and_b32 v61, 0xffff0000, v61
    v_sqrt_f32 v61, v61
    s_nop 0
    v_cvt_pk_bf16_f32 v61, v61, v61
    v_and_b32 v61, 0xffff0000, v61
    v_rcp_f32 v61, v61
    v_cvt_pk_bf16_f32 v25, v25, v25
    v_and_b32 v25, 0xffff0000, v25
    v_pk_add_f32 v[100:101], v[100:101], v[24:25] neg_lo:[0,1] neg_hi:[0,1]
    v_cvt_pk_bf16_f32 v44, v100, v101
    v_lshlrev_b32 v100, 16, v44
    v_and_b32 v101, 0xffff0000, v44
    v_pk_mul_f32 v[100:101], v[100:101], v[60:61]
    v_cvt_pk_bf16_f32 v44, v100, v101
    v_lshlrev_b32 v100, 16, v44
    v_and_b32 v101, 0xffff0000, v44
    v_pk_add_f32 v[120:121], v[120:121], v[24:25] neg_lo:[0,1] neg_hi:[0,1]
    v_cvt_pk_bf16_f32 v44, v120, v121
    v_lshlrev_b32 v120, 16, v44
    v_and_b32 v121, 0xffff0000, v44
    v_pk_mul_f32 v[120:121], v[120:121], v[60:61]
    v_cvt_pk_bf16_f32 v44, v120, v121
    v_lshlrev_b32 v120, 16, v44
    v_and_b32 v121, 0xffff0000, v44
    v_pk_add_f32 v[70:71], v[70:71], v[24:25] neg_lo:[0,1] neg_hi:[0,1]
    v_cvt_pk_bf16_f32 v44, v70, v71
    v_lshlrev_b32 v70, 16, v44
    v_and_b32 v71, 0xffff0000, v44
    v_pk_mul_f32 v[70:71], v[70:71], v[60:61]
    v_cvt_pk_bf16_f32 v44, v70, v71
    v_lshlrev_b32 v70, 16, v44
    v_and_b32 v71, 0xffff0000, v44
    v_pk_add_f32 v[80:81], v[80:81], v[24:25] neg_lo:[0,1] neg_hi:[0,1]
    v_cvt_pk_bf16_f32 v44, v80, v81
    v_lshlrev_b32 v80, 16, v44
    v_and_b32 v81, 0xffff0000, v44
    v_pk_mul_f32 v[80:81], v[80:81], v[60:61]
    v_cvt_pk_bf16_f32 v44, v80, v81
    v_lshlrev_b32 v80, 16, v44
    v_and_b32 v81, 0xffff0000, v44
    v_pk_add_f32 v[104:105], v[104:105], v[24:25] neg_lo:[0,1] neg_hi:[0,1]
    v_cvt_pk_bf16_f32 v44, v104, v105
    v_lshlrev_b32 v104, 16, v44
    v_and_b32 v105, 0xffff0000, v44
    v_pk_mul_f32 v[104:105], v[104:105], v[60:61]
    v_cvt_pk_bf16_f32 v44, v104, v105
    v_lshlrev_b32 v104, 16, v44
    v_and_b32 v105, 0xffff0000, v44
    v_pk_add_f32 v[116:117], v[116:117], v[24:25] neg_lo:[0,1] neg_hi:[0,1]
    v_cvt_pk_bf16_f32 v44, v116, v117
    v_lshlrev_b32 v116, 16, v44
    v_and_b32 v117, 0xffff0000, v44
    v_pk_mul_f32 v[116:117], v[116:117], v[60:61]
    v_cvt_pk_bf16_f32 v44, v116, v117
    v_lshlrev_b32 v116, 16, v44
    v_and_b32 v117, 0xffff0000, v44
    v_pk_add_f32 v[102:103], v[102:103], v[24:25] neg_lo:[0,1] neg_hi:[0,1]
    v_cvt_pk_bf16_f32 v44, v102, v103
    v_lshlrev_b32 v102, 16, v44
    v_and_b32 v103, 0xffff0000, v44
    v_pk_mul_f32 v[102:103], v[102:103], v[60:61]
    v_cvt_pk_bf16_f32 v44, v102, v103
    v_lshlrev_b32 v102, 16, v44
    v_and_b32 v103, 0xffff0000, v44
    v_pk_add_f32 v[42:43], v[42:43], v[24:25] neg_lo:[0,1] neg_hi:[0,1]
    v_cvt_pk_bf16_f32 v44, v42, v43
    v_lshlrev_b32 v42, 16, v44
    v_and_b32 v43, 0xffff0000, v44
    v_pk_mul_f32 v[42:43], v[42:43], v[60:61]
    v_cvt_pk_bf16_f32 v44, v42, v43
    v_lshlrev_b32 v42, 16, v44
    v_and_b32 v43, 0xffff0000, v44
    v_pk_add_f32 v[52:53], v[52:53], v[24:25] neg_lo:[0,1] neg_hi:[0,1]
    v_cvt_pk_bf16_f32 v44, v52, v53
    v_lshlrev_b32 v52, 16, v44
    v_and_b32 v53, 0xffff0000, v44
    v_pk_mul_f32 v[52:53], v[52:53], v[60:61]
    v_cvt_pk_bf16_f32 v44, v52, v53
    v_lshlrev_b32 v52, 16, v44
    v_and_b32 v53, 0xffff0000, v44
    v_pk_add_f32 v[90:91], v[90:91], v[24:25] neg_lo:[0,1] neg_hi:[0,1]
    v_cvt_pk_bf16_f32 v44, v90, v91
    v_lshlrev_b32 v90, 16, v44
    v_and_b32 v91, 0xffff0000, v44
    v_pk_mul_f32 v[90:91], v[90:91], v[60:61]
    v_cvt_pk_bf16_f32 v44, v90, v91
    v_lshlrev_b32 v90, 16, v44
    v_and_b32 v91, 0xffff0000, v44
    v_pk_add_f32 v[82:83], v[82:83], v[24:25] neg_lo:[0,1] neg_hi:[0,1]
    v_cvt_pk_bf16_f32 v44, v82, v83
    v_lshlrev_b32 v82, 16, v44
    v_and_b32 v83, 0xffff0000, v44
    v_pk_mul_f32 v[82:83], v[82:83], v[60:61]
    v_cvt_pk_bf16_f32 v44, v82, v83
    v_lshlrev_b32 v82, 16, v44
    v_and_b32 v83, 0xffff0000, v44
    v_pk_add_f32 v[36:37], v[36:37], v[24:25] neg_lo:[0,1] neg_hi:[0,1]
    v_cvt_pk_bf16_f32 v44, v36, v37
    v_lshlrev_b32 v36, 16, v44
    v_and_b32 v37, 0xffff0000, v44
    v_pk_mul_f32 v[36:37], v[36:37], v[60:61]
    v_cvt_pk_bf16_f32 v44, v36, v37
    v_lshlrev_b32 v36, 16, v44
    v_and_b32 v37, 0xffff0000, v44
    v_pk_add_f32 v[98:99], v[98:99], v[24:25] neg_lo:[0,1] neg_hi:[0,1]
    v_cvt_pk_bf16_f32 v44, v98, v99
    v_lshlrev_b32 v98, 16, v44
    v_and_b32 v99, 0xffff0000, v44
    v_pk_mul_f32 v[98:99], v[98:99], v[60:61]
    v_cvt_pk_bf16_f32 v44, v98, v99
    v_lshlrev_b32 v98, 16, v44
    v_and_b32 v99, 0xffff0000, v44
    v_pk_add_f32 v[50:51], v[50:51], v[24:25] neg_lo:[0,1] neg_hi:[0,1]
    v_cvt_pk_bf16_f32 v44, v50, v51
    v_lshlrev_b32 v50, 16, v44
    v_and_b32 v51, 0xffff0000, v44
    v_pk_mul_f32 v[50:51], v[50:51], v[60:61]
    v_cvt_pk_bf16_f32 v44, v50, v51
    v_lshlrev_b32 v50, 16, v44
    v_and_b32 v51, 0xffff0000, v44
    v_pk_add_f32 v[96:97], v[96:97], v[24:25] neg_lo:[0,1] neg_hi:[0,1]
    v_cvt_pk_bf16_f32 v44, v96, v97
    v_lshlrev_b32 v96, 16, v44
    v_and_b32 v97, 0xffff0000, v44
    v_pk_mul_f32 v[96:97], v[96:97], v[60:61]
    v_cvt_pk_bf16_f32 v44, v96, v97
    v_lshlrev_b32 v96, 16, v44
    v_and_b32 v97, 0xffff0000, v44
    v_pk_add_f32 v[92:93], v[92:93], v[24:25] neg_lo:[0,1] neg_hi:[0,1]
    v_cvt_pk_bf16_f32 v44, v92, v93
    v_lshlrev_b32 v92, 16, v44
    v_and_b32 v93, 0xffff0000, v44
    v_pk_mul_f32 v[92:93], v[92:93], v[60:61]
    v_cvt_pk_bf16_f32 v44, v92, v93
    v_lshlrev_b32 v92, 16, v44
    v_and_b32 v93, 0xffff0000, v44
    v_cvt_pk_bf16_f32 v8, v100, v120
    v_cvt_pk_bf16_f32 v16, v101, v121
    v_cvt_pk_bf16_f32 v9, v70, v80
    v_cvt_pk_bf16_f32 v17, v71, v81
    v_cvt_pk_bf16_f32 v10, v104, v116
    v_cvt_pk_bf16_f32 v18, v105, v117
    v_cvt_pk_bf16_f32 v11, v102, v42
    v_cvt_pk_bf16_f32 v19, v103, v43
    v_cvt_pk_bf16_f32 v12, v52, v90
    v_cvt_pk_bf16_f32 v20, v53, v91
    v_cvt_pk_bf16_f32 v13, v82, v36
    v_cvt_pk_bf16_f32 v21, v83, v37
    v_cvt_pk_bf16_f32 v14, v98, v50
    v_cvt_pk_bf16_f32 v22, v99, v51
    v_cvt_pk_bf16_f32 v15, v96, v92
    v_cvt_pk_bf16_f32 v23, v97, v93
    buffer_store_dwordx4 v[8:11], v3, s[24:27], 0 offen sc1
    buffer_store_dwordx4 v[12:15], v3, s[24:27], 0 offen offset:1024 sc1
    buffer_store_dwordx4 v[16:19], v3, s[24:27], 0 offen offset:2048 sc1
    buffer_store_dwordx4 v[20:23], v3, s[24:27], 0 offen offset:3072 sc1
    s_branch k3_end
k3_tr:
    s_mov_b32 s16, s10
    s_mov_b32 s17, s11
    s_mov_b32 s18, 0x700000
    s_mov_b32 s19, 0x00020000
    s_add_u32 s20, s12, 0x3000000
    s_addc_u32 s21, s13, 0
    s_mov_b32 s22, 0x700000
    s_mov_b32 s23, 0x00020000
    v_lshrrev_b32 v1, 6, v0
    s_nop 0
    v_readfirstlane_b32 s40, v1
    s_sub_u32 s41, s2, 256
    s_lshl_b32 s41, s41, 2
    s_add_u32 s41, s41, s40
    s_mov_b32 s60, 0x4924925
    s_mul_hi_u32 s61, s41, s60
    s_mul_i32 s62, s61, 56
    s_sub_u32 s62, s41, s62
    s_mul_i32 s63, s61, 458752
    s_lshl_b32 s64, s62, 7
    s_add_u32 s63, s63, s64
    s_mul_i32 s64, s62, 131072
    s_lshl_b32 s65, s61, 7
    s_add_u32 s64, s64, s65
    v_and_b32 v8, 63, v0
    v_and_b32 v9, 7, v8
    v_lshrrev_b32 v10, 3, v8
    v_mul_u32_u24 v11, 57344, v10
    v_lshl_add_u32 v11, v9, 4, v11
    v_mul_u32_u24 v12, 16384, v9
    v_lshl_add_u32 v12, v10, 4, v12
    s_add_u32 s65, s63, 0
    buffer_load_dwordx4 v[16:19], v11, s[16:19], s65 offen
    s_add_u32 s65, s63, 7168
    buffer_load_dwordx4 v[20:23], v11, s[16:19], s65 offen
    s_add_u32 s65, s63, 14336
    buffer_load_dwordx4 v[24:27], v11, s[16:19], s65 offen
    s_add_u32 s65, s63, 21504
    buffer_load_dwordx4 v[28:31], v11, s[16:19], s65 offen
    s_add_u32 s65, s63, 28672
    buffer_load_dwordx4 v[32:35], v11, s[16:19], s65 offen
    s_add_u32 s65, s63, 35840
    buffer_load_dwordx4 v[36:39], v11, s[16:19], s65 offen
    s_add_u32 s65, s63, 43008
    buffer_load_dwordx4 v[40:43], v11, s[16:19], s65 offen
    s_add_u32 s65, s63, 50176
    buffer_load_dwordx4 v[44:47], v11, s[16:19], s65 offen
    s_mov_b32 s66, 0x05040100
    s_mov_b32 s67, 0x07060302
    s_waitcnt vmcnt(0)
    v_perm_b32 v48, v20, v16, s66
    v_perm_b32 v49, v28, v24, s66
    v_perm_b32 v50, v36, v32, s66
    v_perm_b32 v51, v44, v40, s66
    v_perm_b32 v52, v20, v16, s67
    v_perm_b32 v53, v28, v24, s67
    v_perm_b32 v54, v36, v32, s67
    v_perm_b32 v55, v44, v40, s67
    v_perm_b32 v56, v21, v17, s66
    v_perm_b32 v57, v29, v25, s66
    v_perm_b32 v58, v37, v33, s66
    v_perm_b32 v59, v45, v41, s66
    v_perm_b32 v60, v21, v17, s67
    v_perm_b32 v61, v29, v25, s67
    v_perm_b32 v62, v37, v33, s67
    v_perm_b32 v63, v45, v41, s67
    v_perm_b32 v64, v22, v18, s66
    v_perm_b32 v65, v30, v26, s66
    v_perm_b32 v66, v38, v34, s66
    v_perm_b32 v67, v46, v42, s66
    v_perm_b32 v68, v22, v18, s67
    v_perm_b32 v69, v30, v26, s67
    v_perm_b32 v70, v38, v34, s67
    v_perm_b32 v71, v46, v42, s67
    v_perm_b32 v72, v23, v19, s66
    v_perm_b32 v73, v31, v27, s66
    v_perm_b32 v74, v39, v35, s66
    v_perm_b32 v75, v47, v43, s66
    v_perm_b32 v76, v23, v19, s67
    v_perm_b32 v77, v31, v27, s67
    v_perm_b32 v78, v39, v35, s67
    v_perm_b32 v79, v47, v43, s67
    s_add_u32 s65, s64, 0
    buffer_store_dwordx4 v[48:51], v12, s[20:23], s65 offen sc1
    s_add_u32 s65, s64, 2048
    buffer_store_dwordx4 v[52:55], v12, s[20:23], s65 offen sc1
    s_add_u32 s65, s64, 4096
    buffer_store_dwordx4 v[56:59], v12, s[20:23], s65 offen sc1
    s_add_u32 s65, s64, 6144
    buffer_store_dwordx4 v[60:63], v12, s[20:23], s65 offen sc1
    s_add_u32 s65, s64, 8192
    buffer_store_dwordx4 v[64:67], v12, s[20:23], s65 offen sc1
    s_add_u32 s65, s64, 10240
    buffer_store_dwordx4 v[68:71], v12, s[20:23], s65 offen sc1
    s_add_u32 s65, s64, 12288
    buffer_store_dwordx4 v[72:75], v12, s[20:23], s65 offen sc1
    s_add_u32 s65, s64, 14336
    buffer_store_dwordx4 v[76:79], v12, s[20:23], s65 offen sc1
k3_end:
    s_endpgm
.p2align 8
.globl k4_kernel
.type k4_kernel,@function
k4_kernel:
    s_cmp_ge_u32 s2, 256
    s_cbranch_scc1 k4_kernel_end
    s_load_dwordx2 s[4:5], s[0:1], 40
    s_load_dwordx2 s[6:7], s[0:1], 56
    s_load_dwordx2 s[12:13], s[0:1], 72
    s_and_b32 s40, s2, 7
    s_lshr_b32 s41, s2, 3
    s_lshr_b32 s42, s40, 2
    s_and_b32 s43, s40, 3
    s_lshr_b32 s44, s41, 2
    s_and_b32 s45, s41, 3
    s_lshl_b32 s42, s42, 3
    s_add_u32 s42, s42, s44
    s_lshl_b32 s43, s43, 2
    s_add_u32 s43, s43, s45
    v_lshrrev_b32 v1, 6, v0
    v_and_b32 v2, 63, v0
    s_nop 0
    v_readfirstlane_b32 s46, v1
    s_waitcnt lgkmcnt(0)
    s_cmp_ge_u32 s46, 4
    s_cbranch_scc1 k4_kernel_prod
    v_lshrrev_b32 v4, 4, v2
    v_and_b32 v5, 7, v2
    v_xor_b32 v4, v4, v5
    v_and_b32 v5, 15, v2
    v_lshlrev_b32 v5, 7, v5
    v_lshl_add_u32 v4, v4, 4, v5
    s_lshr_b32 s58, s46, 1
    s_and_b32 s59, s46, 1
    s_mul_i32 s60, s58, 8192
    s_mul_i32 s61, s59, 14336
    s_add_u32 s61, s61, 16384
    v_add_u32 v6, s60, v4
    v_xor_b32 v7, 64, v6
    v_add_u32 v8, s61, v4
    v_xor_b32 v9, 64, v8
    s_mov_b32 s80, 0
    s_mov_b32 s81, 45056
    s_mov_b32 s82, 90112
    v_accvgpr_write_b32 a0, 0
    v_accvgpr_write_b32 a1, 0
    v_accvgpr_write_b32 a2, 0
    v_accvgpr_write_b32 a3, 0
    v_accvgpr_write_b32 a4, 0
    v_accvgpr_write_b32 a5, 0
    v_accvgpr_write_b32 a6, 0
    v_accvgpr_write_b32 a7, 0
    v_accvgpr_write_b32 a8, 0
    v_accvgpr_write_b32 a9, 0
    v_accvgpr_write_b32 a10, 0
    v_accvgpr_write_b32 a11, 0
    v_accvgpr_write_b32 a12, 0
    v_accvgpr_write_b32 a13, 0
    v_accvgpr_write_b32 a14, 0
    v_accvgpr_write_b32 a15, 0
    v_accvgpr_write_b32 a16, 0
    v_accvgpr_write_b32 a17, 0
    v_accvgpr_write_b32 a18, 0
    v_accvgpr_write_b32 a19, 0
    v_accvgpr_write_b32 a20, 0
    v_accvgpr_write_b32 a21, 0
    v_accvgpr_write_b32 a22, 0
    v_accvgpr_write_b32 a23, 0
    v_accvgpr_write_b32 a24, 0
    v_accvgpr_write_b32 a25, 0
    v_accvgpr_write_b32 a26, 0
    v_accvgpr_write_b32 a27, 0
    v_accvgpr_write_b32 a28, 0
    v_accvgpr_write_b32 a29, 0
    v_accvgpr_write_b32 a30, 0
    v_accvgpr_write_b32 a31, 0
    v_accvgpr_write_b32 a32, 0
    v_accvgpr_write_b32 a33, 0
    v_accvgpr_write_b32 a34, 0
    v_accvgpr_write_b32 a35, 0
    v_accvgpr_write_b32 a36, 0
    v_accvgpr_write_b32 a37, 0
    v_accvgpr_write_b32 a38, 0
    v_accvgpr_write_b32 a39, 0
    v_accvgpr_write_b32 a40, 0
    v_accvgpr_write_b32 a41, 0
    v_accvgpr_write_b32 a42, 0
    v_accvgpr_write_b32 a43, 0
    v_accvgpr_write_b32 a44, 0
    v_accvgpr_write_b32 a45, 0
    v_accvgpr_write_b32 a46, 0
    v_accvgpr_write_b32 a47, 0
    v_accvgpr_write_b32 a48, 0
    v_accvgpr_write_b32 a49, 0
    v_accvgpr_write_b32 a50, 0
    v_accvgpr_write_b32 a51, 0
    v_accvgpr_write_b32 a52, 0
    v_accvgpr_write_b32 a53, 0
    v_accvgpr_write_b32 a54, 0
    v_accvgpr_write_b32 a55, 0
    v_accvgpr_write_b32 a56, 0
    v_accvgpr_write_b32 a57, 0
    v_accvgpr_write_b32 a58, 0
    v_accvgpr_write_b32 a59, 0
    v_accvgpr_write_b32 a60, 0
    v_accvgpr_write_b32 a61, 0
    v_accvgpr_write_b32 a62, 0
    v_accvgpr_write_b32 a63, 0
    v_accvgpr_write_b32 a64, 0
    v_accvgpr_write_b32 a65, 0
    v_accvgpr_write_b32 a66, 0
    v_accvgpr_write_b32 a67, 0
    v_accvgpr_write_b32 a68, 0
    v_accvgpr_write_b32 a69, 0
    v_accvgpr_write_b32 a70, 0
    v_accvgpr_write_b32 a71, 0
    v_accvgpr_write_b32 a72, 0
    v_accvgpr_write_b32 a73, 0
    v_accvgpr_write_b32 a74, 0
    v_accvgpr_write_b32 a75, 0
    v_accvgpr_write_b32 a76, 0
    v_accvgpr_write_b32 a77, 0
    v_accvgpr_write_b32 a78, 0
    v_accvgpr_write_b32 a79, 0
    v_accvgpr_write_b32 a80, 0
    v_accvgpr_write_b32 a81, 0
    v_accvgpr_write_b32 a82, 0
    v_accvgpr_write_b32 a83, 0
    v_accvgpr_write_b32 a84, 0
    v_accvgpr_write_b32 a85, 0
    v_accvgpr_write_b32 a86, 0
    v_accvgpr_write_b32 a87, 0
    v_accvgpr_write_b32 a88, 0
    v_accvgpr_write_b32 a89, 0
    v_accvgpr_write_b32 a90, 0
    v_accvgpr_write_b32 a91, 0
    v_accvgpr_write_b32 a92, 0
    v_accvgpr_write_b32 a93, 0
    v_accvgpr_write_b32 a94, 0
    v_accvgpr_write_b32 a95, 0
    v_accvgpr_write_b32 a96, 0
    v_accvgpr_write_b32 a97, 0
    v_accvgpr_write_b32 a98, 0
    v_accvgpr_write_b32 a99, 0
    v_accvgpr_write_b32 a100, 0
    v_accvgpr_write_b32 a101, 0
    v_accvgpr_write_b32 a102, 0
    v_accvgpr_write_b32 a103, 0
    v_accvgpr_write_b32 a104, 0
    v_accvgpr_write_b32 a105, 0
    v_accvgpr_write_b32 a106, 0
    v_accvgpr_write_b32 a107, 0
    v_accvgpr_write_b32 a108, 0
    v_accvgpr_write_b32 a109, 0
    v_accvgpr_write_b32 a110, 0
    v_accvgpr_write_b32 a111, 0
    s_barrier
    v_add_u32 v10, s80, v6
    v_add_u32 v12, s80, v8
    ds_read_b128 v[16:19], v10 offset:0
    ds_read_b128 v[32:35], v12 offset:0
    ds_read_b128 v[36:39], v12 offset:2048
    ds_read_b128 v[40:43], v12 offset:4096
    ds_read_b128 v[44:47], v12 offset:6144
    ds_read_b128 v[48:51], v12 offset:8192
    ds_read_b128 v[52:55], v12 offset:10240
    ds_read_b128 v[56:59], v12 offset:12288
    ds_read_b128 v[20:23], v10 offset:2048
    ds_read_b128 v[24:27], v10 offset:4096
    ds_read_b128 v[28:31], v10 offset:6144
    v_add_u32 v11, s80, v7
    v_add_u32 v13, s80, v9
    s_mov_b32 s63, 15
k4_kernel_cloop:
    s_waitcnt lgkmcnt(0)
    v_mfma_f32_16x16x32_bf16 a[0:3], v[32:35], v[16:19], a[0:3]
    ds_read_b128 v[60:63], v11 offset:0
    v_mfma_f32_16x16x32_bf16 a[4:7], v[36:39], v[16:19], a[4:7]
    v_mfma_f32_16x16x32_bf16 a[8:11], v[40:43], v[16:19], a[8:11]
    ds_read_b128 v[76:79], v13 offset:0
    v_mfma_f32_16x16x32_bf16 a[12:15], v[44:47], v[16:19], a[12:15]
    v_mfma_f32_16x16x32_bf16 a[16:19], v[48:51], v[16:19], a[16:19]
    ds_read_b128 v[80:83], v13 offset:2048
    v_mfma_f32_16x16x32_bf16 a[20:23], v[52:55], v[16:19], a[20:23]
    v_mfma_f32_16x16x32_bf16 a[24:27], v[56:59], v[16:19], a[24:27]
    ds_read_b128 v[84:87], v13 offset:4096
    v_mfma_f32_16x16x32_bf16 a[28:31], v[32:35], v[20:23], a[28:31]
    v_mfma_f32_16x16x32_bf16 a[32:35], v[36:39], v[20:23], a[32:35]
    ds_read_b128 v[88:91], v13 offset:6144
    v_mfma_f32_16x16x32_bf16 a[36:39], v[40:43], v[20:23], a[36:39]
    v_mfma_f32_16x16x32_bf16 a[40:43], v[44:47], v[20:23], a[40:43]
    ds_read_b128 v[92:95], v13 offset:8192
    v_mfma_f32_16x16x32_bf16 a[44:47], v[48:51], v[20:23], a[44:47]
    v_mfma_f32_16x16x32_bf16 a[48:51], v[52:55], v[20:23], a[48:51]
    ds_read_b128 v[96:99], v13 offset:10240
    v_mfma_f32_16x16x32_bf16 a[52:55], v[56:59], v[20:23], a[52:55]
    v_mfma_f32_16x16x32_bf16 a[56:59], v[32:35], v[24:27], a[56:59]
    ds_read_b128 v[100:103], v13 offset:12288
    v_mfma_f32_16x16x32_bf16 a[60:63], v[36:39], v[24:27], a[60:63]
    v_mfma_f32_16x16x32_bf16 a[64:67], v[40:43], v[24:27], a[64:67]
    ds_read_b128 v[64:67], v11 offset:2048
    v_mfma_f32_16x16x32_bf16 a[68:71], v[44:47], v[24:27], a[68:71]
    v_mfma_f32_16x16x32_bf16 a[72:75], v[48:51], v[24:27], a[72:75]
    ds_read_b128 v[68:71], v11 offset:4096
    v_mfma_f32_16x16x32_bf16 a[76:79], v[52:55], v[24:27], a[76:79]
    v_mfma_f32_16x16x32_bf16 a[80:83], v[56:59], v[24:27], a[80:83]
    ds_read_b128 v[72:75], v11 offset:6144
    v_mfma_f32_16x16x32_bf16 a[84:87], v[32:35], v[28:31], a[84:87]
    v_mfma_f32_16x16x32_bf16 a[88:91], v[36:39], v[28:31], a[88:91]
    v_mfma_f32_16x16x32_bf16 a[92:95], v[40:43], v[28:31], a[92:95]
    v_mfma_f32_16x16x32_bf16 a[96:99], v[44:47], v[28:31], a[96:99]
    v_mfma_f32_16x16x32_bf16 a[100:103], v[48:51], v[28:31], a[100:103]
    v_mfma_f32_16x16x32_bf16 a[104:107], v[52:55], v[28:31], a[104:107]
    v_mfma_f32_16x16x32_bf16 a[108:111], v[56:59], v[28:31], a[108:111]
    s_mov_b32 s62, s80
    s_mov_b32 s80, s81
    s_mov_b32 s81, s82
    s_mov_b32 s82, s62
    v_add_u32 v10, s80, v6
    v_add_u32 v12, s80, v8
    s_waitcnt lgkmcnt(0)
    s_barrier
    v_mfma_f32_16x16x32_bf16 a[0:3], v[76:79], v[60:63], a[0:3]
    ds_read_b128 v[16:19], v10 offset:0
    v_mfma_f32_16x16x32_bf16 a[4:7], v[80:83], v[60:63], a[4:7]
    v_mfma_f32_16x16x32_bf16 a[8:11], v[84:87], v[60:63], a[8:11]
    ds_read_b128 v[32:35], v12 offset:0
    v_mfma_f32_16x16x32_bf16 a[12:15], v[88:91], v[60:63], a[12:15]
    v_mfma_f32_16x16x32_bf16 a[16:19], v[92:95], v[60:63], a[16:19]
    ds_read_b128 v[36:39], v12 offset:2048
    v_mfma_f32_16x16x32_bf16 a[20:23], v[96:99], v[60:63], a[20:23]
    v_mfma_f32_16x16x32_bf16 a[24:27], v[100:103], v[60:63], a[24:27]
    ds_read_b128 v[40:43], v12 offset:4096
    v_mfma_f32_16x16x32_bf16 a[28:31], v[76:79], v[64:67], a[28:31]
    v_mfma_f32_16x16x32_bf16 a[32:35], v[80:83], v[64:67], a[32:35]
    ds_read_b128 v[44:47], v12 offset:6144
    v_mfma_f32_16x16x32_bf16 a[36:39], v[84:87], v[64:67], a[36:39]
    v_mfma_f32_16x16x32_bf16 a[40:43], v[88:91], v[64:67], a[40:43]
    ds_read_b128 v[48:51], v12 offset:8192
    v_mfma_f32_16x16x32_bf16 a[44:47], v[92:95], v[64:67], a[44:47]
    v_mfma_f32_16x16x32_bf16 a[48:51], v[96:99], v[64:67], a[48:51]
    ds_read_b128 v[52:55], v12 offset:10240
    v_mfma_f32_16x16x32_bf16 a[52:55], v[100:103], v[64:67], a[52:55]
    v_mfma_f32_16x16x32_bf16 a[56:59], v[76:79], v[68:71], a[56:59]
    ds_read_b128 v[56:59], v12 offset:12288
    v_mfma_f32_16x16x32_bf16 a[60:63], v[80:83], v[68:71], a[60:63]
    v_mfma_f32_16x16x32_bf16 a[64:67], v[84:87], v[68:71], a[64:67]
    ds_read_b128 v[20:23], v10 offset:2048
    v_mfma_f32_16x16x32_bf16 a[68:71], v[88:91], v[68:71], a[68:71]
    v_mfma_f32_16x16x32_bf16 a[72:75], v[92:95], v[68:71], a[72:75]
    ds_read_b128 v[24:27], v10 offset:4096
    v_mfma_f32_16x16x32_bf16 a[76:79], v[96:99], v[68:71], a[76:79]
    v_mfma_f32_16x16x32_bf16 a[80:83], v[100:103], v[68:71], a[80:83]
    ds_read_b128 v[28:31], v10 offset:6144
    v_mfma_f32_16x16x32_bf16 a[84:87], v[76:79], v[72:75], a[84:87]
    v_mfma_f32_16x16x32_bf16 a[88:91], v[80:83], v[72:75], a[88:91]
    v_mfma_f32_16x16x32_bf16 a[92:95], v[84:87], v[72:75], a[92:95]
    v_mfma_f32_16x16x32_bf16 a[96:99], v[88:91], v[72:75], a[96:99]
    v_mfma_f32_16x16x32_bf16 a[100:103], v[92:95], v[72:75], a[100:103]
    v_mfma_f32_16x16x32_bf16 a[104:107], v[96:99], v[72:75], a[104:107]
    v_mfma_f32_16x16x32_bf16 a[108:111], v[100:103], v[72:75], a[108:111]
    v_add_u32 v11, s80, v7
    v_add_u32 v13, s80, v9
    s_sub_u32 s63, s63, 1
    s_cmp_lg_u32 s63, 0
    s_cbranch_scc1 k4_kernel_cloop
    s_waitcnt lgkmcnt(0)
    v_mfma_f32_16x16x32_bf16 a[0:3], v[32:35], v[16:19], a[0:3]
    ds_read_b128 v[60:63], v11 offset:0
    v_mfma_f32_16x16x32_bf16 a[4:7], v[36:39], v[16:19], a[4:7]
    v_mfma_f32_16x16x32_bf16 a[8:11], v[40:43], v[16:19], a[8:11]
    ds_read_b128 v[76:79], v13 offset:0
    v_mfma_f32_16x16x32_bf16 a[12:15], v[44:47], v[16:19], a[12:15]
    v_mfma_f32_16x16x32_bf16 a[16:19], v[48:51], v[16:19], a[16:19]
    ds_read_b128 v[80:83], v13 offset:2048
    v_mfma_f32_16x16x32_bf16 a[20:23], v[52:55], v[16:19], a[20:23]
    v_mfma_f32_16x16x32_bf16 a[24:27], v[56:59], v[16:19], a[24:27]
    ds_read_b128 v[84:87], v13 offset:4096
    v_mfma_f32_16x16x32_bf16 a[28:31], v[32:35], v[20:23], a[28:31]
    v_mfma_f32_16x16x32_bf16 a[32:35], v[36:39], v[20:23], a[32:35]
    ds_read_b128 v[88:91], v13 offset:6144
    v_mfma_f32_16x16x32_bf16 a[36:39], v[40:43], v[20:23], a[36:39]
    v_mfma_f32_16x16x32_bf16 a[40:43], v[44:47], v[20:23], a[40:43]
    ds_read_b128 v[92:95], v13 offset:8192
    v_mfma_f32_16x16x32_bf16 a[44:47], v[48:51], v[20:23], a[44:47]
    v_mfma_f32_16x16x32_bf16 a[48:51], v[52:55], v[20:23], a[48:51]
    ds_read_b128 v[96:99], v13 offset:10240
    v_mfma_f32_16x16x32_bf16 a[52:55], v[56:59], v[20:23], a[52:55]
    v_mfma_f32_16x16x32_bf16 a[56:59], v[32:35], v[24:27], a[56:59]
    ds_read_b128 v[100:103], v13 offset:12288
    v_mfma_f32_16x16x32_bf16 a[60:63], v[36:39], v[24:27], a[60:63]
    v_mfma_f32_16x16x32_bf16 a[64:67], v[40:43], v[24:27], a[64:67]
    ds_read_b128 v[64:67], v11 offset:2048
    v_mfma_f32_16x16x32_bf16 a[68:71], v[44:47], v[24:27], a[68:71]
    v_mfma_f32_16x16x32_bf16 a[72:75], v[48:51], v[24:27], a[72:75]
    ds_read_b128 v[68:71], v11 offset:4096
    v_mfma_f32_16x16x32_bf16 a[76:79], v[52:55], v[24:27], a[76:79]
    v_mfma_f32_16x16x32_bf16 a[80:83], v[56:59], v[24:27], a[80:83]
    ds_read_b128 v[72:75], v11 offset:6144
    v_mfma_f32_16x16x32_bf16 a[84:87], v[32:35], v[28:31], a[84:87]
    v_mfma_f32_16x16x32_bf16 a[88:91], v[36:39], v[28:31], a[88:91]
    v_mfma_f32_16x16x32_bf16 a[92:95], v[40:43], v[28:31], a[92:95]
    v_mfma_f32_16x16x32_bf16 a[96:99], v[44:47], v[28:31], a[96:99]
    v_mfma_f32_16x16x32_bf16 a[100:103], v[48:51], v[28:31], a[100:103]
    v_mfma_f32_16x16x32_bf16 a[104:107], v[52:55], v[28:31], a[104:107]
    v_mfma_f32_16x16x32_bf16 a[108:111], v[56:59], v[28:31], a[108:111]
    s_waitcnt lgkmcnt(0)
    v_mfma_f32_16x16x32_bf16 a[0:3], v[76:79], v[60:63], a[0:3]
    v_mfma_f32_16x16x32_bf16 a[4:7], v[80:83], v[60:63], a[4:7]
    v_mfma_f32_16x16x32_bf16 a[8:11], v[84:87], v[60:63], a[8:11]
    v_mfma_f32_16x16x32_bf16 a[12:15], v[88:91], v[60:63], a[12:15]
    v_mfma_f32_16x16x32_bf16 a[16:19], v[92:95], v[60:63], a[16:19]
    v_mfma_f32_16x16x32_bf16 a[20:23], v[96:99], v[60:63], a[20:23]
    v_mfma_f32_16x16x32_bf16 a[24:27], v[100:103], v[60:63], a[24:27]
    v_mfma_f32_16x16x32_bf16 a[28:31], v[76:79], v[64:67], a[28:31]
    v_mfma_f32_16x16x32_bf16 a[32:35], v[80:83], v[64:67], a[32:35]
    v_mfma_f32_16x16x32_bf16 a[36:39], v[84:87], v[64:67], a[36:39]
    v_mfma_f32_16x16x32_bf16 a[40:43], v[88:91], v[64:67], a[40:43]
    v_mfma_f32_16x16x32_bf16 a[44:47], v[92:95], v[64:67], a[44:47]
    v_mfma_f32_16x16x32_bf16 a[48:51], v[96:99], v[64:67], a[48:51]
    v_mfma_f32_16x16x32_bf16 a[52:55], v[100:103], v[64:67], a[52:55]
    v_mfma_f32_16x16x32_bf16 a[56:59], v[76:79], v[68:71], a[56:59]
    v_mfma_f32_16x16x32_bf16 a[60:63], v[80:83], v[68:71], a[60:63]
    v_mfma_f32_16x16x32_bf16 a[64:67], v[84:87], v[68:71], a[64:67]
    v_mfma_f32_16x16x32_bf16 a[68:71], v[88:91], v[68:71], a[68:71]
    v_mfma_f32_16x16x32_bf16 a[72:75], v[92:95], v[68:71], a[72:75]
    v_mfma_f32_16x16x32_bf16 a[76:79], v[96:99], v[68:71], a[76:79]
    v_mfma_f32_16x16x32_bf16 a[80:83], v[100:103], v[68:71], a[80:83]
    v_mfma_f32_16x16x32_bf16 a[84:87], v[76:79], v[72:75], a[84:87]
    v_mfma_f32_16x16x32_bf16 a[88:91], v[80:83], v[72:75], a[88:91]
    v_mfma_f32_16x16x32_bf16 a[92:95], v[84:87], v[72:75], a[92:95]
    v_mfma_f32_16x16x32_bf16 a[96:99], v[88:91], v[72:75], a[96:99]
    v_mfma_f32_16x16x32_bf16 a[100:103], v[92:95], v[72:75], a[100:103]
    v_mfma_f32_16x16x32_bf16 a[104:107], v[96:99], v[72:75], a[104:107]
    v_mfma_f32_16x16x32_bf16 a[108:111], v[100:103], v[72:75], a[108:111]
    s_barrier
    s_nop 15
    s_mul_i32 s60, s58, 29696
    s_mul_i32 s61, s59, 224
    s_add_u32 s60, s60, s61
    v_and_b32 v4, 15, v2
    v_mul_u32_u24 v4, 464, v4
    v_lshrrev_b32 v5, 4, v2
    v_lshl_add_u32 v4, v5, 3, v4
    v_add_u32 v4, s60, v4
    v_accvgpr_read_b32 v16, a0
    v_accvgpr_read_b32 v17, a1
    v_accvgpr_read_b32 v18, a2
    v_accvgpr_read_b32 v19, a3
    v_cvt_pk_bf16_f32 v20, v16, v17
    v_cvt_pk_bf16_f32 v21, v18, v19
    ds_write_b64 v4, v[20:21] offset:0
    v_accvgpr_read_b32 v22, a4
    v_accvgpr_read_b32 v23, a5
    v_accvgpr_read_b32 v24, a6
    v_accvgpr_read_b32 v25, a7
    v_cvt_pk_bf16_f32 v26, v22, v23
    v_cvt_pk_bf16_f32 v27, v24, v25
    ds_write_b64 v4, v[26:27] offset:32
    v_accvgpr_read_b32 v28, a8
    v_accvgpr_read_b32 v29, a9
    v_accvgpr_read_b32 v30, a10
    v_accvgpr_read_b32 v31, a11
    v_cvt_pk_bf16_f32 v32, v28, v29
    v_cvt_pk_bf16_f32 v33, v30, v31
    ds_write_b64 v4, v[32:33] offset:64
    v_accvgpr_read_b32 v34, a12
    v_accvgpr_read_b32 v35, a13
    v_accvgpr_read_b32 v36, a14
    v_accvgpr_read_b32 v37, a15
    v_cvt_pk_bf16_f32 v38, v34, v35
    v_cvt_pk_bf16_f32 v39, v36, v37
    ds_write_b64 v4, v[38:39] offset:96
    v_accvgpr_read_b32 v40, a16
    v_accvgpr_read_b32 v41, a17
    v_accvgpr_read_b32 v42, a18
    v_accvgpr_read_b32 v43, a19
    v_cvt_pk_bf16_f32 v44, v40, v41
    v_cvt_pk_bf16_f32 v45, v42, v43
    ds_write_b64 v4, v[44:45] offset:128
    v_accvgpr_read_b32 v46, a20
    v_accvgpr_read_b32 v47, a21
    v_accvgpr_read_b32 v48, a22
    v_accvgpr_read_b32 v49, a23
    v_cvt_pk_bf16_f32 v50, v46, v47
    v_cvt_pk_bf16_f32 v51, v48, v49
    ds_write_b64 v4, v[50:51] offset:160
    v_accvgpr_read_b32 v52, a24
    v_accvgpr_read_b32 v53, a25
    v_accvgpr_read_b32 v54, a26
    v_accvgpr_read_b32 v55, a27
    v_cvt_pk_bf16_f32 v56, v52, v53
    v_cvt_pk_bf16_f32 v57, v54, v55
    ds_write_b64 v4, v[56:57] offset:192
    v_accvgpr_read_b32 v58, a28
    v_accvgpr_read_b32 v59, a29
    v_accvgpr_read_b32 v60, a30
    v_accvgpr_read_b32 v61, a31
    v_cvt_pk_bf16_f32 v62, v58, v59
    v_cvt_pk_bf16_f32 v63, v60, v61
    ds_write_b64 v4, v[62:63] offset:7424
    v_accvgpr_read_b32 v16, a32
    v_accvgpr_read_b32 v17, a33
    v_accvgpr_read_b32 v18, a34
    v_accvgpr_read_b32 v19, a35
    v_cvt_pk_bf16_f32 v20, v16, v17
    v_cvt_pk_bf16_f32 v21, v18, v19
    ds_write_b64 v4, v[20:21] offset:7456
    v_accvgpr_read_b32 v22, a36
    v_accvgpr_read_b32 v23, a37
    v_accvgpr_read_b32 v24, a38
    v_accvgpr_read_b32 v25, a39
    v_cvt_pk_bf16_f32 v26, v22, v23
    v_cvt_pk_bf16_f32 v27, v24, v25
    ds_write_b64 v4, v[26:27] offset:7488
    v_accvgpr_read_b32 v28, a40
    v_accvgpr_read_b32 v29, a41
    v_accvgpr_read_b32 v30, a42
    v_accvgpr_read_b32 v31, a43
    v_cvt_pk_bf16_f32 v32, v28, v29
    v_cvt_pk_bf16_f32 v33, v30, v31
    ds_write_b64 v4, v[32:33] offset:7520
    v_accvgpr_read_b32 v34, a44
    v_accvgpr_read_b32 v35, a45
    v_accvgpr_read_b32 v36, a46
    v_accvgpr_read_b32 v37, a47
    v_cvt_pk_bf16_f32 v38, v34, v35
    v_cvt_pk_bf16_f32 v39, v36, v37
    ds_write_b64 v4, v[38:39] offset:7552
    v_accvgpr_read_b32 v40, a48
    v_accvgpr_read_b32 v41, a49
    v_accvgpr_read_b32 v42, a50
    v_accvgpr_read_b32 v43, a51
    v_cvt_pk_bf16_f32 v44, v40, v41
    v_cvt_pk_bf16_f32 v45, v42, v43
    ds_write_b64 v4, v[44:45] offset:7584
    v_accvgpr_read_b32 v46, a52
    v_accvgpr_read_b32 v47, a53
    v_accvgpr_read_b32 v48, a54
    v_accvgpr_read_b32 v49, a55
    v_cvt_pk_bf16_f32 v50, v46, v47
    v_cvt_pk_bf16_f32 v51, v48, v49
    ds_write_b64 v4, v[50:51] offset:7616
    v_accvgpr_read_b32 v52, a56
    v_accvgpr_read_b32 v53, a57
    v_accvgpr_read_b32 v54, a58
    v_accvgpr_read_b32 v55, a59
    v_cvt_pk_bf16_f32 v56, v52, v53
    v_cvt_pk_bf16_f32 v57, v54, v55
    ds_write_b64 v4, v[56:57] offset:14848
    v_accvgpr_read_b32 v58, a60
    v_accvgpr_read_b32 v59, a61
    v_accvgpr_read_b32 v60, a62
    v_accvgpr_read_b32 v61, a63
    v_cvt_pk_bf16_f32 v62, v58, v59
    v_cvt_pk_bf16_f32 v63, v60, v61
    ds_write_b64 v4, v[62:63] offset:14880
    v_accvgpr_read_b32 v16, a64
    v_accvgpr_read_b32 v17, a65
    v_accvgpr_read_b32 v18, a66
    v_accvgpr_read_b32 v19, a67
    v_cvt_pk_bf16_f32 v20, v16, v17
    v_cvt_pk_bf16_f32 v21, v18, v19
    ds_write_b64 v4, v[20:21] offset:14912
    v_accvgpr_read_b32 v22, a68
    v_accvgpr_read_b32 v23, a69
    v_accvgpr_read_b32 v24, a70
    v_accvgpr_read_b32 v25, a71
    v_cvt_pk_bf16_f32 v26, v22, v23
    v_cvt_pk_bf16_f32 v27, v24, v25
    ds_write_b64 v4, v[26:27] offset:14944
    v_accvgpr_read_b32 v28, a72
    v_accvgpr_read_b32 v29, a73
    v_accvgpr_read_b32 v30, a74
    v_accvgpr_read_b32 v31, a75
    v_cvt_pk_bf16_f32 v32, v28, v29
    v_cvt_pk_bf16_f32 v33, v30, v31
    ds_write_b64 v4, v[32:33] offset:14976
    v_accvgpr_read_b32 v34, a76
    v_accvgpr_read_b32 v35, a77
    v_accvgpr_read_b32 v36, a78
    v_accvgpr_read_b32 v37, a79
    v_cvt_pk_bf16_f32 v38, v34, v35
    v_cvt_pk_bf16_f32 v39, v36, v37
    ds_write_b64 v4, v[38:39] offset:15008
    v_accvgpr_read_b32 v40, a80
    v_accvgpr_read_b32 v41, a81
    v_accvgpr_read_b32 v42, a82
    v_accvgpr_read_b32 v43, a83
    v_cvt_pk_bf16_f32 v44, v40, v41
    v_cvt_pk_bf16_f32 v45, v42, v43
    ds_write_b64 v4, v[44:45] offset:15040
    v_accvgpr_read_b32 v46, a84
    v_accvgpr_read_b32 v47, a85
    v_accvgpr_read_b32 v48, a86
    v_accvgpr_read_b32 v49, a87
    v_cvt_pk_bf16_f32 v50, v46, v47
    v_cvt_pk_bf16_f32 v51, v48, v49
    ds_write_b64 v4, v[50:51] offset:22272
    v_accvgpr_read_b32 v52, a88
    v_accvgpr_read_b32 v53, a89
    v_accvgpr_read_b32 v54, a90
    v_accvgpr_read_b32 v55, a91
    v_cvt_pk_bf16_f32 v56, v52, v53
    v_cvt_pk_bf16_f32 v57, v54, v55
    ds_write_b64 v4, v[56:57] offset:22304
    v_accvgpr_read_b32 v58, a92
    v_accvgpr_read_b32 v59, a93
    v_accvgpr_read_b32 v60, a94
    v_accvgpr_read_b32 v61, a95
    v_cvt_pk_bf16_f32 v62, v58, v59
    v_cvt_pk_bf16_f32 v63, v60, v61
    ds_write_b64 v4, v[62:63] offset:22336
    v_accvgpr_read_b32 v16, a96
    v_accvgpr_read_b32 v17, a97
    v_accvgpr_read_b32 v18, a98
    v_accvgpr_read_b32 v19, a99
    v_cvt_pk_bf16_f32 v20, v16, v17
    v_cvt_pk_bf16_f32 v21, v18, v19
    ds_write_b64 v4, v[20:21] offset:22368
    v_accvgpr_read_b32 v22, a100
    v_accvgpr_read_b32 v23, a101
    v_accvgpr_read_b32 v24, a102
    v_accvgpr_read_b32 v25, a103
    v_cvt_pk_bf16_f32 v26, v22, v23
    v_cvt_pk_bf16_f32 v27, v24, v25
    ds_write_b64 v4, v[26:27] offset:22400
    v_accvgpr_read_b32 v28, a104
    v_accvgpr_read_b32 v29, a105
    v_accvgpr_read_b32 v30, a106
    v_accvgpr_read_b32 v31, a107
    v_cvt_pk_bf16_f32 v32, v28, v29
    v_cvt_pk_bf16_f32 v33, v30, v31
    ds_write_b64 v4, v[32:33] offset:22432
    v_accvgpr_read_b32 v34, a108
    v_accvgpr_read_b32 v35, a109
    v_accvgpr_read_b32 v36, a110
    v_accvgpr_read_b32 v37, a111
    v_cvt_pk_bf16_f32 v38, v34, v35
    v_cvt_pk_bf16_f32 v39, v36, v37
    ds_write_b64 v4, v[38:39] offset:22464
    s_branch k4_kernel_epi
k4_kernel_prod:
    s_add_u32 s16, s12, 0x1c00000
    s_addc_u32 s17, s13, 0
    s_mov_b32 s18, 0x400000
    s_mov_b32 s19, 0x00020000
    s_add_u32 s20, s12, 0x3000000
    s_addc_u32 s21, s13, 0
    s_mov_b32 s22, 0x700000
    s_mov_b32 s23, 0x00020000
    s_sub_u32 s46, s46, 4
    v_lshrrev_b32 v4, 3, v2
    v_and_b32 v5, 7, v2
    v_xor_b32 v5, v5, v4
    v_mul_u32_u24 v3, 2048, v4
    v_lshl_add_u32 v3, v5, 4, v3
    s_mul_i32 s47, s42, 128
    s_lshl_b32 s49, s46, 3
    s_add_u32 s47, s47, s49
    s_mul_i32 s47, s47, 2048
    s_mul_i32 s48, s43, 224
    s_add_u32 s48, s48, s49
    s_mul_i32 s48, s48, 2048
    s_lshl_b32 s50, s46, 10
    s_add_u32 s70, s50, 0
    s_add_u32 s71, s50, 45056
    s_add_u32 s72, s50, 90112
    s_add_u32 s51, s47, 0
    s_add_u32 m0, s70, 0
    s_nop 0
    buffer_load_dwordx4 v3, s[16:19], s51 offen lds
    s_add_u32 s51, s47, 65536
    s_add_u32 m0, s70, 4096
    s_nop 0
    buffer_load_dwordx4 v3, s[16:19], s51 offen lds
    s_add_u32 s51, s47, 131072
    s_add_u32 m0, s70, 8192
    s_nop 0
    buffer_load_dwordx4 v3, s[16:19], s51 offen lds
    s_add_u32 s51, s47, 196608
    s_add_u32 m0, s70, 12288
    s_nop 0
    buffer_load_dwordx4 v3, s[16:19], s51 offen lds
    s_add_u32 s51, s48, 0
    s_add_u32 m0, s70, 16384
    s_nop 0
    buffer_load_dwordx4 v3, s[20:23], s51 offen lds
    s_add_u32 s51, s48, 65536
    s_add_u32 m0, s70, 20480
    s_nop 0
    buffer_load_dwordx4 v3, s[20:23], s51 offen lds
    s_add_u32 s51, s48, 131072
    s_add_u32 m0, s70, 24576
    s_nop 0
    buffer_load_dwordx4 v3, s[20:23], s51 offen lds
    s_add_u32 s51, s48, 196608
    s_add_u32 m0, s70, 28672
    s_nop 0
    buffer_load_dwordx4 v3, s[20:23], s51 offen lds
    s_add_u32 s51, s48, 262144
    s_add_u32 m0, s70, 32768
    s_nop 0
    buffer_load_dwordx4 v3, s[20:23], s51 offen lds
    s_add_u32 s51, s48, 327680
    s_add_u32 m0, s70, 36864
    s_nop 0
    buffer_load_dwordx4 v3, s[20:23], s51 offen lds
    s_add_u32 s51, s48, 393216
    s_add_u32 m0, s70, 40960
    s_nop 0
    buffer_load_dwordx4 v3, s[20:23], s51 offen lds
    s_add_u32 s47, s47, 128
    s_add_u32 s48, s48, 128
    s_add_u32 s51, s47, 0
    s_add_u32 m0, s71, 0
    s_nop 0
    buffer_load_dwordx4 v3, s[16:19], s51 offen lds
    s_add_u32 s51, s47, 65536
    s_add_u32 m0, s71, 4096
    s_nop 0
    buffer_load_dwordx4 v3, s[16:19], s51 offen lds
    s_add_u32 s51, s47, 131072
    s_add_u32 m0, s71, 8192
    s_nop 0
    buffer_load_dwordx4 v3, s[16:19], s51 offen lds
    s_add_u32 s51, s47, 196608
    s_add_u32 m0, s71, 12288
    s_nop 0
    buffer_load_dwordx4 v3, s[16:19], s51 offen lds
    s_add_u32 s51, s48, 0
    s_add_u32 m0, s71, 16384
    s_nop 0
    buffer_load_dwordx4 v3, s[20:23], s51 offen lds
    s_add_u32 s51, s48, 65536
    s_add_u32 m0, s71, 20480
    s_nop 0
    buffer_load_dwordx4 v3, s[20:23], s51 offen lds
    s_add_u32 s51, s48, 131072
    s_add_u32 m0, s71, 24576
    s_nop 0
    buffer_load_dwordx4 v3, s[20:23], s51 offen lds
    s_add_u32 s51, s48, 196608
    s_add_u32 m0, s71, 28672
    s_nop 0
    buffer_load_dwordx4 v3, s[20:23], s51 offen lds
    s_add_u32 s51, s48, 262144
    s_add_u32 m0, s71, 32768
    s_nop 0
    buffer_load_dwordx4 v3, s[20:23], s51 offen lds
    s_add_u32 s51, s48, 327680
    s_add_u32 m0, s71, 36864
    s_nop 0
    buffer_load_dwordx4 v3, s[20:23], s51 offen lds
    s_add_u32 s51, s48, 393216
    s_add_u32 m0, s71, 40960
    s_nop 0
    buffer_load_dwordx4 v3, s[20:23], s51 offen lds
    s_add_u32 s47, s47, 128
    s_add_u32 s48, s48, 128
    s_add_u32 s51, s47, 0
    s_add_u32 m0, s72, 0
    s_nop 0
    buffer_load_dwordx4 v3, s[16:19], s51 offen lds
    s_add_u32 s51, s47, 65536
    s_add_u32 m0, s72, 4096
    s_nop 0
    buffer_load_dwordx4 v3, s[16:19], s51 offen lds
    s_add_u32 s51, s47, 131072
    s_add_u32 m0, s72, 8192
    s_nop 0
    buffer_load_dwordx4 v3, s[16:19], s51 offen lds
    s_add_u32 s51, s47, 196608
    s_add_u32 m0, s72, 12288
    s_nop 0
    buffer_load_dwordx4 v3, s[16:19], s51 offen lds
    s_add_u32 s51, s48, 0
    s_add_u32 m0, s72, 16384
    s_nop 0
    buffer_load_dwordx4 v3, s[20:23], s51 offen lds
    s_add_u32 s51, s48, 65536
    s_add_u32 m0, s72, 20480
    s_nop 0
    buffer_load_dwordx4 v3, s[20:23], s51 offen lds
    s_add_u32 s51, s48, 131072
    s_add_u32 m0, s72, 24576
    s_nop 0
    buffer_load_dwordx4 v3, s[20:23], s51 offen lds
    s_add_u32 s51, s48, 196608
    s_add_u32 m0, s72, 28672
    s_nop 0
    buffer_load_dwordx4 v3, s[20:23], s51 offen lds
    s_add_u32 s51, s48, 262144
    s_add_u32 m0, s72, 32768
    s_nop 0
    buffer_load_dwordx4 v3, s[20:23], s51 offen lds
    s_add_u32 s51, s48, 327680
    s_add_u32 m0, s72, 36864
    s_nop 0
    buffer_load_dwordx4 v3, s[20:23], s51 offen lds
    s_add_u32 s51, s48, 393216
    s_add_u32 m0, s72, 40960
    s_nop 0
    buffer_load_dwordx4 v3, s[20:23], s51 offen lds
    s_add_u32 s47, s47, 128
    s_add_u32 s48, s48, 128
    s_waitcnt vmcnt(22)
    s_barrier
    s_mov_b32 s63, 13
k4_kernel_ploop:
    s_waitcnt vmcnt(11)
    s_barrier
    s_add_u32 s51, s47, 0
    s_add_u32 m0, s70, 0
    s_nop 0
    buffer_load_dwordx4 v3, s[16:19], s51 offen lds
    s_add_u32 s51, s47, 65536
    s_add_u32 m0, s70, 4096
    s_nop 0
    buffer_load_dwordx4 v3, s[16:19], s51 offen lds
    s_add_u32 s51, s47, 131072
    s_add_u32 m0, s70, 8192
    s_nop 0
    buffer_load_dwordx4 v3, s[16:19], s51 offen lds
    s_add_u32 s51, s47, 196608
    s_add_u32 m0, s70, 12288
    s_nop 0
    buffer_load_dwordx4 v3, s[16:19], s51 offen lds
    s_add_u32 s51, s48, 0
    s_add_u32 m0, s70, 16384
    s_nop 0
    buffer_load_dwordx4 v3, s[20:23], s51 offen lds
    s_add_u32 s51, s48, 65536
    s_add_u32 m0, s70, 20480
    s_nop 0
    buffer_load_dwordx4 v3, s[20:23], s51 offen lds
    s_add_u32 s51, s48, 131072
    s_add_u32 m0, s70, 24576
    s_nop 0
    buffer_load_dwordx4 v3, s[20:23], s51 offen lds
    s_add_u32 s51, s48, 196608
    s_add_u32 m0, s70, 28672
    s_nop 0
    buffer_load_dwordx4 v3, s[20:23], s51 offen lds
    s_add_u32 s51, s48, 262144
    s_add_u32 m0, s70, 32768
    s_nop 0
    buffer_load_dwordx4 v3, s[20:23], s51 offen lds
    s_add_u32 s51, s48, 327680
    s_add_u32 m0, s70, 36864
    s_nop 0
    buffer_load_dwordx4 v3, s[20:23], s51 offen lds
    s_add_u32 s51, s48, 393216
    s_add_u32 m0, s70, 40960
    s_nop 0
    buffer_load_dwordx4 v3, s[20:23], s51 offen lds
    s_add_u32 s47, s47, 128
    s_add_u32 s48, s48, 128
    s_mov_b32 s62, s70
    s_mov_b32 s70, s71
    s_mov_b32 s71, s72
    s_mov_b32 s72, s62
    s_sub_u32 s63, s63, 1
    s_cmp_lg_u32 s63, 0
    s_cbranch_scc1 k4_kernel_ploop
    s_waitcnt vmcnt(11)
    s_barrier
    s_waitcnt vmcnt(0)
    s_barrier
    s_barrier
k4_kernel_epi:
    s_mov_b32 s24, s4
    s_mov_b32 s25, s5
    s_mov_b32 s26, 0x1c00
    s_mov_b32 s27, 0x00020000
    s_add_u32 s28, s12, 0x2000000
    s_addc_u32 s29, s13, 0
    s_mov_b32 s30, 0xe00000
    s_mov_b32 s31, 0x00020000
    s_mov_b32 s60, 0x924924a
    v_mul_hi_u32 v4, s60, v0
    v_mul_u32_u24 v5, 28, v4
    v_sub_u32 v5, v0, v5
    s_mul_i32 s61, s43, 448
    v_lshlrev_b32 v6, 4, v5
    buffer_load_dwordx4 v[8:11], v6, s[24:27], s61 offen
    v_mul_u32_u24 v7, 464, v4
    v_add_u32 v7, v7, v6
    v_mul_u32_u24 v12, 7168, v4
    v_add_u32 v12, v12, v6
    s_mul_i32 s62, s42, 917504
    s_add_u32 s62, s62, s61
    s_waitcnt lgkmcnt(0)
    s_barrier
    v_cmp_gt_u32 vcc, 448, v0
    s_and_saveexec_b64 s[64:65], vcc
    s_cbranch_execz k4_kernel_end
    ds_read_b128 v[16:19], v7 offset:0
    ds_read_b128 v[20:23], v7 offset:7424
    ds_read_b128 v[24:27], v7 offset:14848
    ds_read_b128 v[28:31], v7 offset:22272
    ds_read_b128 v[32:35], v7 offset:29696
    ds_read_b128 v[36:39], v7 offset:37120
    ds_read_b128 v[40:43], v7 offset:44544
    ds_read_b128 v[44:47], v7 offset:51968
    s_waitcnt vmcnt(0)
    s_mov_b32 s68, 0x3fb8aa3b
    s_mov_b32 s69, 0x3fb8aa3b
    s_mov_b32 s67, 0x41e6d4ca
    v_lshlrev_b32 v48, 16, v8
    v_and_b32 v49, 0xffff0000, v8
    v_lshlrev_b32 v50, 16, v9
    v_and_b32 v51, 0xffff0000, v9
    v_lshlrev_b32 v52, 16, v10
    v_and_b32 v53, 0xffff0000, v10
    v_lshlrev_b32 v54, 16, v11
    v_and_b32 v55, 0xffff0000, v11
    s_waitcnt lgkmcnt(7)
    v_lshlrev_b32 v56, 16, v16
    v_and_b32 v57, 0xffff0000, v16
    v_lshlrev_b32 v58, 16, v17
    v_and_b32 v59, 0xffff0000, v17
    v_lshlrev_b32 v60, 16, v18
    v_and_b32 v61, 0xffff0000, v18
    v_lshlrev_b32 v62, 16, v19
    v_and_b32 v63, 0xffff0000, v19
    v_pk_add_f32 v[56:57], v[56:57], v[48:49]
    v_pk_add_f32 v[58:59], v[58:59], v[50:51]
    v_pk_add_f32 v[60:61], v[60:61], v[52:53]
    v_pk_add_f32 v[62:63], v[62:63], v[54:55]
    v_cvt_pk_bf16_f32 v16, v56, v57
    v_cvt_pk_bf16_f32 v17, v58, v59
    v_cvt_pk_bf16_f32 v18, v60, v61
    v_cvt_pk_bf16_f32 v19, v62, v63
    v_lshlrev_b32 v56, 16, v16
    v_and_b32 v57, 0xffff0000, v16
    v_lshlrev_b32 v58, 16, v17
    v_and_b32 v59, 0xffff0000, v17
    v_lshlrev_b32 v60, 16, v18
    v_and_b32 v61, 0xffff0000, v18
    v_lshlrev_b32 v62, 16, v19
    v_and_b32 v63, 0xffff0000, v19
    v_pk_mul_f32 v[64:65], v[56:57], s[68:69]
    v_pk_mul_f32 v[66:67], v[58:59], s[68:69]
    v_pk_mul_f32 v[68:69], v[60:61], s[68:69]
    v_pk_mul_f32 v[70:71], v[62:63], s[68:69]
    v_min_f32 v64, s67, v64
    v_min_f32 v65, s67, v65
    v_min_f32 v66, s67, v66
    v_min_f32 v67, s67, v67
    v_min_f32 v68, s67, v68
    v_min_f32 v69, s67, v69
    v_min_f32 v70, s67, v70
    v_min_f32 v71, s67, v71
    v_exp_f32 v64, v64
    v_exp_f32 v65, v65
    v_exp_f32 v66, v66
    v_exp_f32 v67, v67
    v_exp_f32 v68, v68
    v_exp_f32 v69, v69
    v_exp_f32 v70, v70
    v_exp_f32 v71, v71
    v_pk_add_f32 v[72:73], v[64:65], 2.0 op_sel_hi:[1,0]
    v_pk_add_f32 v[74:75], v[66:67], 2.0 op_sel_hi:[1,0]
    v_pk_add_f32 v[76:77], v[68:69], 2.0 op_sel_hi:[1,0]
    v_pk_add_f32 v[78:79], v[70:71], 2.0 op_sel_hi:[1,0]
    v_pk_mul_f32 v[72:73], v[72:73], v[64:65]
    v_pk_mul_f32 v[74:75], v[74:75], v[66:67]
    v_pk_mul_f32 v[76:77], v[76:77], v[68:69]
    v_pk_mul_f32 v[78:79], v[78:79], v[70:71]
    v_pk_add_f32 v[64:65], v[72:73], 2.0 op_sel_hi:[1,0]
    v_pk_add_f32 v[66:67], v[74:75], 2.0 op_sel_hi:[1,0]
    v_pk_add_f32 v[68:69], v[76:77], 2.0 op_sel_hi:[1,0]
    v_pk_add_f32 v[70:71], v[78:79], 2.0 op_sel_hi:[1,0]
    v_rcp_f32 v64, v64
    v_rcp_f32 v65, v65
    v_rcp_f32 v66, v66
    v_rcp_f32 v67, v67
    v_rcp_f32 v68, v68
    v_rcp_f32 v69, v69
    v_rcp_f32 v70, v70
    v_rcp_f32 v71, v71
    v_pk_mul_f32 v[72:73], v[72:73], v[56:57]
    v_pk_mul_f32 v[74:75], v[74:75], v[58:59]
    v_pk_mul_f32 v[76:77], v[76:77], v[60:61]
    v_pk_mul_f32 v[78:79], v[78:79], v[62:63]
    v_pk_mul_f32 v[72:73], v[72:73], v[64:65]
    v_pk_mul_f32 v[74:75], v[74:75], v[66:67]
    v_pk_mul_f32 v[76:77], v[76:77], v[68:69]
    v_pk_mul_f32 v[78:79], v[78:79], v[70:71]
    v_cvt_pk_bf16_f32 v16, v72, v73
    v_cvt_pk_bf16_f32 v17, v74, v75
    v_cvt_pk_bf16_f32 v18, v76, v77
    v_cvt_pk_bf16_f32 v19, v78, v79
    s_add_u32 s61, s62, 0
    buffer_store_dwordx4 v[16:19], v12, s[28:31], s61 offen sc1
    s_waitcnt lgkmcnt(6)
    v_lshlrev_b32 v80, 16, v20
    v_and_b32 v81, 0xffff0000, v20
    v_lshlrev_b32 v82, 16, v21
    v_and_b32 v83, 0xffff0000, v21
    v_lshlrev_b32 v84, 16, v22
    v_and_b32 v85, 0xffff0000, v22
    v_lshlrev_b32 v86, 16, v23
    v_and_b32 v87, 0xffff0000, v23
    v_pk_add_f32 v[80:81], v[80:81], v[48:49]
    v_pk_add_f32 v[82:83], v[82:83], v[50:51]
    v_pk_add_f32 v[84:85], v[84:85], v[52:53]
    v_pk_add_f32 v[86:87], v[86:87], v[54:55]
    v_cvt_pk_bf16_f32 v20, v80, v81
    v_cvt_pk_bf16_f32 v21, v82, v83
    v_cvt_pk_bf16_f32 v22, v84, v85
    v_cvt_pk_bf16_f32 v23, v86, v87
    v_lshlrev_b32 v80, 16, v20
    v_and_b32 v81, 0xffff0000, v20
    v_lshlrev_b32 v82, 16, v21
    v_and_b32 v83, 0xffff0000, v21
    v_lshlrev_b32 v84, 16, v22
    v_and_b32 v85, 0xffff0000, v22
    v_lshlrev_b32 v86, 16, v23
    v_and_b32 v87, 0xffff0000, v23
    v_pk_mul_f32 v[88:89], v[80:81], s[68:69]
    v_pk_mul_f32 v[90:91], v[82:83], s[68:69]
    v_pk_mul_f32 v[92:93], v[84:85], s[68:69]
    v_pk_mul_f32 v[94:95], v[86:87], s[68:69]
    v_min_f32 v88, s67, v88
    v_min_f32 v89, s67, v89
    v_min_f32 v90, s67, v90
    v_min_f32 v91, s67, v91
    v_min_f32 v92, s67, v92
    v_min_f32 v93, s67, v93
    v_min_f32 v94, s67, v94
    v_min_f32 v95, s67, v95
    v_exp_f32 v88, v88
    v_exp_f32 v89, v89
    v_exp_f32 v90, v90
    v_exp_f32 v91, v91
    v_exp_f32 v92, v92
    v_exp_f32 v93, v93
    v_exp_f32 v94, v94
    v_exp_f32 v95, v95
    v_pk_add_f32 v[96:97], v[88:89], 2.0 op_sel_hi:[1,0]
    v_pk_add_f32 v[98:99], v[90:91], 2.0 op_sel_hi:[1,0]
    v_pk_add_f32 v[100:101], v[92:93], 2.0 op_sel_hi:[1,0]
    v_pk_add_f32 v[102:103], v[94:95], 2.0 op_sel_hi:[1,0]
    v_pk_mul_f32 v[96:97], v[96:97], v[88:89]
    v_pk_mul_f32 v[98:99], v[98:99], v[90:91]
    v_pk_mul_f32 v[100:101], v[100:101], v[92:93]
    v_pk_mul_f32 v[102:103], v[102:103], v[94:95]
    v_pk_add_f32 v[88:89], v[96:97], 2.0 op_sel_hi:[1,0]
    v_pk_add_f32 v[90:91], v[98:99], 2.0 op_sel_hi:[1,0]
    v_pk_add_f32 v[92:93], v[100:101], 2.0 op_sel_hi:[1,0]
    v_pk_add_f32 v[94:95], v[102:103], 2.0 op_sel_hi:[1,0]
    v_rcp_f32 v88, v88
    v_rcp_f32 v89, v89
    v_rcp_f32 v90, v90
    v_rcp_f32 v91, v91
    v_rcp_f32 v92, v92
    v_rcp_f32 v93, v93
    v_rcp_f32 v94, v94
    v_rcp_f32 v95, v95
    v_pk_mul_f32 v[96:97], v[96:97], v[80:81]
    v_pk_mul_f32 v[98:99], v[98:99], v[82:83]
    v_pk_mul_f32 v[100:101], v[100:101], v[84:85]
    v_pk_mul_f32 v[102:103], v[102:103], v[86:87]
    v_pk_mul_f32 v[96:97], v[96:97], v[88:89]
    v_pk_mul_f32 v[98:99], v[98:99], v[90:91]
    v_pk_mul_f32 v[100:101], v[100:101], v[92:93]
    v_pk_mul_f32 v[102:103], v[102:103], v[94:95]
    v_cvt_pk_bf16_f32 v20, v96, v97
    v_cvt_pk_bf16_f32 v21, v98, v99
    v_cvt_pk_bf16_f32 v22, v100, v101
    v_cvt_pk_bf16_f32 v23, v102, v103
    s_add_u32 s61, s62, 114688
    buffer_store_dwordx4 v[20:23], v12, s[28:31], s61 offen sc1
    s_waitcnt lgkmcnt(5)
    v_lshlrev_b32 v104, 16, v24
    v_and_b32 v105, 0xffff0000, v24
    v_lshlrev_b32 v106, 16, v25
    v_and_b32 v107, 0xffff0000, v25
    v_lshlrev_b32 v108, 16, v26
    v_and_b32 v109, 0xffff0000, v26
    v_lshlrev_b32 v110, 16, v27
    v_and_b32 v111, 0xffff0000, v27
    v_pk_add_f32 v[104:105], v[104:105], v[48:49]
    v_pk_add_f32 v[106:107], v[106:107], v[50:51]
    v_pk_add_f32 v[108:109], v[108:109], v[52:53]
    v_pk_add_f32 v[110:111], v[110:111], v[54:55]
    v_cvt_pk_bf16_f32 v24, v104, v105
    v_cvt_pk_bf16_f32 v25, v106, v107
    v_cvt_pk_bf16_f32 v26, v108, v109
    v_cvt_pk_bf16_f32 v27, v110, v111
    v_lshlrev_b32 v104, 16, v24
    v_and_b32 v105, 0xffff0000, v24
    v_lshlrev_b32 v106, 16, v25
    v_and_b32 v107, 0xffff0000, v25
    v_lshlrev_b32 v108, 16, v26
    v_and_b32 v109, 0xffff0000, v26
    v_lshlrev_b32 v110, 16, v27
    v_and_b32 v111, 0xffff0000, v27
    v_pk_mul_f32 v[112:113], v[104:105], s[68:69]
    v_pk_mul_f32 v[114:115], v[106:107], s[68:69]
    v_pk_mul_f32 v[116:117], v[108:109], s[68:69]
    v_pk_mul_f32 v[118:119], v[110:111], s[68:69]
    v_min_f32 v112, s67, v112
    v_min_f32 v113, s67, v113
    v_min_f32 v114, s67, v114
    v_min_f32 v115, s67, v115
    v_min_f32 v116, s67, v116
    v_min_f32 v117, s67, v117
    v_min_f32 v118, s67, v118
    v_min_f32 v119, s67, v119
    v_exp_f32 v112, v112
    v_exp_f32 v113, v113
    v_exp_f32 v114, v114
    v_exp_f32 v115, v115
    v_exp_f32 v116, v116
    v_exp_f32 v117, v117
    v_exp_f32 v118, v118
    v_exp_f32 v119, v119
    v_pk_add_f32 v[120:121], v[112:113], 2.0 op_sel_hi:[1,0]
    v_pk_add_f32 v[122:123], v[114:115], 2.0 op_sel_hi:[1,0]
    v_pk_add_f32 v[124:125], v[116:117], 2.0 op_sel_hi:[1,0]
    v_pk_add_f32 v[126:127], v[118:119], 2.0 op_sel_hi:[1,0]
    v_pk_mul_f32 v[120:121], v[120:121], v[112:113]
    v_pk_mul_f32 v[122:123], v[122:123], v[114:115]
    v_pk_mul_f32 v[124:125], v[124:125], v[116:117]
    v_pk_mul_f32 v[126:127], v[126:127], v[118:119]
    v_pk_add_f32 v[112:113], v[120:121], 2.0 op_sel_hi:[1,0]
    v_pk_add_f32 v[114:115], v[122:123], 2.0 op_sel_hi:[1,0]
    v_pk_add_f32 v[116:117], v[124:125], 2.0 op_sel_hi:[1,0]
    v_pk_add_f32 v[118:119], v[126:127], 2.0 op_sel_hi:[1,0]
    v_rcp_f32 v112, v112
    v_rcp_f32 v113, v113
    v_rcp_f32 v114, v114
    v_rcp_f32 v115, v115
    v_rcp_f32 v116, v116
    v_rcp_f32 v117, v117
    v_rcp_f32 v118, v118
    v_rcp_f32 v119, v119
    v_pk_mul_f32 v[120:121], v[120:121], v[104:105]
    v_pk_mul_f32 v[122:123], v[122:123], v[106:107]
    v_pk_mul_f32 v[124:125], v[124:125], v[108:109]
    v_pk_mul_f32 v[126:127], v[126:127], v[110:111]
    v_pk_mul_f32 v[120:121], v[120:121], v[112:113]
    v_pk_mul_f32 v[122:123], v[122:123], v[114:115]
    v_pk_mul_f32 v[124:125], v[124:125], v[116:117]
    v_pk_mul_f32 v[126:127], v[126:127], v[118:119]
    v_cvt_pk_bf16_f32 v24, v120, v121
    v_cvt_pk_bf16_f32 v25, v122, v123
    v_cvt_pk_bf16_f32 v26, v124, v125
    v_cvt_pk_bf16_f32 v27, v126, v127
    s_add_u32 s61, s62, 229376
    buffer_store_dwordx4 v[24:27], v12, s[28:31], s61 offen sc1
    s_waitcnt lgkmcnt(4)
    v_lshlrev_b32 v56, 16, v28
    v_and_b32 v57, 0xffff0000, v28
    v_lshlrev_b32 v58, 16, v29
    v_and_b32 v59, 0xffff0000, v29
    v_lshlrev_b32 v60, 16, v30
    v_and_b32 v61, 0xffff0000, v30
    v_lshlrev_b32 v62, 16, v31
    v_and_b32 v63, 0xffff0000, v31
    v_pk_add_f32 v[56:57], v[56:57], v[48:49]
    v_pk_add_f32 v[58:59], v[58:59], v[50:51]
    v_pk_add_f32 v[60:61], v[60:61], v[52:53]
    v_pk_add_f32 v[62:63], v[62:63], v[54:55]
    v_cvt_pk_bf16_f32 v28, v56, v57
    v_cvt_pk_bf16_f32 v29, v58, v59
    v_cvt_pk_bf16_f32 v30, v60, v61
    v_cvt_pk_bf16_f32 v31, v62, v63
    v_lshlrev_b32 v56, 16, v28
    v_and_b32 v57, 0xffff0000, v28
    v_lshlrev_b32 v58, 16, v29
    v_and_b32 v59, 0xffff0000, v29
    v_lshlrev_b32 v60, 16, v30
    v_and_b32 v61, 0xffff0000, v30
    v_lshlrev_b32 v62, 16, v31
    v_and_b32 v63, 0xffff0000, v31
    v_pk_mul_f32 v[64:65], v[56:57], s[68:69]
    v_pk_mul_f32 v[66:67], v[58:59], s[68:69]
    v_pk_mul_f32 v[68:69], v[60:61], s[68:69]
    v_pk_mul_f32 v[70:71], v[62:63], s[68:69]
    v_min_f32 v64, s67, v64
    v_min_f32 v65, s67, v65
    v_min_f32 v66, s67, v66
    v_min_f32 v67, s67, v67
    v_min_f32 v68, s67, v68
    v_min_f32 v69, s67, v69
    v_min_f32 v70, s67, v70
    v_min_f32 v71, s67, v71
    v_exp_f32 v64, v64
    v_exp_f32 v65, v65
    v_exp_f32 v66, v66
    v_exp_f32 v67, v67
    v_exp_f32 v68, v68
    v_exp_f32 v69, v69
    v_exp_f32 v70, v70
    v_exp_f32 v71, v71
    v_pk_add_f32 v[72:73], v[64:65], 2.0 op_sel_hi:[1,0]
    v_pk_add_f32 v[74:75], v[66:67], 2.0 op_sel_hi:[1,0]
    v_pk_add_f32 v[76:77], v[68:69], 2.0 op_sel_hi:[1,0]
    v_pk_add_f32 v[78:79], v[70:71], 2.0 op_sel_hi:[1,0]
    v_pk_mul_f32 v[72:73], v[72:73], v[64:65]
    v_pk_mul_f32 v[74:75], v[74:75], v[66:67]
    v_pk_mul_f32 v[76:77], v[76:77], v[68:69]
    v_pk_mul_f32 v[78:79], v[78:79], v[70:71]
    v_pk_add_f32 v[64:65], v[72:73], 2.0 op_sel_hi:[1,0]
    v_pk_add_f32 v[66:67], v[74:75], 2.0 op_sel_hi:[1,0]
    v_pk_add_f32 v[68:69], v[76:77], 2.0 op_sel_hi:[1,0]
    v_pk_add_f32 v[70:71], v[78:79], 2.0 op_sel_hi:[1,0]
    v_rcp_f32 v64, v64
    v_rcp_f32 v65, v65
    v_rcp_f32 v66, v66
    v_rcp_f32 v67, v67
    v_rcp_f32 v68, v68
    v_rcp_f32 v69, v69
    v_rcp_f32 v70, v70
    v_rcp_f32 v71, v71
    v_pk_mul_f32 v[72:73], v[72:73], v[56:57]
    v_pk_mul_f32 v[74:75], v[74:75], v[58:59]
    v_pk_mul_f32 v[76:77], v[76:77], v[60:61]
    v_pk_mul_f32 v[78:79], v[78:79], v[62:63]
    v_pk_mul_f32 v[72:73], v[72:73], v[64:65]
    v_pk_mul_f32 v[74:75], v[74:75], v[66:67]
    v_pk_mul_f32 v[76:77], v[76:77], v[68:69]
    v_pk_mul_f32 v[78:79], v[78:79], v[70:71]
    v_cvt_pk_bf16_f32 v28, v72, v73
    v_cvt_pk_bf16_f32 v29, v74, v75
    v_cvt_pk_bf16_f32 v30, v76, v77
    v_cvt_pk_bf16_f32 v31, v78, v79
    s_add_u32 s61, s62, 344064
    buffer_store_dwordx4 v[28:31], v12, s[28:31], s61 offen sc1
    s_waitcnt lgkmcnt(3)
    v_lshlrev_b32 v80, 16, v32
    v_and_b32 v81, 0xffff0000, v32
    v_lshlrev_b32 v82, 16, v33
    v_and_b32 v83, 0xffff0000, v33
    v_lshlrev_b32 v84, 16, v34
    v_and_b32 v85, 0xffff0000, v34
    v_lshlrev_b32 v86, 16, v35
    v_and_b32 v87, 0xffff0000, v35
    v_pk_add_f32 v[80:81], v[80:81], v[48:49]
    v_pk_add_f32 v[82:83], v[82:83], v[50:51]
    v_pk_add_f32 v[84:85], v[84:85], v[52:53]
    v_pk_add_f32 v[86:87], v[86:87], v[54:55]
    v_cvt_pk_bf16_f32 v32, v80, v81
    v_cvt_pk_bf16_f32 v33, v82, v83
    v_cvt_pk_bf16_f32 v34, v84, v85
    v_cvt_pk_bf16_f32 v35, v86, v87
    v_lshlrev_b32 v80, 16, v32
    v_and_b32 v81, 0xffff0000, v32
    v_lshlrev_b32 v82, 16, v33
    v_and_b32 v83, 0xffff0000, v33
    v_lshlrev_b32 v84, 16, v34
    v_and_b32 v85, 0xffff0000, v34
    v_lshlrev_b32 v86, 16, v35
    v_and_b32 v87, 0xffff0000, v35
    v_pk_mul_f32 v[88:89], v[80:81], s[68:69]
    v_pk_mul_f32 v[90:91], v[82:83], s[68:69]
    v_pk_mul_f32 v[92:93], v[84:85], s[68:69]
    v_pk_mul_f32 v[94:95], v[86:87], s[68:69]
    v_min_f32 v88, s67, v88
    v_min_f32 v89, s67, v89
    v_min_f32 v90, s67, v90
    v_min_f32 v91, s67, v91
    v_min_f32 v92, s67, v92
    v_min_f32 v93, s67, v93
    v_min_f32 v94, s67, v94
    v_min_f32 v95, s67, v95
    v_exp_f32 v88, v88
    v_exp_f32 v89, v89
    v_exp_f32 v90, v90
    v_exp_f32 v91, v91
    v_exp_f32 v92, v92
    v_exp_f32 v93, v93
    v_exp_f32 v94, v94
    v_exp_f32 v95, v95
    v_pk_add_f32 v[96:97], v[88:89], 2.0 op_sel_hi:[1,0]
    v_pk_add_f32 v[98:99], v[90:91], 2.0 op_sel_hi:[1,0]
    v_pk_add_f32 v[100:101], v[92:93], 2.0 op_sel_hi:[1,0]
    v_pk_add_f32 v[102:103], v[94:95], 2.0 op_sel_hi:[1,0]
    v_pk_mul_f32 v[96:97], v[96:97], v[88:89]
    v_pk_mul_f32 v[98:99], v[98:99], v[90:91]
    v_pk_mul_f32 v[100:101], v[100:101], v[92:93]
    v_pk_mul_f32 v[102:103], v[102:103], v[94:95]
    v_pk_add_f32 v[88:89], v[96:97], 2.0 op_sel_hi:[1,0]
    v_pk_add_f32 v[90:91], v[98:99], 2.0 op_sel_hi:[1,0]
    v_pk_add_f32 v[92:93], v[100:101], 2.0 op_sel_hi:[1,0]
    v_pk_add_f32 v[94:95], v[102:103], 2.0 op_sel_hi:[1,0]
    v_rcp_f32 v88, v88
    v_rcp_f32 v89, v89
    v_rcp_f32 v90, v90
    v_rcp_f32 v91, v91
    v_rcp_f32 v92, v92
    v_rcp_f32 v93, v93
    v_rcp_f32 v94, v94
    v_rcp_f32 v95, v95
    v_pk_mul_f32 v[96:97], v[96:97], v[80:81]
    v_pk_mul_f32 v[98:99], v[98:99], v[82:83]
    v_pk_mul_f32 v[100:101], v[100:101], v[84:85]
    v_pk_mul_f32 v[102:103], v[102:103], v[86:87]
    v_pk_mul_f32 v[96:97], v[96:97], v[88:89]
    v_pk_mul_f32 v[98:99], v[98:99], v[90:91]
    v_pk_mul_f32 v[100:101], v[100:101], v[92:93]
    v_pk_mul_f32 v[102:103], v[102:103], v[94:95]
    v_cvt_pk_bf16_f32 v32, v96, v97
    v_cvt_pk_bf16_f32 v33, v98, v99
    v_cvt_pk_bf16_f32 v34, v100, v101
    v_cvt_pk_bf16_f32 v35, v102, v103
    s_add_u32 s61, s62, 458752
    buffer_store_dwordx4 v[32:35], v12, s[28:31], s61 offen sc1
    s_waitcnt lgkmcnt(2)
    v_lshlrev_b32 v104, 16, v36
    v_and_b32 v105, 0xffff0000, v36
    v_lshlrev_b32 v106, 16, v37
    v_and_b32 v107, 0xffff0000, v37
    v_lshlrev_b32 v108, 16, v38
    v_and_b32 v109, 0xffff0000, v38
    v_lshlrev_b32 v110, 16, v39
    v_and_b32 v111, 0xffff0000, v39
    v_pk_add_f32 v[104:105], v[104:105], v[48:49]
    v_pk_add_f32 v[106:107], v[106:107], v[50:51]
    v_pk_add_f32 v[108:109], v[108:109], v[52:53]
    v_pk_add_f32 v[110:111], v[110:111], v[54:55]
    v_cvt_pk_bf16_f32 v36, v104, v105
    v_cvt_pk_bf16_f32 v37, v106, v107
    v_cvt_pk_bf16_f32 v38, v108, v109
    v_cvt_pk_bf16_f32 v39, v110, v111
    v_lshlrev_b32 v104, 16, v36
    v_and_b32 v105, 0xffff0000, v36
    v_lshlrev_b32 v106, 16, v37
    v_and_b32 v107, 0xffff0000, v37
    v_lshlrev_b32 v108, 16, v38
    v_and_b32 v109, 0xffff0000, v38
    v_lshlrev_b32 v110, 16, v39
    v_and_b32 v111, 0xffff0000, v39
    v_pk_mul_f32 v[112:113], v[104:105], s[68:69]
    v_pk_mul_f32 v[114:115], v[106:107], s[68:69]
    v_pk_mul_f32 v[116:117], v[108:109], s[68:69]
    v_pk_mul_f32 v[118:119], v[110:111], s[68:69]
    v_min_f32 v112, s67, v112
    v_min_f32 v113, s67, v113
    v_min_f32 v114, s67, v114
    v_min_f32 v115, s67, v115
    v_min_f32 v116, s67, v116
    v_min_f32 v117, s67, v117
    v_min_f32 v118, s67, v118
    v_min_f32 v119, s67, v119
    v_exp_f32 v112, v112
    v_exp_f32 v113, v113
    v_exp_f32 v114, v114
    v_exp_f32 v115, v115
    v_exp_f32 v116, v116
    v_exp_f32 v117, v117
    v_exp_f32 v118, v118
    v_exp_f32 v119, v119
    v_pk_add_f32 v[120:121], v[112:113], 2.0 op_sel_hi:[1,0]
    v_pk_add_f32 v[122:123], v[114:115], 2.0 op_sel_hi:[1,0]
    v_pk_add_f32 v[124:125], v[116:117], 2.0 op_sel_hi:[1,0]
    v_pk_add_f32 v[126:127], v[118:119], 2.0 op_sel_hi:[1,0]
    v_pk_mul_f32 v[120:121], v[120:121], v[112:113]
    v_pk_mul_f32 v[122:123], v[122:123], v[114:115]
    v_pk_mul_f32 v[124:125], v[124:125], v[116:117]
    v_pk_mul_f32 v[126:127], v[126:127], v[118:119]
    v_pk_add_f32 v[112:113], v[120:121], 2.0 op_sel_hi:[1,0]
    v_pk_add_f32 v[114:115], v[122:123], 2.0 op_sel_hi:[1,0]
    v_pk_add_f32 v[116:117], v[124:125], 2.0 op_sel_hi:[1,0]
    v_pk_add_f32 v[118:119], v[126:127], 2.0 op_sel_hi:[1,0]
    v_rcp_f32 v112, v112
    v_rcp_f32 v113, v113
    v_rcp_f32 v114, v114
    v_rcp_f32 v115, v115
    v_rcp_f32 v116, v116
    v_rcp_f32 v117, v117
    v_rcp_f32 v118, v118
    v_rcp_f32 v119, v119
    v_pk_mul_f32 v[120:121], v[120:121], v[104:105]
    v_pk_mul_f32 v[122:123], v[122:123], v[106:107]
    v_pk_mul_f32 v[124:125], v[124:125], v[108:109]
    v_pk_mul_f32 v[126:127], v[126:127], v[110:111]
    v_pk_mul_f32 v[120:121], v[120:121], v[112:113]
    v_pk_mul_f32 v[122:123], v[122:123], v[114:115]
    v_pk_mul_f32 v[124:125], v[124:125], v[116:117]
    v_pk_mul_f32 v[126:127], v[126:127], v[118:119]
    v_cvt_pk_bf16_f32 v36, v120, v121
    v_cvt_pk_bf16_f32 v37, v122, v123
    v_cvt_pk_bf16_f32 v38, v124, v125
    v_cvt_pk_bf16_f32 v39, v126, v127
    s_add_u32 s61, s62, 573440
    buffer_store_dwordx4 v[36:39], v12, s[28:31], s61 offen sc1
    s_waitcnt lgkmcnt(1)
    v_lshlrev_b32 v56, 16, v40
    v_and_b32 v57, 0xffff0000, v40
    v_lshlrev_b32 v58, 16, v41
    v_and_b32 v59, 0xffff0000, v41
    v_lshlrev_b32 v60, 16, v42
    v_and_b32 v61, 0xffff0000, v42
    v_lshlrev_b32 v62, 16, v43
    v_and_b32 v63, 0xffff0000, v43
    v_pk_add_f32 v[56:57], v[56:57], v[48:49]
    v_pk_add_f32 v[58:59], v[58:59], v[50:51]
    v_pk_add_f32 v[60:61], v[60:61], v[52:53]
    v_pk_add_f32 v[62:63], v[62:63], v[54:55]
    v_cvt_pk_bf16_f32 v40, v56, v57
    v_cvt_pk_bf16_f32 v41, v58, v59
    v_cvt_pk_bf16_f32 v42, v60, v61
    v_cvt_pk_bf16_f32 v43, v62, v63
    v_lshlrev_b32 v56, 16, v40
    v_and_b32 v57, 0xffff0000, v40
    v_lshlrev_b32 v58, 16, v41
    v_and_b32 v59, 0xffff0000, v41
    v_lshlrev_b32 v60, 16, v42
    v_and_b32 v61, 0xffff0000, v42
    v_lshlrev_b32 v62, 16, v43
    v_and_b32 v63, 0xffff0000, v43
    v_pk_mul_f32 v[64:65], v[56:57], s[68:69]
    v_pk_mul_f32 v[66:67], v[58:59], s[68:69]
    v_pk_mul_f32 v[68:69], v[60:61], s[68:69]
    v_pk_mul_f32 v[70:71], v[62:63], s[68:69]
    v_min_f32 v64, s67, v64
    v_min_f32 v65, s67, v65
    v_min_f32 v66, s67, v66
    v_min_f32 v67, s67, v67
    v_min_f32 v68, s67, v68
    v_min_f32 v69, s67, v69
    v_min_f32 v70, s67, v70
    v_min_f32 v71, s67, v71
    v_exp_f32 v64, v64
    v_exp_f32 v65, v65
    v_exp_f32 v66, v66
    v_exp_f32 v67, v67
    v_exp_f32 v68, v68
    v_exp_f32 v69, v69
    v_exp_f32 v70, v70
    v_exp_f32 v71, v71
    v_pk_add_f32 v[72:73], v[64:65], 2.0 op_sel_hi:[1,0]
    v_pk_add_f32 v[74:75], v[66:67], 2.0 op_sel_hi:[1,0]
    v_pk_add_f32 v[76:77], v[68:69], 2.0 op_sel_hi:[1,0]
    v_pk_add_f32 v[78:79], v[70:71], 2.0 op_sel_hi:[1,0]
    v_pk_mul_f32 v[72:73], v[72:73], v[64:65]
    v_pk_mul_f32 v[74:75], v[74:75], v[66:67]
    v_pk_mul_f32 v[76:77], v[76:77], v[68:69]
    v_pk_mul_f32 v[78:79], v[78:79], v[70:71]
    v_pk_add_f32 v[64:65], v[72:73], 2.0 op_sel_hi:[1,0]
    v_pk_add_f32 v[66:67], v[74:75], 2.0 op_sel_hi:[1,0]
    v_pk_add_f32 v[68:69], v[76:77], 2.0 op_sel_hi:[1,0]
    v_pk_add_f32 v[70:71], v[78:79], 2.0 op_sel_hi:[1,0]
    v_rcp_f32 v64, v64
    v_rcp_f32 v65, v65
    v_rcp_f32 v66, v66
    v_rcp_f32 v67, v67
    v_rcp_f32 v68, v68
    v_rcp_f32 v69, v69
    v_rcp_f32 v70, v70
    v_rcp_f32 v71, v71
    v_pk_mul_f32 v[72:73], v[72:73], v[56:57]
    v_pk_mul_f32 v[74:75], v[74:75], v[58:59]
    v_pk_mul_f32 v[76:77], v[76:77], v[60:61]
    v_pk_mul_f32 v[78:79], v[78:79], v[62:63]
    v_pk_mul_f32 v[72:73], v[72:73], v[64:65]
    v_pk_mul_f32 v[74:75], v[74:75], v[66:67]
    v_pk_mul_f32 v[76:77], v[76:77], v[68:69]
    v_pk_mul_f32 v[78:79], v[78:79], v[70:71]
    v_cvt_pk_bf16_f32 v40, v72, v73
    v_cvt_pk_bf16_f32 v41, v74, v75
    v_cvt_pk_bf16_f32 v42, v76, v77
    v_cvt_pk_bf16_f32 v43, v78, v79
    s_add_u32 s61, s62, 688128
    buffer_store_dwordx4 v[40:43], v12, s[28:31], s61 offen sc1
    s_waitcnt lgkmcnt(0)
    v_lshlrev_b32 v80, 16, v44
    v_and_b32 v81, 0xffff0000, v44
    v_lshlrev_b32 v82, 16, v45
    v_and_b32 v83, 0xffff0000, v45
    v_lshlrev_b32 v84, 16, v46
    v_and_b32 v85, 0xffff0000, v46
    v_lshlrev_b32 v86, 16, v47
    v_and_b32 v87, 0xffff0000, v47
    v_pk_add_f32 v[80:81], v[80:81], v[48:49]
    v_pk_add_f32 v[82:83], v[82:83], v[50:51]
    v_pk_add_f32 v[84:85], v[84:85], v[52:53]
    v_pk_add_f32 v[86:87], v[86:87], v[54:55]
    v_cvt_pk_bf16_f32 v44, v80, v81
    v_cvt_pk_bf16_f32 v45, v82, v83
    v_cvt_pk_bf16_f32 v46, v84, v85
    v_cvt_pk_bf16_f32 v47, v86, v87
    v_lshlrev_b32 v80, 16, v44
    v_and_b32 v81, 0xffff0000, v44
    v_lshlrev_b32 v82, 16, v45
    v_and_b32 v83, 0xffff0000, v45
    v_lshlrev_b32 v84, 16, v46
    v_and_b32 v85, 0xffff0000, v46
    v_lshlrev_b32 v86, 16, v47
    v_and_b32 v87, 0xffff0000, v47
    v_pk_mul_f32 v[88:89], v[80:81], s[68:69]
    v_pk_mul_f32 v[90:91], v[82:83], s[68:69]
    v_pk_mul_f32 v[92:93], v[84:85], s[68:69]
    v_pk_mul_f32 v[94:95], v[86:87], s[68:69]
    v_min_f32 v88, s67, v88
    v_min_f32 v89, s67, v89
    v_min_f32 v90, s67, v90
    v_min_f32 v91, s67, v91
    v_min_f32 v92, s67, v92
    v_min_f32 v93, s67, v93
    v_min_f32 v94, s67, v94
    v_min_f32 v95, s67, v95
    v_exp_f32 v88, v88
    v_exp_f32 v89, v89
    v_exp_f32 v90, v90
    v_exp_f32 v91, v91
    v_exp_f32 v92, v92
    v_exp_f32 v93, v93
    v_exp_f32 v94, v94
    v_exp_f32 v95, v95
    v_pk_add_f32 v[96:97], v[88:89], 2.0 op_sel_hi:[1,0]
    v_pk_add_f32 v[98:99], v[90:91], 2.0 op_sel_hi:[1,0]
    v_pk_add_f32 v[100:101], v[92:93], 2.0 op_sel_hi:[1,0]
    v_pk_add_f32 v[102:103], v[94:95], 2.0 op_sel_hi:[1,0]
    v_pk_mul_f32 v[96:97], v[96:97], v[88:89]
    v_pk_mul_f32 v[98:99], v[98:99], v[90:91]
    v_pk_mul_f32 v[100:101], v[100:101], v[92:93]
    v_pk_mul_f32 v[102:103], v[102:103], v[94:95]
    v_pk_add_f32 v[88:89], v[96:97], 2.0 op_sel_hi:[1,0]
    v_pk_add_f32 v[90:91], v[98:99], 2.0 op_sel_hi:[1,0]
    v_pk_add_f32 v[92:93], v[100:101], 2.0 op_sel_hi:[1,0]
    v_pk_add_f32 v[94:95], v[102:103], 2.0 op_sel_hi:[1,0]
    v_rcp_f32 v88, v88
    v_rcp_f32 v89, v89
    v_rcp_f32 v90, v90
    v_rcp_f32 v91, v91
    v_rcp_f32 v92, v92
    v_rcp_f32 v93, v93
    v_rcp_f32 v94, v94
    v_rcp_f32 v95, v95
    v_pk_mul_f32 v[96:97], v[96:97], v[80:81]
    v_pk_mul_f32 v[98:99], v[98:99], v[82:83]
    v_pk_mul_f32 v[100:101], v[100:101], v[84:85]
    v_pk_mul_f32 v[102:103], v[102:103], v[86:87]
    v_pk_mul_f32 v[96:97], v[96:97], v[88:89]
    v_pk_mul_f32 v[98:99], v[98:99], v[90:91]
    v_pk_mul_f32 v[100:101], v[100:101], v[92:93]
    v_pk_mul_f32 v[102:103], v[102:103], v[94:95]
    v_cvt_pk_bf16_f32 v44, v96, v97
    v_cvt_pk_bf16_f32 v45, v98, v99
    v_cvt_pk_bf16_f32 v46, v100, v101
    v_cvt_pk_bf16_f32 v47, v102, v103
    s_add_u32 s61, s62, 802816
    buffer_store_dwordx4 v[44:47], v12, s[28:31], s61 offen sc1
k4_kernel_end:
    s_endpgm
.p2align 8
.globl k5_kernel
.type k5_kernel,@function
k5_kernel:
    s_cmp_ge_u32 s2, 256
    s_cbranch_scc1 k5_kernel_end
    s_load_dwordx2 s[4:5], s[0:1], 40
    s_load_dwordx2 s[6:7], s[0:1], 56
    s_load_dwordx2 s[12:13], s[0:1], 72
    s_and_b32 s40, s2, 7
    s_lshr_b32 s41, s2, 3
    s_lshr_b32 s42, s40, 1
    s_and_b32 s43, s40, 1
    s_lshr_b32 s44, s41, 3
    s_and_b32 s45, s41, 7
    s_lshl_b32 s42, s42, 2
    s_add_u32 s42, s42, s44
    s_lshl_b32 s43, s43, 3
    s_add_u32 s43, s43, s45
    v_lshrrev_b32 v1, 6, v0
    v_and_b32 v2, 63, v0
    s_nop 0
    v_readfirstlane_b32 s46, v1
    s_waitcnt lgkmcnt(0)
    s_cmp_ge_u32 s46, 4
    s_cbranch_scc1 k5_kernel_prod
    v_lshrrev_b32 v4, 4, v2
    v_and_b32 v5, 7, v2
    v_xor_b32 v4, v4, v5
    v_and_b32 v5, 15, v2
    v_lshlrev_b32 v5, 7, v5
    v_lshl_add_u32 v4, v4, 4, v5
    s_lshr_b32 s58, s46, 1
    s_and_b32 s59, s46, 1
    s_mul_i32 s60, s58, 8192
    s_mul_i32 s61, s59, 4096
    s_add_u32 s61, s61, 16384
    v_add_u32 v6, s60, v4
    v_xor_b32 v7, 64, v6
    v_add_u32 v8, s61, v4
    v_xor_b32 v9, 64, v8
    s_mov_b32 s80, 0
    s_mov_b32 s81, 24576
    s_mov_b32 s82, 49152
    s_mov_b32 s83, 73728
    v_accvgpr_write_b32 a0, 0
    v_accvgpr_write_b32 a1, 0
    v_accvgpr_write_b32 a2, 0
    v_accvgpr_write_b32 a3, 0
    v_accvgpr_write_b32 a4, 0
    v_accvgpr_write_b32 a5, 0
    v_accvgpr_write_b32 a6, 0
    v_accvgpr_write_b32 a7, 0
    v_accvgpr_write_b32 a8, 0
    v_accvgpr_write_b32 a9, 0
    v_accvgpr_write_b32 a10, 0
    v_accvgpr_write_b32 a11, 0
    v_accvgpr_write_b32 a12, 0
    v_accvgpr_write_b32 a13, 0
    v_accvgpr_write_b32 a14, 0
    v_accvgpr_write_b32 a15, 0
    v_accvgpr_write_b32 a16, 0
    v_accvgpr_write_b32 a17, 0
    v_accvgpr_write_b32 a18, 0
    v_accvgpr_write_b32 a19, 0
    v_accvgpr_write_b32 a20, 0
    v_accvgpr_write_b32 a21, 0
    v_accvgpr_write_b32 a22, 0
    v_accvgpr_write_b32 a23, 0
    v_accvgpr_write_b32 a24, 0
    v_accvgpr_write_b32 a25, 0
    v_accvgpr_write_b32 a26, 0
    v_accvgpr_write_b32 a27, 0
    v_accvgpr_write_b32 a28, 0
    v_accvgpr_write_b32 a29, 0
    v_accvgpr_write_b32 a30, 0
    v_accvgpr_write_b32 a31, 0
    s_barrier
    v_add_u32 v10, s80, v6
    v_add_u32 v12, s80, v8
    ds_read_b128 v[16:19], v10 offset:0
    ds_read_b128 v[32:35], v12 offset:0
    ds_read_b128 v[36:39], v12 offset:2048
    ds_read_b128 v[20:23], v10 offset:2048
    ds_read_b128 v[24:27], v10 offset:4096
    ds_read_b128 v[28:31], v10 offset:6144
    v_add_u32 v11, s80, v7
    v_add_u32 v13, s80, v9
    s_mov_b32 s63, 55
k5_kernel_cloop:
    s_waitcnt lgkmcnt(0)
    v_mfma_f32_16x16x32_bf16 a[0:3], v[32:35], v[16:19], a[0:3]
    ds_read_b128 v[40:43], v11 offset:0
    v_mfma_f32_16x16x32_bf16 a[4:7], v[36:39], v[16:19], a[4:7]
    ds_read_b128 v[56:59], v13 offset:0
    v_mfma_f32_16x16x32_bf16 a[8:11], v[32:35], v[20:23], a[8:11]
    ds_read_b128 v[60:63], v13 offset:2048
    v_mfma_f32_16x16x32_bf16 a[12:15], v[36:39], v[20:23], a[12:15]
    ds_read_b128 v[44:47], v11 offset:2048
    v_mfma_f32_16x16x32_bf16 a[16:19], v[32:35], v[24:27], a[16:19]
    ds_read_b128 v[48:51], v11 offset:4096
    v_mfma_f32_16x16x32_bf16 a[20:23], v[36:39], v[24:27], a[20:23]
    ds_read_b128 v[52:55], v11 offset:6144
    v_mfma_f32_16x16x32_bf16 a[24:27], v[32:35], v[28:31], a[24:27]
    v_mfma_f32_16x16x32_bf16 a[28:31], v[36:39], v[28:31], a[28:31]
    s_mov_b32 s62, s80
    s_mov_b32 s80, s81
    s_mov_b32 s81, s82
    s_mov_b32 s82, s83
    s_mov_b32 s83, s62
    v_add_u32 v10, s80, v6
    v_add_u32 v12, s80, v8
    s_waitcnt lgkmcnt(0)
    s_barrier
    v_mfma_f32_16x16x32_bf16 a[0:3], v[56:59], v[40:43], a[0:3]
    ds_read_b128 v[16:19], v10 offset:0
    v_mfma_f32_16x16x32_bf16 a[4:7], v[60:63], v[40:43], a[4:7]
    ds_read_b128 v[32:35], v12 offset:0
    v_mfma_f32_16x16x32_bf16 a[8:11], v[56:59], v[44:47], a[8:11]
    ds_read_b128 v[36:39], v12 offset:2048
    v_mfma_f32_16x16x32_bf16 a[12:15], v[60:63], v[44:47], a[12:15]
    ds_read_b128 v[20:23], v10 offset:2048
    v_mfma_f32_16x16x32_bf16 a[16:19], v[56:59], v[48:51], a[16:19]
    ds_read_b128 v[24:27], v10 offset:4096
    v_mfma_f32_16x16x32_bf16 a[20:23], v[60:63], v[48:51], a[20:23]
    ds_read_b128 v[28:31], v10 offset:6144
    v_mfma_f32_16x16x32_bf16 a[24:27], v[56:59], v[52:55], a[24:27]
    v_mfma_f32_16x16x32_bf16 a[28:31], v[60:63], v[52:55], a[28:31]
    v_add_u32 v11, s80, v7
    v_add_u32 v13, s80, v9
    s_sub_u32 s63, s63, 1
    s_cmp_lg_u32 s63, 0
    s_cbranch_scc1 k5_kernel_cloop
    s_waitcnt lgkmcnt(0)
    v_mfma_f32_16x16x32_bf16 a[0:3], v[32:35], v[16:19], a[0:3]
    ds_read_b128 v[40:43], v11 offset:0
    v_mfma_f32_16x16x32_bf16 a[4:7], v[36:39], v[16:19], a[4:7]
    ds_read_b128 v[56:59], v13 offset:0
    v_mfma_f32_16x16x32_bf16 a[8:11], v[32:35], v[20:23], a[8:11]
    ds_read_b128 v[60:63], v13 offset:2048
    v_mfma_f32_16x16x32_bf16 a[12:15], v[36:39], v[20:23], a[12:15]
    ds_read_b128 v[44:47], v11 offset:2048
    v_mfma_f32_16x16x32_bf16 a[16:19], v[32:35], v[24:27], a[16:19]
    ds_read_b128 v[48:51], v11 offset:4096
    v_mfma_f32_16x16x32_bf16 a[20:23], v[36:39], v[24:27], a[20:23]
    ds_read_b128 v[52:55], v11 offset:6144
    v_mfma_f32_16x16x32_bf16 a[24:27], v[32:35], v[28:31], a[24:27]
    v_mfma_f32_16x16x32_bf16 a[28:31], v[36:39], v[28:31], a[28:31]
    s_waitcnt lgkmcnt(0)
    v_mfma_f32_16x16x32_bf16 a[0:3], v[56:59], v[40:43], a[0:3]
    v_mfma_f32_16x16x32_bf16 a[4:7], v[60:63], v[40:43], a[4:7]
    v_mfma_f32_16x16x32_bf16 a[8:11], v[56:59], v[44:47], a[8:11]
    v_mfma_f32_16x16x32_bf16 a[12:15], v[60:63], v[44:47], a[12:15]
    v_mfma_f32_16x16x32_bf16 a[16:19], v[56:59], v[48:51], a[16:19]
    v_mfma_f32_16x16x32_bf16 a[20:23], v[60:63], v[48:51], a[20:23]
    v_mfma_f32_16x16x32_bf16 a[24:27], v[56:59], v[52:55], a[24:27]
    v_mfma_f32_16x16x32_bf16 a[28:31], v[60:63], v[52:55], a[28:31]
    s_barrier
    s_nop 15
    s_mul_i32 s60, s58, 9216
    s_mul_i32 s61, s59, 64
    s_add_u32 s60, s60, s61
    v_and_b32 v4, 15, v2
    v_mul_u32_u24 v4, 144, v4
    v_lshrrev_b32 v5, 4, v2
    v_lshl_add_u32 v4, v5, 3, v4
    v_add_u32 v4, s60, v4
    v_accvgpr_read_b32 v16, a0
    v_accvgpr_read_b32 v17, a1
    v_accvgpr_read_b32 v18, a2
    v_accvgpr_read_b32 v19, a3
    v_cvt_pk_bf16_f32 v20, v16, v17
    v_cvt_pk_bf16_f32 v21, v18, v19
    ds_write_b64 v4, v[20:21] offset:0
    v_accvgpr_read_b32 v22, a4
    v_accvgpr_read_b32 v23, a5
    v_accvgpr_read_b32 v24, a6
    v_accvgpr_read_b32 v25, a7
    v_cvt_pk_bf16_f32 v26, v22, v23
    v_cvt_pk_bf16_f32 v27, v24, v25
    ds_write_b64 v4, v[26:27] offset:32
    v_accvgpr_read_b32 v28, a8
    v_accvgpr_read_b32 v29, a9
    v_accvgpr_read_b32 v30, a10
    v_accvgpr_read_b32 v31, a11
    v_cvt_pk_bf16_f32 v32, v28, v29
    v_cvt_pk_bf16_f32 v33, v30, v31
    ds_write_b64 v4, v[32:33] offset:2304
    v_accvgpr_read_b32 v34, a12
    v_accvgpr_read_b32 v35, a13
    v_accvgpr_read_b32 v36, a14
    v_accvgpr_read_b32 v37, a15
    v_cvt_pk_bf16_f32 v38, v34, v35
    v_cvt_pk_bf16_f32 v39, v36, v37
    ds_write_b64 v4, v[38:39] offset:2336
    v_accvgpr_read_b32 v40, a16
    v_accvgpr_read_b32 v41, a17
    v_accvgpr_read_b32 v42, a18
    v_accvgpr_read_b32 v43, a19
    v_cvt_pk_bf16_f32 v44, v40, v41
    v_cvt_pk_bf16_f32 v45, v42, v43
    ds_write_b64 v4, v[44:45] offset:4608
    v_accvgpr_read_b32 v46, a20
    v_accvgpr_read_b32 v47, a21
    v_accvgpr_read_b32 v48, a22
    v_accvgpr_read_b32 v49, a23
    v_cvt_pk_bf16_f32 v50, v46, v47
    v_cvt_pk_bf16_f32 v51, v48, v49
    ds_write_b64 v4, v[50:51] offset:4640
    v_accvgpr_read_b32 v52, a24
    v_accvgpr_read_b32 v53, a25
    v_accvgpr_read_b32 v54, a26
    v_accvgpr_read_b32 v55, a27
    v_cvt_pk_bf16_f32 v56, v52, v53
    v_cvt_pk_bf16_f32 v57, v54, v55
    ds_write_b64 v4, v[56:57] offset:6912
    v_accvgpr_read_b32 v58, a28
    v_accvgpr_read_b32 v59, a29
    v_accvgpr_read_b32 v60, a30
    v_accvgpr_read_b32 v61, a31
    v_cvt_pk_bf16_f32 v62, v58, v59
    v_cvt_pk_bf16_f32 v63, v60, v61
    ds_write_b64 v4, v[62:63] offset:6944
    s_branch k5_kernel_epi
k5_kernel_prod:
    s_add_u32 s16, s12, 0x2000000
    s_addc_u32 s17, s13, 0
    s_mov_b32 s18, 0xe00000
    s_mov_b32 s19, 0x00020000
    s_add_u32 s20, s12, 0x3800000
    s_addc_u32 s21, s13, 0
    s_mov_b32 s22, 0x700000
    s_mov_b32 s23, 0x00020000
    s_sub_u32 s46, s46, 4
    v_lshrrev_b32 v4, 3, v2
    v_and_b32 v5, 7, v2
    v_xor_b32 v5, v5, v4
    v_mul_u32_u24 v3, 7168, v4
    v_lshl_add_u32 v3, v5, 4, v3
    s_mul_i32 s47, s42, 128
    s_lshl_b32 s49, s46, 3
    s_add_u32 s47, s47, s49
    s_mul_i32 s47, s47, 7168
    s_mul_i32 s48, s43, 64
    s_add_u32 s48, s48, s49
    s_mul_i32 s48, s48, 7168
    s_lshl_b32 s50, s46, 10
    s_add_u32 s70, s50, 0
    s_add_u32 s71, s50, 24576
    s_add_u32 s72, s50, 49152
    s_add_u32 s73, s50, 73728
    s_add_u32 s51, s47, 0
    s_add_u32 m0, s70, 0
    s_nop 0
    buffer_load_dwordx4 v3, s[16:19], s51 offen lds
    s_add_u32 s51, s47, 229376
    s_add_u32 m0, s70, 4096
    s_nop 0
    buffer_load_dwordx4 v3, s[16:19], s51 offen lds
    s_add_u32 s51, s47, 458752
    s_add_u32 m0, s70, 8192
    s_nop 0
    buffer_load_dwordx4 v3, s[16:19], s51 offen lds
    s_add_u32 s51, s47, 688128
    s_add_u32 m0, s70, 12288
    s_nop 0
    buffer_load_dwordx4 v3, s[16:19], s51 offen lds
    s_add_u32 s51, s48, 0
    s_add_u32 m0, s70, 16384
    s_nop 0
    buffer_load_dwordx4 v3, s[20:23], s51 offen lds
    s_add_u32 s51, s48, 229376
    s_add_u32 m0, s70, 20480
    s_nop 0
    buffer_load_dwordx4 v3, s[20:23], s51 offen lds
    s_add_u32 s47, s47, 128
    s_add_u32 s48, s48, 128
    s_add_u32 s51, s47, 0
    s_add_u32 m0, s71, 0
    s_nop 0
    buffer_load_dwordx4 v3, s[16:19], s51 offen lds
    s_add_u32 s51, s47, 229376
    s_add_u32 m0, s71, 4096
    s_nop 0
    buffer_load_dwordx4 v3, s[16:19], s51 offen lds
    s_add_u32 s51, s47, 458752
    s_add_u32 m0, s71, 8192
    s_nop 0
    buffer_load_dwordx4 v3, s[16:19], s51 offen lds
    s_add_u32 s51, s47, 688128
    s_add_u32 m0, s71, 12288
    s_nop 0
    buffer_load_dwordx4 v3, s[16:19], s51 offen lds
    s_add_u32 s51, s48, 0
    s_add_u32 m0, s71, 16384
    s_nop 0
    buffer_load_dwordx4 v3, s[20:23], s51 offen lds
    s_add_u32 s51, s48, 229376
    s_add_u32 m0, s71, 20480
    s_nop 0
    buffer_load_dwordx4 v3, s[20:23], s51 offen lds
    s_add_u32 s47, s47, 128
    s_add_u32 s48, s48, 128
    s_add_u32 s51, s47, 0
    s_add_u32 m0, s72, 0
    s_nop 0
    buffer_load_dwordx4 v3, s[16:19], s51 offen lds
    s_add_u32 s51, s47, 229376
    s_add_u32 m0, s72, 4096
    s_nop 0
    buffer_load_dwordx4 v3, s[16:19], s51 offen lds
    s_add_u32 s51, s47, 458752
    s_add_u32 m0, s72, 8192
    s_nop 0
    buffer_load_dwordx4 v3, s[16:19], s51 offen lds
    s_add_u32 s51, s47, 688128
    s_add_u32 m0, s72, 12288
    s_nop 0
    buffer_load_dwordx4 v3, s[16:19], s51 offen lds
    s_add_u32 s51, s48, 0
    s_add_u32 m0, s72, 16384
    s_nop 0
    buffer_load_dwordx4 v3, s[20:23], s51 offen lds
    s_add_u32 s51, s48, 229376
    s_add_u32 m0, s72, 20480
    s_nop 0
    buffer_load_dwordx4 v3, s[20:23], s51 offen lds
    s_add_u32 s47, s47, 128
    s_add_u32 s48, s48, 128
    s_add_u32 s51, s47, 0
    s_add_u32 m0, s73, 0
    s_nop 0
    buffer_load_dwordx4 v3, s[16:19], s51 offen lds
    s_add_u32 s51, s47, 229376
    s_add_u32 m0, s73, 4096
    s_nop 0
    buffer_load_dwordx4 v3, s[16:19], s51 offen lds
    s_add_u32 s51, s47, 458752
    s_add_u32 m0, s73, 8192
    s_nop 0
    buffer_load_dwordx4 v3, s[16:19], s51 offen lds
    s_add_u32 s51, s47, 688128
    s_add_u32 m0, s73, 12288
    s_nop 0
    buffer_load_dwordx4 v3, s[16:19], s51 offen lds
    s_add_u32 s51, s48, 0
    s_add_u32 m0, s73, 16384
    s_nop 0
    buffer_load_dwordx4 v3, s[20:23], s51 offen lds
    s_add_u32 s51, s48, 229376
    s_add_u32 m0, s73, 20480
    s_nop 0
    buffer_load_dwordx4 v3, s[20:23], s51 offen lds
    s_add_u32 s47, s47, 128
    s_add_u32 s48, s48, 128
    s_waitcnt vmcnt(18)
    s_barrier
    s_mov_b32 s63, 52
k5_kernel_ploop:
    s_waitcnt vmcnt(12)
    s_barrier
    s_add_u32 s51, s47, 0
    s_add_u32 m0, s70, 0
    s_nop 0
    buffer_load_dwordx4 v3, s[16:19], s51 offen lds
    s_add_u32 s51, s47, 229376
    s_add_u32 m0, s70, 4096
    s_nop 0
    buffer_load_dwordx4 v3, s[16:19], s51 offen lds
    s_add_u32 s51, s47, 458752
    s_add_u32 m0, s70, 8192
    s_nop 0
    buffer_load_dwordx4 v3, s[16:19], s51 offen lds
    s_add_u32 s51, s47, 688128
    s_add_u32 m0, s70, 12288
    s_nop 0
    buffer_load_dwordx4 v3, s[16:19], s51 offen lds
    s_add_u32 s51, s48, 0
    s_add_u32 m0, s70, 16384
    s_nop 0
    buffer_load_dwordx4 v3, s[20:23], s51 offen lds
    s_add_u32 s51, s48, 229376
    s_add_u32 m0, s70, 20480
    s_nop 0
    buffer_load_dwordx4 v3, s[20:23], s51 offen lds
    s_add_u32 s47, s47, 128
    s_add_u32 s48, s48, 128
    s_mov_b32 s62, s70
    s_mov_b32 s70, s71
    s_mov_b32 s71, s72
    s_mov_b32 s72, s73
    s_mov_b32 s73, s62
    s_sub_u32 s63, s63, 1
    s_cmp_lg_u32 s63, 0
    s_cbranch_scc1 k5_kernel_ploop
    s_waitcnt vmcnt(12)
    s_barrier
    s_waitcnt vmcnt(6)
    s_barrier
    s_waitcnt vmcnt(0)
    s_barrier
    s_barrier
k5_kernel_epi:
    s_add_u32 s24, s12, 0x1800000
    s_addc_u32 s25, s13, 0
    s_mov_b32 s26, 0x400000
    s_mov_b32 s27, 0x00020000
    s_mov_b32 s28, s6
    s_mov_b32 s29, s7
    s_mov_b32 s30, 0x400000
    s_mov_b32 s31, 0x00020000
    v_lshrrev_b32 v4, 3, v0
    v_and_b32 v5, 7, v0
    v_lshlrev_b32 v6, 4, v5
    v_mul_u32_u24 v7, 144, v4
    v_add_u32 v7, v7, v6
    v_mul_u32_u24 v12, 2048, v4
    v_add_u32 v12, v12, v6
    s_mul_i32 s62, s42, 262144
    s_mul_i32 s61, s43, 128
    s_add_u32 s62, s62, s61
    s_add_u32 s61, s62, 0
    buffer_load_dwordx4 v[16:19], v12, s[24:27], s61 offen
    s_add_u32 s61, s62, 131072
    buffer_load_dwordx4 v[20:23], v12, s[24:27], s61 offen
    s_waitcnt lgkmcnt(0)
    s_barrier
    ds_read_b128 v[24:27], v7 offset:0
    ds_read_b128 v[28:31], v7 offset:9216
    s_waitcnt vmcnt(0) lgkmcnt(0)
    v_lshlrev_b32 v32, 16, v24
    v_and_b32 v33, 0xffff0000, v24
    v_lshlrev_b32 v40, 16, v16
    v_and_b32 v41, 0xffff0000, v16
    v_lshlrev_b32 v34, 16, v25
    v_and_b32 v35, 0xffff0000, v25
    v_lshlrev_b32 v42, 16, v17
    v_and_b32 v43, 0xffff0000, v17
    v_lshlrev_b32 v36, 16, v26
    v_and_b32 v37, 0xffff0000, v26
    v_lshlrev_b32 v44, 16, v18
    v_and_b32 v45, 0xffff0000, v18
    v_lshlrev_b32 v38, 16, v27
    v_and_b32 v39, 0xffff0000, v27
    v_lshlrev_b32 v46, 16, v19
    v_and_b32 v47, 0xffff0000, v19
    v_add_f32 v32, v32, v40
    v_add_f32 v33, v33, v41
    v_add_f32 v34, v34, v42
    v_add_f32 v35, v35, v43
    v_add_f32 v36, v36, v44
    v_add_f32 v37, v37, v45
    v_add_f32 v38, v38, v46
    v_add_f32 v39, v39, v47
    v_cvt_pk_bf16_f32 v24, v32, v33
    v_cvt_pk_bf16_f32 v25, v34, v35
    v_cvt_pk_bf16_f32 v26, v36, v37
    v_cvt_pk_bf16_f32 v27, v38, v39
    s_add_u32 s61, s62, 0
    buffer_store_dwordx4 v[24:27], v12, s[28:31], s61 offen sc1
    v_lshlrev_b32 v48, 16, v28
    v_and_b32 v49, 0xffff0000, v28
    v_lshlrev_b32 v56, 16, v20
    v_and_b32 v57, 0xffff0000, v20
    v_lshlrev_b32 v50, 16, v29
    v_and_b32 v51, 0xffff0000, v29
    v_lshlrev_b32 v58, 16, v21
    v_and_b32 v59, 0xffff0000, v21
    v_lshlrev_b32 v52, 16, v30
    v_and_b32 v53, 0xffff0000, v30
    v_lshlrev_b32 v60, 16, v22
    v_and_b32 v61, 0xffff0000, v22
    v_lshlrev_b32 v54, 16, v31
    v_and_b32 v55, 0xffff0000, v31
    v_lshlrev_b32 v62, 16, v23
    v_and_b32 v63, 0xffff0000, v23
    v_add_f32 v48, v48, v56
    v_add_f32 v49, v49, v57
    v_add_f32 v50, v50, v58
    v_add_f32 v51, v51, v59
    v_add_f32 v52, v52, v60
    v_add_f32 v53, v53, v61
    v_add_f32 v54, v54, v62
    v_add_f32 v55, v55, v63
    v_cvt_pk_bf16_f32 v28, v48, v49
    v_cvt_pk_bf16_f32 v29, v50, v51
    v_cvt_pk_bf16_f32 v30, v52, v53
    v_cvt_pk_bf16_f32 v31, v54, v55
    s_add_u32 s61, s62, 131072
    buffer_store_dwordx4 v[28:31], v12, s[28:31], s61 offen sc1
k5_kernel_end:
    s_endpgm
.section .rodata,"a"
.p2align 6
.amdhsa_kernel k1_kernel
  .amdhsa_next_free_vgpr 128
  .amdhsa_next_free_sgpr 102
  .amdhsa_accum_offset 128
  .amdhsa_group_segment_fixed_size 0
  .amdhsa_kernarg_size 80
  .amdhsa_user_sgpr_count 2
  .amdhsa_user_sgpr_kernarg_segment_ptr 1
  .amdhsa_system_sgpr_workgroup_id_x 1
.end_amdhsa_kernel
.p2align 6
.amdhsa_kernel k2_kernel
  .amdhsa_next_free_vgpr 128
  .amdhsa_next_free_sgpr 102
  .amdhsa_accum_offset 128
  .amdhsa_group_segment_fixed_size 0
  .amdhsa_kernarg_size 80
  .amdhsa_user_sgpr_count 2
  .amdhsa_user_sgpr_kernarg_segment_ptr 1
  .amdhsa_system_sgpr_workgroup_id_x 1
.end_amdhsa_kernel
.p2align 6
.amdhsa_kernel k3_kernel
  .amdhsa_next_free_vgpr 128
  .amdhsa_next_free_sgpr 102
  .amdhsa_accum_offset 128
  .amdhsa_group_segment_fixed_size 0
  .amdhsa_kernarg_size 80
  .amdhsa_user_sgpr_count 2
  .amdhsa_user_sgpr_kernarg_segment_ptr 1
  .amdhsa_system_sgpr_workgroup_id_x 1
.end_amdhsa_kernel
.p2align 6
.amdhsa_kernel k4_kernel
  .amdhsa_next_free_vgpr 240
  .amdhsa_next_free_sgpr 102
  .amdhsa_accum_offset 128
  .amdhsa_group_segment_fixed_size 0
  .amdhsa_kernarg_size 80
  .amdhsa_user_sgpr_count 2
  .amdhsa_user_sgpr_kernarg_segment_ptr 1
  .amdhsa_system_sgpr_workgroup_id_x 1
.end_amdhsa_kernel
.p2align 6
.amdhsa_kernel k5_kernel
  .amdhsa_next_free_vgpr 160
  .amdhsa_next_free_sgpr 102
  .amdhsa_accum_offset 128
  .amdhsa_group_segment_fixed_size 0
  .amdhsa_kernarg_size 80
  .amdhsa_user_sgpr_count 2
  .amdhsa_user_sgpr_kernarg_segment_ptr 1
  .amdhsa_system_sgpr_workgroup_id_x 1
.end_amdhsa_kernel
```
